```python
import torch

def _softmax(x, axis=-1):
    return torch.softmax(x, dim=axis)
def _gelu(x):
    return torch.nn.functional.gelu(x, approximate="tanh")
def _silu(x):
    return torch.nn.functional.silu(x)
def _sigmoid(x):
    return torch.sigmoid(x)
def _layernorm(x, axis=-1, eps=1e-5):
    m = x.mean(dim=axis, keepdim=True)
    v = x.var(dim=axis, keepdim=True, unbiased=False)
    return (x - m) / torch.sqrt(v + eps)
def _scatter_add(tgt, idx, src, axis=0):
    return tgt.clone().index_add_(axis, idx, src)
def _segment_sum(src, seg, n):
    out = torch.zeros((n,) + src.shape[1:], dtype=src.dtype)
    return out.index_add_(0, seg, src)
def _pad(x, pw):
    flat = tuple(v for pair in reversed(pw) for v in pair)
    return torch.nn.functional.pad(x, flat)

kernel_name = 'recurrent_scan__ssm_conv_s5__mixer_channel_mlp__prompt'

def setup_inputs():

    _w = (lambda a: (lambda t: t.to(torch.bfloat16) if t.is_floating_point() else t)(torch.as_tensor(a)))
    def _A_setup():
        B, S, D = 1, 2048, 1024
        P = D
        Lambda_re = -0.5 * (lambda _x: torch.exp(torch.as_tensor(_x)))((lambda *s: torch.randn(*s, dtype=torch.bfloat16) * 0.8)(P))
        Lambda_im = (lambda *s: torch.randn(*s, dtype=torch.bfloat16) * 0.8)(P) * 1.0
        B_re = (lambda *s: torch.randn(*s, dtype=torch.bfloat16) * 0.8)(P, D) * (D ** -0.5)
        B_im = (lambda *s: torch.randn(*s, dtype=torch.bfloat16) * 0.8)(P, D) * (D ** -0.5)
        C_re = (lambda *s: torch.randn(*s, dtype=torch.bfloat16) * 0.8)(D, P) * (P ** -0.5)
        C_im = (lambda *s: torch.randn(*s, dtype=torch.bfloat16) * 0.8)(D, P) * (P ** -0.5)
        log_dt = (lambda *s: torch.randn(*s, dtype=torch.bfloat16) * 0.8)(P) * 0.3 - 2.0
        Dskip = (lambda *s: torch.randn(*s, dtype=torch.bfloat16) * 0.4)(D)
        return {
            "x": _w((lambda *s: torch.randn(*s, dtype=torch.bfloat16) * 0.05)(B, S, D)),
            "Lambda_re": _w(Lambda_re),
            "Lambda_im": _w(Lambda_im),
            "B_re": _w(B_re),
            "B_im": _w(B_im),
            "C_re": _w(C_re),
            "C_im": _w(C_im),
            "log_dt": _w(log_dt),
            "Dskip": _w(Dskip),
        }
    _A_in = _A_setup()

    def _B_setup():
        B, S, D, F = 1, 2048, 1024, 3584
        return {
            "x": _w((lambda *s: torch.randn(*s, dtype=torch.bfloat16) * 0.05)(B, S, D)),
            "w1": _w((lambda *s: torch.randn(*s, dtype=torch.bfloat16) * 0.8)(D, F) * (D ** -0.5)),
            "b1": _w((lambda *s: torch.randn(*s, dtype=torch.bfloat16) * 0.8)(F)),
            "w2": _w((lambda *s: torch.randn(*s, dtype=torch.bfloat16) * 0.1)(F, D) * (F ** -0.5)),
            "b2": _w((lambda *s: torch.randn(*s, dtype=torch.bfloat16) * 0.1)(D)),
        }
    _B_in = _B_setup()

    return {
        "A_x": _A_in["x"],
        "A_Lambda_re": _A_in["Lambda_re"],
        "A_Lambda_im": _A_in["Lambda_im"],
        "A_B_re": _A_in["B_re"],
        "A_B_im": _A_in["B_im"],
        "A_C_re": _A_in["C_re"],
        "A_C_im": _A_in["C_im"],
        "A_log_dt": _A_in["log_dt"],
        "A_Dskip": _A_in["Dskip"],
        "B_x": _B_in["x"],
        "B_w1": _B_in["w1"],
        "B_b1": _B_in["b1"],
        "B_w2": _B_in["w2"],
        "B_b2": _B_in["b2"],
    }

def reference(A_x, A_Lambda_re, A_Lambda_im, A_B_re, A_B_im, A_C_re, A_C_im, A_log_dt, A_Dskip, B_x, B_w1, B_b1, B_w2, B_b2):
    def _A_ref(x, Lambda_re, Lambda_im, B_re, B_im, C_re, C_im, log_dt, Dskip):
        Bsz, L, H = x.shape
        Lam = Lambda_re + 1j * Lambda_im
        Bmat = B_re + 1j * B_im
        Cmat = C_re + 1j * C_im
        dt = torch.exp(log_dt)
        Lam_bar = torch.exp(dt * Lam)
        B_bar = ((Lam_bar - 1.0) / Lam)[:, None] * Bmat
        Bu = torch.einsum("bld,pd->blp", x + 0j, B_bar)
        h = torch.zeros_like(Bu[:, 0, :])
        hs = []
        for t in range(L):
            h = Lam_bar[None, :] * h + Bu[:, t, :]
            hs.append(h)
        hseq = torch.stack(hs, 1)
        y = 2.0 * torch.einsum("blp,dp->bld", hseq, Cmat).real + x * Dskip[None, None, :]
        return y

    def _B_ref(x, w1, b1, w2, b2):
        y = _layernorm(x, axis=-1)
        h = _gelu(torch.einsum("bsd,df->bsf", y, w1) + b1)
        return torch.einsum("bsf,fd->bsd", h, w2) + b2

    x = A_x
    xn = _layernorm(x, axis=-1)
    s = _A_ref(xn, A_Lambda_re, A_Lambda_im, A_B_re, A_B_im, A_C_re, A_C_im, A_log_dt, A_Dskip)
    g = _silu(_B_ref(xn, B_w1, B_b1, B_w2, B_b2))
    return x + s * g
```

```asm
; @launch grid=(256,1,1) block=(256,1,1) lds=163840
.amdgcn_target "amdgcn-amd-amdhsa--gfx950"
.text
.globl recurrent_scan__ssm_conv_s5__mixer_channel_mlp__prompt_kernel
.p2align 8
.type recurrent_scan__ssm_conv_s5__mixer_channel_mlp__prompt_kernel,@function
recurrent_scan__ssm_conv_s5__mixer_channel_mlp__prompt_kernel:
    s_cmp_ge_u32 s2, 256
    s_cbranch_scc1 L_end
    s_load_dwordx16 s[4:19], s[0:1], 0
    s_load_dwordx16 s[20:35], s[0:1], 64
    s_load_dwordx2 s[36:37], s[0:1], 128
    v_lshrrev_b32 v40, 6, v0
    v_and_b32 v1, 63, v0
    v_lshrrev_b32 v41, 4, v1
    v_and_b32 v42, 15, v1
    v_readfirstlane_b32 s38, v40
    s_getpc_b64 s[60:61]
L_pc_1:
    s_sub_u32 s60, s60, L_pc_1-recurrent_scan__ssm_conv_s5__mixer_channel_mlp__prompt_kernel
    s_subb_u32 s61, s61, 0
    s_mov_b32 s62, L_code_end-recurrent_scan__ssm_conv_s5__mixer_channel_mlp__prompt_kernel
    s_mov_b32 s63, 0x20000
    s_lshr_b32 s93, s2, 3
    s_mul_i32 s93, s93, ((L_pfc_b-L_pfc_a+4095)/4096)
    v_add_u32 v44, s93, v1
    v_lshlrev_b32 v44, 7, v44
    v_add_u32 v44, L_pfc_a-recurrent_scan__ssm_conv_s5__mixer_channel_mlp__prompt_kernel, v44
    s_cmp_eq_u32 s38, 3
    s_cselect_b32 s93, ((L_pfc_b-L_pfc_a+4095)/4096), 0
    v_cmp_gt_u32 vcc, s93, v1
    v_mov_b32 v43, 1073741824
    s_nop 0
    v_cndmask_b32 v44, v43, v44, vcc
    buffer_load_dword v150, v44, s[60:63], 0 offen
L_pfc_a:
    s_and_b32 s91, s2, 7
    s_lshr_b32 s92, s2, 3
    s_and_b32 s93, s92, 3
    s_lshr_b32 s94, s92, 2
    s_and_b32 s72, s91, 1
    s_lshl_b32 s72, s72, 2
    s_add_u32 s72, s72, s93
    s_lshr_b32 s73, s91, 1
    s_lshl_b32 s73, s73, 3
    s_add_u32 s73, s73, s94
    s_lshl_b32 s74, s72, 2
    s_add_u32 s74, s74, s38
    s_and_b32 s75, s73, 1
    s_and_b32 s76, s91, 1
    s_lshr_b32 s77, s91, 1
    s_lshl_b32 s77, s77, 2
    s_add_u32 s77, s77, s93
    s_mov_b32 s78, s94
    s_lshl_b32 s79, s77, 3
    s_add_u32 s79, s79, s78
    s_lshl_b32 s79, s79, 2
    s_add_u32 s79, s79, s38
    s_lshr_b32 s91, s73, 3
    s_lshl_b32 s92, s72, 2
    s_add_u32 s91, s91, s92
    s_bfe_u32 s92, s73, 0x20001
    s_lshl_b32 s93, s91, 6
    s_lshl_b32 s94, s75, 5
    s_add_u32 s93, s93, s94
    s_lshl_b32 s94, s92, 2
    s_add_u32 s93, s93, s94
    v_and_b32 v128, 7, v1
    v_lshrrev_b32 v129, 3, v1
    v_lshrrev_b32 v134, 2, v129
    v_lshlrev_b32 v134, 4, v134
    v_and_b32 v135, 3, v129
    v_add3_u32 v134, v134, v135, s93
    v_lshlrev_b32 v130, 11, v134
    s_lshl_b32 s94, s38, 9
    v_lshl_add_u32 v130, v128, 4, v130
    v_add_u32 v130, s94, v130
    s_waitcnt lgkmcnt(0)
    s_mov_b32 s44, s4
    s_mov_b32 s45, s5
    s_mov_b32 s46, 0x400000
    s_mov_b32 s47, 0x20000
    s_mov_b32 s40, s36
    s_mov_b32 s41, s37
    s_mov_b32 s42, 0x2900000
    s_mov_b32 s43, 0x20000
    s_mov_b32 s68, s34
    s_mov_b32 s69, s35
    s_mov_b32 s70, 0x100
    s_mov_b32 s71, 0x20000
    s_lshl_b32 s22, s2, 2
    s_add_u32 s22, s22, s38
    s_cmp_lg_u32 s22, 3
    s_cbranch_scc1 L_noclr
    v_lshlrev_b32 v144, 7, v1
    v_add_u32 v144, 40042496, v144
    v_mov_b32 v145, 0
    buffer_store_dword v145, v144, s[40:43], 0 offen sc1
    v_add_u32 v144, 8192, v144
    s_mov_b64 exec, 0xff
    buffer_store_dword v145, v144, s[40:43], 0 offen sc1
    s_mov_b64 exec, -1
L_noclr:
    buffer_load_dwordx4 v[80:83], v130, s[44:47], 0 offen offset:0 nt
    buffer_load_dwordx4 v[84:87], v130, s[44:47], 0 offen offset:128 nt
    buffer_load_dwordx4 v[88:91], v130, s[44:47], 0 offen offset:256 nt
    buffer_load_dwordx4 v[92:95], v130, s[44:47], 0 offen offset:384 nt
    s_cmp_lg_u32 s22, 3
    s_cbranch_scc1 L_noann
    v_mov_b32 v144, 0
    v_mov_b32 v145, 1
    s_waitcnt vmcnt(4)
    s_mov_b64 exec, 1
    buffer_store_dword v145, v144, s[68:71], 0 offen sc1
    s_mov_b64 exec, -1
L_noann:
    s_lshl_b32 s94, s73, 6
    v_lshl_add_u32 v48, v42, 1, s94
    v_min_u32 v44, 111, v0
    v_lshrrev_b32 v43, 4, v44
    v_add_u32 v43, s75, v43
    v_cmp_eq_u32 vcc, 7, v43
    v_and_b32 v44, 15, v44
    s_mul_i32 s94, s73, 112
    v_cndmask_b32 v43, v43, 0, vcc
    v_lshl_add_u32 v44, v43, 4, v44
    v_add_u32 v44, s94, v44
    v_lshlrev_b32 v49, 1, v44
    global_load_ushort v52, v48, s[6:7]
    global_load_ushort v53, v48, s[6:7] offset:32
    global_load_ushort v54, v48, s[8:9]
    global_load_ushort v55, v48, s[8:9] offset:32
    global_load_ushort v56, v48, s[18:19]
    global_load_ushort v57, v48, s[18:19] offset:32
    global_load_ushort v58, v49, s[26:27]
    s_lshl_b32 s94, s73, 3
    s_add_u32 s94, s94, s72
    s_lshl_b32 s94, s94, 8
    s_add_u32 s94, s94, 39911424
    s_cmp_eq_u32 s38, 1
    s_cselect_b32 s95, s94, 1073741824
    v_lshlrev_b32 v144, 2, v1
    v_mov_b32 v145, -1
    buffer_store_dword v145, v144, s[40:43], s95 offen sc1
    s_cmp_eq_u32 s38, 0
    s_cselect_b32 s94, 0, 1073741824
    v_mov_b32 v146, s94
    s_mov_b64 exec, 1
    buffer_load_dword v147, v146, s[68:71], 0 offen sc1
    s_mov_b64 exec, -1
    s_mov_b32 s48, s10
    s_mov_b32 s49, s11
    s_mov_b32 s50, 0x200000
    s_mov_b32 s51, 0x20000
    s_mov_b32 s52, s12
    s_mov_b32 s53, s13
    s_mov_b32 s54, 0x200000
    s_mov_b32 s55, 0x20000
    s_mov_b32 s56, s24
    s_mov_b32 s57, s25
    s_mov_b32 s58, 0x700000
    s_mov_b32 s59, 0x20000
    v_lshrrev_b32 v131, 2, v129
    v_lshlrev_b32 v131, 17, v131
    v_and_b32 v134, 3, v129
    v_lshl_add_u32 v131, v134, 8, v131
    v_lshl_add_u32 v131, v128, 4, v131
    s_lshl_b32 s93, s38, 20
    s_lshl_b32 s94, s91, 12
    s_add_u32 s93, s93, s94
    s_lshl_b32 s94, s92, 10
    s_add_u32 s93, s93, s94
    s_lshl_b32 s94, s75, 7
    s_add_u32 s93, s93, s94
    v_add_u32 v131, s93, v131
    v_xor_b32 v135, v128, v129
    v_lshlrev_b32 v135, 4, v135
    s_lshl_b32 s94, s38, 12
    s_add_u32 s94, s94, 91136
    v_add_u32 v135, s94, v135
    v_lshl_add_u32 v144, v129, 7, v135
    v_lshl_add_u32 v145, v128, 7, v135
    v_lshlrev_b32 v132, 5, v129
    s_lshl_b32 s94, s38, 3
    v_add_u32 v134, 156672, v132
    v_add_u32 v133, s94, v134
    s_lshl_b32 s93, s91, 9
    s_lshl_b32 s94, s75, 8
    s_add_u32 s93, s93, s94
    s_lshl_b32 s94, s92, 2
    s_add_u32 s93, s93, s94
    s_add_u32 s93, s93, 39845888
    s_cmp_eq_u32 s38, 0
    s_cselect_b32 s23, s93, 1073741824
    s_lshl_b32 s93, s74, 12
    v_lshl_add_u32 v2, v1, 4, s93
    v_lshrrev_b32 v43, 3, v1
    s_lshl_b32 s93, s38, 3
    s_lshl_b32 s94, s73, 5
    s_add_u32 s94, s94, s93
    v_add_u32 v44, s94, v43
    v_lshlrev_b32 v44, 11, v44
    s_lshl_b32 s93, s38, 2
    v_add_u32 v45, s93, v41
    v_and_b32 v45, 7, v45
    v_and_b32 v46, 7, v1
    v_xor_b32 v45, v45, v46
    v_lshl_add_u32 v3, v45, 4, v44
    s_mul_i32 s94, s73, 224
    s_lshl_b32 s95, s75, 1
    s_movk_i32 s91, 4682
    s_movk_i32 s92, 7168
    s_mul_i32 s93, s38, 192
    s_add_u32 s93, s93, 0
    v_add_u32 v43, s93, v1
    v_mul_u32_u24 v44, s91, v43
    v_lshrrev_b32 v44, 16, v44
    v_mul_u32_u24 v45, 14, v44
    v_sub_u32 v45, v43, v45
    v_add_u32 v45, s95, v45
    v_subrev_u32 v46, 14, v45
    v_min_u32 v45, v45, v46
    v_lshrrev_b32 v46, 2, v44
    v_lshrrev_b32 v47, 3, v44
    v_xor_b32 v46, v46, v47
    v_and_b32 v46, 1, v46
    v_mul_u32_u24 v46, 12, v46
    v_xor_b32 v44, v44, v46
    v_mul_u32_u24 v44, s92, v44
    v_lshl_add_u32 v44, v45, 4, v44
    v_add_u32 v4, s94, v44
    s_mul_i32 s93, s38, 192
    s_add_u32 s93, s93, 64
    v_add_u32 v43, s93, v1
    v_mul_u32_u24 v44, s91, v43
    v_lshrrev_b32 v44, 16, v44
    v_mul_u32_u24 v45, 14, v44
    v_sub_u32 v45, v43, v45
    v_add_u32 v45, s95, v45
    v_subrev_u32 v46, 14, v45
    v_min_u32 v45, v45, v46
    v_lshrrev_b32 v46, 2, v44
    v_lshrrev_b32 v47, 3, v44
    v_xor_b32 v46, v46, v47
    v_and_b32 v46, 1, v46
    v_mul_u32_u24 v46, 12, v46
    v_xor_b32 v44, v44, v46
    v_mul_u32_u24 v44, s92, v44
    v_lshl_add_u32 v44, v45, 4, v44
    v_add_u32 v5, s94, v44
    s_mul_i32 s93, s38, 192
    s_add_u32 s93, s93, 128
    v_add_u32 v43, s93, v1
    v_mul_u32_u24 v44, s91, v43
    v_lshrrev_b32 v44, 16, v44
    v_mul_u32_u24 v45, 14, v44
    v_sub_u32 v45, v43, v45
    v_add_u32 v45, s95, v45
    v_subrev_u32 v46, 14, v45
    v_min_u32 v45, v45, v46
    v_lshrrev_b32 v46, 2, v44
    v_lshrrev_b32 v47, 3, v44
    v_xor_b32 v46, v46, v47
    v_and_b32 v46, 1, v46
    v_mul_u32_u24 v46, 12, v46
    v_xor_b32 v44, v44, v46
    v_mul_u32_u24 v44, s92, v44
    v_lshl_add_u32 v44, v45, 4, v44
    v_add_u32 v6, s94, v44
    s_lshr_b32 s93, s38, 1
    s_lshl_b32 s93, s93, 6
    s_add_u32 s93, s93, 768
    v_add_u32 v43, s93, v1
    v_mul_u32_u24 v44, s91, v43
    v_lshrrev_b32 v44, 16, v44
    v_mul_u32_u24 v45, 14, v44
    v_sub_u32 v45, v43, v45
    v_add_u32 v45, s95, v45
    v_subrev_u32 v46, 14, v45
    v_min_u32 v45, v45, v46
    v_lshrrev_b32 v46, 2, v44
    v_lshrrev_b32 v47, 3, v44
    v_xor_b32 v46, v46, v47
    v_and_b32 v46, 1, v46
    v_mul_u32_u24 v46, 12, v46
    v_xor_b32 v44, v44, v46
    v_mul_u32_u24 v44, s92, v44
    v_lshl_add_u32 v44, v45, 4, v44
    v_add_u32 v7, s94, v44
    s_lshl_b32 s83, s38, 10
    s_mul_i32 s84, s38, 3072
    s_add_u32 s84, s84, 8192
    s_lshr_b32 s85, s38, 1
    s_lshl_b32 s85, s85, 10
    s_add_u32 s85, s85, 20480
    s_and_b32 s93, s38, 1
    s_cmp_eq_u32 s93, 0
    s_cselect_b32 s86, -1, 0
    s_cselect_b32 s87, 0, -1
    s_mov_b32 s80, 0
    s_mov_b32 s81, 0
    s_mov_b32 s82, 0
    v_lshrrev_b32 v43, 1, v42
    v_xor_b32 v44, v43, v41
    v_lshlrev_b32 v44, 4, v44
    v_lshl_add_u32 v44, v42, 7, v44
    v_xor_b32 v45, 64, v44
    v_add_u32 v8, 1024, v44
    v_add_u32 v9, 1024, v45
    v_add_u32 v10, 46080, v44
    v_add_u32 v11, 46080, v45
    v_lshrrev_b32 v43, 1, v41
    v_lshlrev_b32 v43, 4, v43
    v_and_b32 v44, 1, v41
    v_lshl_add_u32 v43, v44, 2, v43
    v_lshrrev_b32 v44, 2, v42
    v_add_u32 v43, v43, v44
    v_mul_u32_u24 v43, 224, v43
    v_and_b32 v44, 3, v42
    v_lshl_add_u32 v43, v44, 3, v43
    v_add_u32 v12, 9216, v43
    v_add_u32 v13, 54272, v43
    v_lshlrev_b32 v50, 5, v42
    s_lshl_b32 s93, s74, 9
    v_add_u32 v50, s93, v50
    s_cmp_eq_u32 s38, 1
    s_cselect_b32 s26, s10, s12
    s_cselect_b32 s27, s11, s13
    s_cmp_eq_u32 s38, 0
    s_cselect_b32 s24, s24, s26
    s_cselect_b32 s25, s25, s27
    s_mov_b32 s94, 7340032
    s_cselect_b32 s26, s94, 0x200000
    s_cmp_eq_u32 s38, 3
    s_cselect_b32 s26, 0, s26
    s_mov_b32 s27, 0x20000
    s_mul_i32 s94, s2, 56
    v_add_u32 v43, s94, v1
    v_lshlrev_b32 v43, 7, v43
    v_lshrrev_b32 v44, 2, v1
    s_lshl_b32 s94, s2, 2
    v_add_u32 v44, s94, v44
    v_lshlrev_b32 v44, 11, v44
    v_and_b32 v45, 3, v1
    v_lshl_add_u32 v44, v45, 7, v44
    s_cmp_eq_u32 s38, 0
    s_cselect_b32 s94, 56, 16
    s_cselect_b64 vcc, -1, 0
    v_cndmask_b32 v49, v44, v43, vcc
    v_cmp_gt_u32 vcc, s94, v1
    v_mov_b32 v43, 1073741824
    s_nop 0
    v_cndmask_b32 v49, v43, v49, vcc
    s_add_u32 m0, s83, 1024
    s_nop 0
    buffer_load_dwordx4 v3, s[48:51], s81 offen lds
    s_add_u32 m0, s83, 5120
    s_nop 0
    buffer_load_dwordx4 v3, s[52:55], s81 offen lds
    s_add_u32 m0, s84, 1024
    s_add_u32 s81, s81, 128
    buffer_load_dwordx4 v4, s[56:59], s82 offen lds
    s_add_u32 m0, s84, 2048
    s_nop 0
    buffer_load_dwordx4 v5, s[56:59], s82 offen lds
    s_add_u32 m0, s84, 3072
    s_nop 0
    buffer_load_dwordx4 v6, s[56:59], s82 offen lds
    s_add_u32 m0, s85, 1024
    s_nop 0
    s_mov_b64 exec, s[86:87]
    buffer_load_dwordx4 v7, s[56:59], s82 offen lds
    s_mov_b64 exec, -1
    s_add_u32 s82, s82, 458752
    s_mov_b32 s91, 0x40000
    s_mov_b32 s92, 0x80000
    s_mov_b32 s93, 0xc0000
    s_mov_b32 s94, 0x3f803f80
    s_mov_b32 s95, 0xffff0000
    v_mov_b32 v136, 0
    v_mov_b32 v137, 0
    v_mov_b32 v138, 0
    v_mov_b32 v139, 0
    s_waitcnt vmcnt(15)
    v_dot2_f32_bf16 v136, v80, s94, v136
    v_dot2_f32_bf16 v137, v80, v80, v137
    v_dot2_f32_bf16 v138, v81, s94, v138
    v_dot2_f32_bf16 v139, v81, v81, v139
    v_dot2_f32_bf16 v136, v82, s94, v136
    v_dot2_f32_bf16 v137, v82, v82, v137
    v_dot2_f32_bf16 v138, v83, s94, v138
    v_dot2_f32_bf16 v139, v83, v83, v139
    v_dot2_f32_bf16 v136, v84, s94, v136
    v_dot2_f32_bf16 v137, v84, v84, v137
    v_dot2_f32_bf16 v138, v85, s94, v138
    v_dot2_f32_bf16 v139, v85, v85, v139
    v_dot2_f32_bf16 v136, v86, s94, v136
    v_dot2_f32_bf16 v137, v86, v86, v137
    v_dot2_f32_bf16 v138, v87, s94, v138
    v_dot2_f32_bf16 v139, v87, v87, v139
    v_dot2_f32_bf16 v136, v88, s94, v136
    v_dot2_f32_bf16 v137, v88, v88, v137
    v_dot2_f32_bf16 v138, v89, s94, v138
    v_dot2_f32_bf16 v139, v89, v89, v139
    v_dot2_f32_bf16 v136, v90, s94, v136
    v_dot2_f32_bf16 v137, v90, v90, v137
    v_dot2_f32_bf16 v138, v91, s94, v138
    v_dot2_f32_bf16 v139, v91, v91, v139
    v_dot2_f32_bf16 v136, v92, s94, v136
    v_dot2_f32_bf16 v137, v92, v92, v137
    v_dot2_f32_bf16 v138, v93, s94, v138
    v_dot2_f32_bf16 v139, v93, v93, v139
    v_dot2_f32_bf16 v136, v94, s94, v136
    v_dot2_f32_bf16 v137, v94, v94, v137
    v_dot2_f32_bf16 v138, v95, s94, v138
    v_dot2_f32_bf16 v139, v95, v95, v139
    s_nop 2
    v_add_f32 v136, v136, v138
    v_add_f32 v137, v137, v139
    s_nop 1
    v_add_f32_dpp v136, v136, v136 quad_perm:[1,0,3,2] row_mask:0xf bank_mask:0xf
    v_add_f32_dpp v137, v137, v137 quad_perm:[1,0,3,2] row_mask:0xf bank_mask:0xf
    s_nop 0
    v_add_f32_dpp v136, v136, v136 quad_perm:[2,3,0,1] row_mask:0xf bank_mask:0xf
    v_add_f32_dpp v137, v137, v137 quad_perm:[2,3,0,1] row_mask:0xf bank_mask:0xf
    s_nop 0
    v_add_f32_dpp v136, v136, v136 row_half_mirror row_mask:0xf bank_mask:0xf
    v_add_f32_dpp v137, v137, v137 row_half_mirror row_mask:0xf bank_mask:0xf
    ds_write_b64 v133, v[136:137] offset:0
    v_lshlrev_b32 v96, 16, v80
    v_and_b32 v97, s95, v80
    v_lshlrev_b32 v98, 16, v81
    v_and_b32 v99, s95, v81
    v_lshlrev_b32 v100, 16, v82
    v_and_b32 v101, s95, v82
    v_lshlrev_b32 v102, 16, v83
    v_and_b32 v103, s95, v83
    v_lshlrev_b32 v104, 16, v84
    v_and_b32 v105, s95, v84
    v_lshlrev_b32 v106, 16, v85
    v_and_b32 v107, s95, v85
    v_lshlrev_b32 v108, 16, v86
    v_and_b32 v109, s95, v86
    v_lshlrev_b32 v110, 16, v87
    v_and_b32 v111, s95, v87
    v_lshlrev_b32 v112, 16, v88
    v_and_b32 v113, s95, v88
    v_lshlrev_b32 v114, 16, v89
    v_and_b32 v115, s95, v89
    v_lshlrev_b32 v116, 16, v90
    v_and_b32 v117, s95, v90
    v_lshlrev_b32 v118, 16, v91
    v_and_b32 v119, s95, v91
    v_lshlrev_b32 v120, 16, v92
    v_and_b32 v121, s95, v92
    v_lshlrev_b32 v122, 16, v93
    v_and_b32 v123, s95, v93
    v_lshlrev_b32 v124, 16, v94
    v_and_b32 v125, s95, v94
    v_lshlrev_b32 v126, 16, v95
    v_and_b32 v127, s95, v95
    s_waitcnt lgkmcnt(0)
    s_barrier
    ds_read_b128 v[136:139], v134 offset:0
    ds_read_b128 v[140:143], v134 offset:16
    s_waitcnt lgkmcnt(0)
    v_pk_add_f32 v[136:137], v[136:137], v[138:139]
    v_pk_add_f32 v[140:141], v[140:141], v[142:143]
    v_pk_add_f32 v[136:137], v[136:137], v[140:141]
    v_mul_f32 v136, 0x3a800000, v136
    v_mul_f32 v137, 0x3a800000, v137
    v_fma_f32 v137, -v136, v136, v137
    v_max_f32 v137, 0, v137
    v_mov_b32 v139, v137
    v_cvt_pk_bf16_f32 v137, v137, v137
    v_lshlrev_b32 v137, 16, v137
    v_add_f32 v137, 0x3727c5ac, v137
    v_cvt_pk_bf16_f32 v137, v137, v137
    v_lshlrev_b32 v137, 16, v137
    v_sqrt_f32 v137, v137
    s_nop 0
    v_cvt_pk_bf16_f32 v137, v137, v137
    v_lshlrev_b32 v137, 16, v137
    v_rcp_f32 v137, v137
    s_nop 0
    v_mul_f32 v136, v136, v137
    v_pk_fma_f32 v[96:97], v[96:97], v[136:137], v[136:137] op_sel:[0,1,0] op_sel_hi:[1,1,0] neg_lo:[0,0,1] neg_hi:[0,0,1]
    v_pk_fma_f32 v[98:99], v[98:99], v[136:137], v[136:137] op_sel:[0,1,0] op_sel_hi:[1,1,0] neg_lo:[0,0,1] neg_hi:[0,0,1]
    v_pk_fma_f32 v[100:101], v[100:101], v[136:137], v[136:137] op_sel:[0,1,0] op_sel_hi:[1,1,0] neg_lo:[0,0,1] neg_hi:[0,0,1]
    v_pk_fma_f32 v[102:103], v[102:103], v[136:137], v[136:137] op_sel:[0,1,0] op_sel_hi:[1,1,0] neg_lo:[0,0,1] neg_hi:[0,0,1]
    v_pk_fma_f32 v[104:105], v[104:105], v[136:137], v[136:137] op_sel:[0,1,0] op_sel_hi:[1,1,0] neg_lo:[0,0,1] neg_hi:[0,0,1]
    v_pk_fma_f32 v[106:107], v[106:107], v[136:137], v[136:137] op_sel:[0,1,0] op_sel_hi:[1,1,0] neg_lo:[0,0,1] neg_hi:[0,0,1]
    v_pk_fma_f32 v[108:109], v[108:109], v[136:137], v[136:137] op_sel:[0,1,0] op_sel_hi:[1,1,0] neg_lo:[0,0,1] neg_hi:[0,0,1]
    v_pk_fma_f32 v[110:111], v[110:111], v[136:137], v[136:137] op_sel:[0,1,0] op_sel_hi:[1,1,0] neg_lo:[0,0,1] neg_hi:[0,0,1]
    v_pk_fma_f32 v[112:113], v[112:113], v[136:137], v[136:137] op_sel:[0,1,0] op_sel_hi:[1,1,0] neg_lo:[0,0,1] neg_hi:[0,0,1]
    v_pk_fma_f32 v[114:115], v[114:115], v[136:137], v[136:137] op_sel:[0,1,0] op_sel_hi:[1,1,0] neg_lo:[0,0,1] neg_hi:[0,0,1]
    v_pk_fma_f32 v[116:117], v[116:117], v[136:137], v[136:137] op_sel:[0,1,0] op_sel_hi:[1,1,0] neg_lo:[0,0,1] neg_hi:[0,0,1]
    v_pk_fma_f32 v[118:119], v[118:119], v[136:137], v[136:137] op_sel:[0,1,0] op_sel_hi:[1,1,0] neg_lo:[0,0,1] neg_hi:[0,0,1]
    v_pk_fma_f32 v[120:121], v[120:121], v[136:137], v[136:137] op_sel:[0,1,0] op_sel_hi:[1,1,0] neg_lo:[0,0,1] neg_hi:[0,0,1]
    v_pk_fma_f32 v[122:123], v[122:123], v[136:137], v[136:137] op_sel:[0,1,0] op_sel_hi:[1,1,0] neg_lo:[0,0,1] neg_hi:[0,0,1]
    v_pk_fma_f32 v[124:125], v[124:125], v[136:137], v[136:137] op_sel:[0,1,0] op_sel_hi:[1,1,0] neg_lo:[0,0,1] neg_hi:[0,0,1]
    v_pk_fma_f32 v[126:127], v[126:127], v[136:137], v[136:137] op_sel:[0,1,0] op_sel_hi:[1,1,0] neg_lo:[0,0,1] neg_hi:[0,0,1]
    v_cvt_pk_bf16_f32 v80, v96, v97
    v_cvt_pk_bf16_f32 v81, v98, v99
    v_cvt_pk_bf16_f32 v82, v100, v101
    v_cvt_pk_bf16_f32 v83, v102, v103
    ds_write_b128 v144, v[80:83] offset:0
    v_cvt_pk_bf16_f32 v84, v104, v105
    v_cvt_pk_bf16_f32 v85, v106, v107
    v_cvt_pk_bf16_f32 v86, v108, v109
    v_cvt_pk_bf16_f32 v87, v110, v111
    ds_write_b128 v144, v[84:87] offset:1024
    v_cvt_pk_bf16_f32 v88, v112, v113
    v_cvt_pk_bf16_f32 v89, v114, v115
    v_cvt_pk_bf16_f32 v90, v116, v117
    v_cvt_pk_bf16_f32 v91, v118, v119
    ds_write_b128 v144, v[88:91] offset:2048
    v_cvt_pk_bf16_f32 v92, v120, v121
    v_cvt_pk_bf16_f32 v93, v122, v123
    v_cvt_pk_bf16_f32 v94, v124, v125
    v_cvt_pk_bf16_f32 v95, v126, v127
    ds_write_b128 v144, v[92:95] offset:3072
    s_waitcnt lgkmcnt(0)
    ds_read_b128 v[96:99], v145 offset:0
    ds_read_b128 v[100:103], v145 offset:1024
    ds_read_b128 v[104:107], v145 offset:2048
    ds_read_b128 v[108:111], v145 offset:3072
    s_waitcnt lgkmcnt(3)
    buffer_store_dwordx4 v[96:99], v131, s[40:43], 0 offen sc1
    s_waitcnt lgkmcnt(2)
    buffer_store_dwordx4 v[100:103], v131, s[40:43], s91 offen sc1
    s_waitcnt lgkmcnt(1)
    buffer_store_dwordx4 v[104:107], v131, s[40:43], s92 offen sc1
    s_waitcnt lgkmcnt(0)
    buffer_store_dwordx4 v[108:111], v131, s[40:43], s93 offen sc1
    v_mul_f32 v139, v139, v137
    v_mul_f32 v139, v139, v137
    v_cvt_pk_bf16_f32 v139, v139, v139
    v_lshlrev_b32 v139, 16, v139
    v_add_f32 v139, 0x3727c5ac, v139
    v_cvt_pk_bf16_f32 v139, v139, v139
    v_lshlrev_b32 v139, 16, v139
    v_sqrt_f32 v139, v139
    s_nop 0
    v_cvt_pk_bf16_f32 v139, v139, v139
    v_lshlrev_b32 v139, 16, v139
    v_rcp_f32 v139, v139
    s_mov_b32 exec_lo, 0x01010101
    s_mov_b32 exec_hi, 0x01010101
    buffer_store_dword v139, v132, s[40:43], s23 offen sc1
    s_mov_b64 exec, -1
    s_mov_b32 s44, s36
    s_mov_b32 s45, s37
    s_mov_b32 s46, 0x400000
    s_mov_b32 s47, 0x20000
    s_waitcnt vmcnt(5)
    v_lshlrev_b32 v52, 16, v52
    v_lshlrev_b32 v54, 16, v54
    v_lshlrev_b32 v56, 16, v56
    v_mul_f32 v56, 0x3fb8aa3b, v56
    v_exp_f32 v56, v56
    s_nop 0
    v_cvt_pk_bf16_f32 v56, v56, v56
    v_lshlrev_b32 v56, 16, v56
    v_mul_f32 v60, v56, v52
    v_mul_f32 v61, v56, v54
    v_mul_f32 v60, 0x3fb8aa3b, v60
    v_mul_f32 v61, 0.15915494, v61
    v_exp_f32 v60, v60
    v_fract_f32 v61, v61
    v_cos_f32 v62, v61
    v_sin_f32 v63, v61
    s_nop 0
    v_mul_f32 v14, v60, v62
    v_mul_f32 v15, v60, v63
    v_sub_f32 v16, 0, v15
    v_add_f32 v60, -1.0, v14
    v_mul_f32 v61, v52, v52
    v_fmac_f32 v61, v54, v54
    v_rcp_f32 v61, v61
    v_mul_f32 v62, v60, v52
    v_fmac_f32 v62, v15, v54
    v_mul_f32 v63, v15, v52
    v_fma_f32 v63, -v60, v54, v63
    v_add_f32 v61, v61, v61
    v_mul_f32 v20, v62, v61
    v_mul_f32 v21, v63, v61
    v_lshlrev_b32 v53, 16, v53
    v_lshlrev_b32 v55, 16, v55
    v_lshlrev_b32 v57, 16, v57
    v_mul_f32 v57, 0x3fb8aa3b, v57
    v_exp_f32 v57, v57
    s_nop 0
    v_cvt_pk_bf16_f32 v57, v57, v57
    v_lshlrev_b32 v57, 16, v57
    v_mul_f32 v60, v57, v53
    v_mul_f32 v61, v57, v55
    v_mul_f32 v60, 0x3fb8aa3b, v60
    v_mul_f32 v61, 0.15915494, v61
    v_exp_f32 v60, v60
    v_fract_f32 v61, v61
    v_cos_f32 v62, v61
    v_sin_f32 v63, v61
    s_nop 0
    v_mul_f32 v17, v60, v62
    v_mul_f32 v18, v60, v63
    v_sub_f32 v19, 0, v18
    v_add_f32 v60, -1.0, v17
    v_mul_f32 v61, v53, v53
    v_fmac_f32 v61, v55, v55
    v_rcp_f32 v61, v61
    v_mul_f32 v62, v60, v53
    v_fmac_f32 v62, v18, v55
    v_mul_f32 v63, v18, v53
    v_fma_f32 v63, -v60, v55, v63
    v_add_f32 v61, v61, v61
    v_mul_f32 v22, v62, v61
    v_mul_f32 v23, v63, v61
    v_and_b32 v43, 1, v41
    v_cmp_eq_u32 vcc, 1, v43
    v_lshlrev_b32 v58, 16, v58
    v_lshlrev_b32 v43, 2, v0
    v_cndmask_b32 v24, v14, v17, vcc
    v_cndmask_b32 v25, v15, v18, vcc
    ds_write_b32 v43, v58 offset:0
    v_mul_f32 v60, v25, v25
    v_mul_f32 v25, v24, v25
    v_fma_f32 v24, v24, v24, -v60
    v_add_f32 v25, v25, v25
    v_mul_f32 v60, v25, v25
    v_mul_f32 v25, v24, v25
    v_fma_f32 v24, v24, v24, -v60
    v_add_f32 v25, v25, v25
    v_mul_f32 v60, v25, v25
    v_mul_f32 v25, v24, v25
    v_fma_f32 v24, v24, v24, -v60
    v_add_f32 v25, v25, v25
    v_mul_f32 v60, v25, v25
    v_mul_f32 v25, v24, v25
    v_fma_f32 v24, v24, v24, -v60
    v_add_f32 v25, v25, v25
    v_mov_b32 v28, v24
    v_mov_b32 v29, v25
    v_sub_f32 v26, 0, v25
    v_mul_f32 v60, v29, v29
    v_mul_f32 v29, v28, v29
    v_fma_f32 v28, v28, v28, -v60
    v_add_f32 v29, v29, v29
    v_mul_f32 v60, v29, v29
    v_mul_f32 v29, v28, v29
    v_fma_f32 v28, v28, v28, -v60
    v_add_f32 v29, v29, v29
    v_mul_f32 v60, v29, v29
    v_mul_f32 v29, v28, v29
    v_fma_f32 v28, v28, v28, -v60
    v_add_f32 v29, v29, v29
    v_mul_f32 v60, v29, v29
    v_mul_f32 v29, v28, v29
    v_fma_f32 v28, v28, v28, -v60
    v_add_f32 v29, v29, v29
    v_sub_f32 v27, 0, v29
    v_readfirstlane_b32 s22, v147
    s_cmp_eq_u32 s38, 1
    s_cselect_b32 s64, s16, s14
    s_cselect_b32 s65, s17, s15
    s_cmp_lt_u32 s38, 2
    s_cselect_b32 s66, 0x200000, 0
    s_mov_b32 s67, 0x20000
    s_lshl_b32 s94, s2, 13
    v_lshl_add_u32 v30, v1, 7, s94
    s_lshl_b32 s94, s2, 2
    s_add_u32 s94, s94, s38
    s_mul_i32 s94, s94, 7168
    v_lshl_add_u32 v31, v1, 7, s94
    v_cmp_gt_u32 vcc, 56, v1
    v_mov_b32 v43, 1073741824
    s_lshr_b32 s94, s2, 3
    v_cndmask_b32 v31, v43, v31, vcc
    s_mul_i32 s95, s94, 43
    s_lshr_b32 s95, s95, 7
    s_mul_i32 s95, s95, 3
    s_sub_u32 s94, s94, s95
    s_sub_u32 s89, 4, s94
    s_lshl_b32 s94, s79, 13
    s_add_u32 s94, s94, 27262976
    s_add_u32 s60, s36, s94
    s_addc_u32 s61, s37, 0
    s_lshl_b32 s62, s76, 13
    s_mov_b32 s63, 0x20000
    s_mov_b32 s13, 0
    v_lshlrev_b32 v55, 4, v1
    v_mov_b64 v[56:57], -1
    v_mov_b64 v[58:59], -1
    s_getpc_b64 s[8:9]
L_pc_2:
    s_sub_u32 s8, s8, L_pc_2-recurrent_scan__ssm_conv_s5__mixer_channel_mlp__prompt_kernel
    s_subb_u32 s9, s9, 0
    s_mov_b32 s10, L_code_end-recurrent_scan__ssm_conv_s5__mixer_channel_mlp__prompt_kernel
    s_mov_b32 s11, 0x20000
    s_lshr_b32 s93, s2, 3
    s_mul_i32 s93, s93, ((L_code_end-L_pfc_b+4095)/4096)
    v_add_u32 v51, s93, v1
    v_lshlrev_b32 v51, 7, v51
    v_add_u32 v51, L_pfc_b-recurrent_scan__ssm_conv_s5__mixer_channel_mlp__prompt_kernel, v51
    s_cmp_eq_u32 s38, 2
    s_cselect_b32 s93, ((L_code_end-L_pfc_b+4095)/4096), 0
    v_cmp_gt_u32 vcc, s93, v1
    v_mov_b32 v43, 1073741824
    s_nop 0
    v_cndmask_b32 v51, v43, v51, vcc
    s_mov_b32 s68, s28
    s_mov_b32 s69, s29
    s_mov_b32 s70, 0x700000
    s_mov_b32 s71, 0x20000
    v_mov_b32 v80, 0
    v_mov_b32 v81, 0
    v_mov_b32 v82, 0
    v_mov_b32 v83, 0
    v_mov_b32 v84, 0
    v_mov_b32 v85, 0
    v_mov_b32 v86, 0
    v_mov_b32 v87, 0
    v_mov_b32 v88, 0
    v_mov_b32 v89, 0
    v_mov_b32 v90, 0
    v_mov_b32 v91, 0
    v_mov_b32 v92, 0
    v_mov_b32 v93, 0
    v_mov_b32 v94, 0
    v_mov_b32 v95, 0
    v_mov_b32 v112, 0
    v_mov_b32 v113, 0
    v_mov_b32 v114, 0
    v_mov_b32 v115, 0
    v_mov_b32 v116, 0
    v_mov_b32 v117, 0
    v_mov_b32 v118, 0
    v_mov_b32 v119, 0
    v_mov_b32 v120, 0
    v_mov_b32 v121, 0
    v_mov_b32 v122, 0
    v_mov_b32 v123, 0
    v_mov_b32 v124, 0
    v_mov_b32 v125, 0
    v_mov_b32 v126, 0
    v_mov_b32 v127, 0
    v_mov_b32 v128, 0
    v_mov_b32 v129, 0
    v_mov_b32 v130, 0
    v_mov_b32 v131, 0
    v_mov_b32 v132, 0
    v_mov_b32 v133, 0
    v_mov_b32 v134, 0
    v_mov_b32 v135, 0
    v_mov_b32 v136, 0
    v_mov_b32 v137, 0
    v_mov_b32 v138, 0
    v_mov_b32 v140, 0
    v_mov_b32 v141, 0
    v_mov_b32 v142, 0
    v_mov_b32 v143, 0
    v_mov_b32 v144, 0
    v_mov_b32 v145, 0
    v_mov_b32 v146, 0
    v_mov_b32 v147, 0
    v_mov_b32 v148, 0
    v_mov_b32 v149, 0
    v_mov_b32 v150, 0
    v_mov_b32 v151, 0
    v_mov_b32 v152, 0
    v_mov_b32 v153, 0
    v_mov_b32 v154, 0
    v_mov_b32 v155, 0
    v_mov_b32 v156, 0
    v_mov_b32 v157, 0
    v_mov_b32 v158, 0
    v_mov_b32 v159, 0
    v_mov_b32 v160, 0
    v_mov_b32 v161, 0
    v_mov_b32 v162, 0
    v_mov_b32 v163, 0
    v_mov_b32 v164, 0
    v_mov_b32 v165, 0
    v_mov_b32 v166, 0
    v_mov_b32 v167, 0
    v_mov_b32 v168, 0
    v_mov_b32 v169, 0
    v_mov_b32 v170, 0
    v_mov_b32 v171, 0
    v_mov_b32 v172, 0
    v_mov_b32 v173, 0
    v_mov_b32 v174, 0
    v_mov_b32 v175, 0
    v_mov_b32 v176, 0
    v_mov_b32 v177, 0
    v_mov_b32 v178, 0
    v_mov_b32 v179, 0
    v_mov_b32 v180, 0
    v_mov_b32 v181, 0
    v_mov_b32 v182, 0
    v_mov_b32 v183, 0
    v_mov_b32 v184, 0
    v_mov_b32 v185, 0
    v_mov_b32 v186, 0
    v_mov_b32 v187, 0
    v_mov_b32 v188, 0
    v_mov_b32 v189, 0
    v_mov_b32 v190, 0
    v_mov_b32 v191, 0
    v_mov_b32 v192, 0
    v_mov_b32 v193, 0
    v_mov_b32 v194, 0
    v_mov_b32 v195, 0
    v_mov_b32 v196, 0
    v_mov_b32 v197, 0
    v_mov_b32 v198, 0
    v_mov_b32 v199, 0
    v_mov_b32 v200, 0
    v_mov_b32 v201, 0
    v_mov_b32 v202, 0
    v_mov_b32 v203, 0
    v_mov_b32 v204, 0
    v_mov_b32 v205, 0
    v_mov_b32 v206, 0
    v_mov_b32 v207, 0
    v_mov_b32 v208, 0
    v_mov_b32 v209, 0
    v_mov_b32 v210, 0
    v_mov_b32 v211, 0
    v_mov_b32 v212, 0
    v_mov_b32 v213, 0
    v_mov_b32 v214, 0
    v_mov_b32 v215, 0
    v_mov_b32 v216, 0
    v_mov_b32 v217, 0
    v_mov_b32 v218, 0
    v_mov_b32 v219, 0
    v_mov_b32 v220, 0
    v_mov_b32 v221, 0
    v_mov_b32 v222, 0
    v_mov_b32 v223, 0
    v_mov_b32 v224, 0
    v_mov_b32 v225, 0
    v_mov_b32 v226, 0
    v_mov_b32 v227, 0
    v_mov_b32 v228, 0
    v_mov_b32 v229, 0
    v_mov_b32 v230, 0
    v_mov_b32 v231, 0
    v_mov_b32 v232, 0
    v_mov_b32 v233, 0
    v_mov_b32 v234, 0
    v_mov_b32 v235, 0
    v_mov_b32 v236, 0
    v_mov_b32 v237, 0
    v_mov_b32 v238, 0
    v_mov_b32 v239, 0
    v_mov_b32 v240, 0
    v_mov_b32 v241, 0
    v_mov_b32 v242, 0
    v_mov_b32 v243, 0
    v_mov_b32 v244, 0
    v_mov_b32 v245, 0
    v_mov_b32 v246, 0
    v_mov_b32 v247, 0
    v_mov_b32 v248, 0
    v_mov_b32 v249, 0
    v_mov_b32 v250, 0
    v_mov_b32 v251, 0
    v_mov_b32 v252, 0
    v_mov_b32 v253, 0
    v_mov_b32 v254, 0
    v_mov_b32 v255, 0
    s_waitcnt vmcnt(0)
    v_mov_b32 v96, 0
    v_mov_b32 v97, 0
    v_mov_b32 v98, 0
    v_mov_b32 v99, 0
    v_mov_b32 v100, 0
    v_mov_b32 v101, 0
    v_mov_b32 v102, 0
    v_mov_b32 v103, 0
    v_mov_b32 v104, 0
    v_mov_b32 v105, 0
    v_mov_b32 v106, 0
    v_mov_b32 v107, 0
    v_mov_b32 v108, 0
    v_mov_b32 v109, 0
    v_mov_b32 v110, 0
    v_mov_b32 v111, 0
    v_mov_b32 v139, 0
    s_cmp_lg_u32 s38, 0
    s_cbranch_scc1 L_hsok
    s_mov_b32 s92, 1048576
    v_mov_b32 v46, 0
    s_mov_b32 s93, s22
L_hs:
    s_sub_u32 s92, s92, 1
    s_cselect_b32 s93, 1, s93
    s_cmp_lg_u32 s93, 0
    s_cbranch_scc1 L_hsok
    global_load_dword v47, v46, s[34:35] sc1
    s_waitcnt vmcnt(0)
    v_readfirstlane_b32 s93, v47
    s_branch L_hs
L_hsok:
    s_barrier
    s_cmp_lg_u32 s38, 0
    s_cbranch_scc1 L_noarrA
    s_lshr_b32 s92, s73, 3
    s_lshl_b32 s93, s72, 2
    s_add_u32 s92, s92, s93
    s_lshl_b32 s91, s92, 7
    s_add_u32 s91, s91, 40042496
    v_mov_b32 v44, 0
    v_mov_b32 v45, 1
    s_mov_b64 exec, 1
    buffer_atomic_add v45, v44, s[40:43], s91 offen sc1
    s_mov_b64 exec, -1
L_noarrA:
    s_lshl_b32 s91, s74, 7
    s_add_u32 s91, s91, 40042496
    s_add_u32 m0, s83, 23552
    s_nop 0
    buffer_load_dwordx4 v3, s[48:51], s81 offen lds
    s_add_u32 m0, s83, 27648
    s_nop 0
    buffer_load_dwordx4 v3, s[52:55], s81 offen lds
    s_add_u32 m0, s84, 23552
    s_add_u32 s81, s81, 128
    buffer_load_dwordx4 v4, s[56:59], s82 offen lds
    s_add_u32 m0, s84, 24576
    s_nop 0
    buffer_load_dwordx4 v5, s[56:59], s82 offen lds
    s_add_u32 m0, s84, 25600
    s_nop 0
    buffer_load_dwordx4 v6, s[56:59], s82 offen lds
    s_add_u32 m0, s85, 23552
    s_nop 0
    s_mov_b64 exec, s[86:87]
    buffer_load_dwordx4 v7, s[56:59], s82 offen lds
    s_mov_b64 exec, -1
    s_add_u32 s82, s82, 458752
    s_mov_b32 s92, 1048576
    v_mov_b32 v44, 0
    s_mov_b64 exec, 1
L_pollA:
    buffer_load_dword v45, v44, s[40:43], s91 offen sc1
    s_waitcnt vmcnt(0)
    v_readfirstlane_b32 s93, v45
    s_sub_u32 s92, s92, 1
    s_cselect_b32 s93, 8, s93
    s_cmp_ge_u32 s93, 8
    s_cbranch_scc1 L_pollA_ok
    s_branch L_pollA
L_pollA_ok:
    s_mov_b64 exec, -1
    s_barrier
    s_cmp_eq_u32 s38, 0
    s_movk_i32 s23, 512
    s_cselect_b32 s23, 1835008, s23
    s_mov_b32 s22, s23
    buffer_load_dwordx4 a[0:3], v2, s[44:47], s80 offen offset:0 sc1
    buffer_load_dwordx4 a[4:7], v2, s[44:47], s80 offen offset:1024 sc1
    buffer_load_dwordx4 a[8:11], v2, s[44:47], s80 offen offset:2048 sc1
    buffer_load_dwordx4 a[12:15], v2, s[44:47], s80 offen offset:3072 sc1
    s_add_u32 s80, s80, 131072
    s_mov_b32 s91, 39845888
    buffer_load_dwordx4 v[32:35], v50, s[40:43], s91 offen sc1
    buffer_load_dwordx4 a[16:19], v2, s[44:47], s80 offen offset:0 sc1
    buffer_load_dwordx4 a[20:23], v2, s[44:47], s80 offen offset:1024 sc1
    buffer_load_dwordx4 a[24:27], v2, s[44:47], s80 offen offset:2048 sc1
    buffer_load_dwordx4 a[28:31], v2, s[44:47], s80 offen offset:3072 sc1
    s_add_u32 s80, s80, 131072
    s_add_u32 m0, s83, 46080
    s_nop 0
    buffer_load_dwordx4 v3, s[48:51], s81 offen lds
    s_add_u32 m0, s83, 50176
    s_nop 0
    buffer_load_dwordx4 v3, s[52:55], s81 offen lds
    s_add_u32 m0, s84, 46080
    s_add_u32 s81, s81, 128
    buffer_load_dwordx4 v4, s[56:59], s82 offen lds
    buffer_load_dwordx4 a[32:35], v2, s[44:47], s80 offen offset:0 sc1
    buffer_load_dwordx4 a[36:39], v2, s[44:47], s80 offen offset:1024 sc1
    buffer_load_dwordx4 a[40:43], v2, s[44:47], s80 offen offset:2048 sc1
    buffer_load_dwordx4 a[44:47], v2, s[44:47], s80 offen offset:3072 sc1
    s_add_u32 s80, s80, 131072
    ds_read_b128 a[64:67], v8 offset:0
    ds_read_b128 a[68:71], v8 offset:2048
    ds_read_b128 a[72:75], v8 offset:4096
    ds_read_b128 a[76:79], v8 offset:6144
    ds_read_b64_tr_b16 a[80:81], v12 offset:0
    ds_read_b64_tr_b16 a[82:83], v12 offset:1792
    ds_read_b64_tr_b16 a[84:85], v12 offset:32
    ds_read_b64_tr_b16 a[86:87], v12 offset:1824
    ds_read_b64_tr_b16 a[88:89], v12 offset:64
    ds_read_b64_tr_b16 a[90:91], v12 offset:1856
    ds_read_b64_tr_b16 a[92:93], v12 offset:96
    ds_read_b64_tr_b16 a[94:95], v12 offset:1888
    ds_read_b64_tr_b16 a[96:97], v12 offset:128
    ds_read_b64_tr_b16 a[98:99], v12 offset:1920
    ds_read_b64_tr_b16 a[100:101], v12 offset:160
    ds_read_b64_tr_b16 a[102:103], v12 offset:1952
    ds_read_b64_tr_b16 a[104:105], v12 offset:192
    ds_read_b64_tr_b16 a[106:107], v12 offset:1984
    s_mov_b32 s88, 4
L_bloop:
    s_waitcnt vmcnt(12) lgkmcnt(0)
    v_mfma_f32_16x16x32_bf16 v[80:83], a[0:3], a[64:67], v[80:83]
    ds_read_b128 a[108:111], v9 offset:0
    v_mfma_f32_16x16x32_bf16 v[84:87], a[4:7], a[64:67], v[84:87]
    ds_read_b128 a[112:115], v9 offset:2048
    v_mfma_f32_16x16x32_bf16 v[88:91], a[8:11], a[64:67], v[88:91]
    buffer_load_dwordx4 a[48:51], v2, s[44:47], s80 offen offset:0 sc1
    v_mfma_f32_16x16x32_bf16 v[92:95], a[12:15], a[64:67], v[92:95]
    ds_read_b128 a[116:119], v9 offset:4096
    v_mfma_f32_16x16x32_bf16 v[108:111], a[12:15], a[68:71], v[108:111]
    ds_read_b128 a[120:123], v9 offset:6144
    v_mfma_f32_16x16x32_bf16 v[104:107], a[8:11], a[68:71], v[104:107]
    s_add_u32 m0, s84, 47104
    v_mfma_f32_16x16x32_bf16 v[100:103], a[4:7], a[68:71], v[100:103]
    ds_read_b64_tr_b16 a[124:125], v12 offset:7168
    v_mfma_f32_16x16x32_bf16 v[96:99], a[0:3], a[68:71], v[96:99]
    ds_read_b64_tr_b16 a[126:127], v12 offset:8960
    v_mfma_f32_16x16x32_bf16 v[112:115], a[0:3], a[72:75], v[112:115]
    buffer_load_dwordx4 v5, s[56:59], s82 offen lds
    v_mfma_f32_16x16x32_bf16 v[116:119], a[4:7], a[72:75], v[116:119]
    ds_read_b64_tr_b16 a[128:129], v12 offset:7200
    v_mfma_f32_16x16x32_bf16 v[120:123], a[8:11], a[72:75], v[120:123]
    ds_read_b64_tr_b16 a[130:131], v12 offset:8992
    v_mfma_f32_16x16x32_bf16 v[124:127], a[12:15], a[72:75], v[124:127]
    buffer_load_dwordx4 a[52:55], v2, s[44:47], s80 offen offset:1024 sc1
    v_mfma_f32_16x16x32_bf16 v[140:143], a[12:15], a[76:79], v[140:143]
    ds_read_b64_tr_b16 a[132:133], v12 offset:7232
    v_mfma_f32_16x16x32_bf16 v[136:139], a[8:11], a[76:79], v[136:139]
    ds_read_b64_tr_b16 a[134:135], v12 offset:9024
    v_mfma_f32_16x16x32_bf16 v[132:135], a[4:7], a[76:79], v[132:135]
    s_add_u32 m0, s84, 48128
    v_mfma_f32_16x16x32_bf16 v[128:131], a[0:3], a[76:79], v[128:131]
    ds_read_b64_tr_b16 a[136:137], v12 offset:7264
    v_mfma_f32_16x16x32_bf16 v[144:147], a[80:83], a[0:3], v[144:147]
    ds_read_b64_tr_b16 a[138:139], v12 offset:9056
    v_mfma_f32_16x16x32_bf16 v[148:151], a[80:83], a[4:7], v[148:151]
    buffer_load_dwordx4 v6, s[56:59], s82 offen lds
    v_mfma_f32_16x16x32_bf16 v[152:155], a[80:83], a[8:11], v[152:155]
    ds_read_b64_tr_b16 a[140:141], v12 offset:7296
    v_mfma_f32_16x16x32_bf16 v[156:159], a[80:83], a[12:15], v[156:159]
    ds_read_b64_tr_b16 a[142:143], v12 offset:9088
    v_mfma_f32_16x16x32_bf16 v[172:175], a[84:87], a[12:15], v[172:175]
    buffer_load_dwordx4 a[56:59], v2, s[44:47], s80 offen offset:2048 sc1
    v_mfma_f32_16x16x32_bf16 v[168:171], a[84:87], a[8:11], v[168:171]
    ds_read_b64_tr_b16 a[144:145], v12 offset:7328
    v_mfma_f32_16x16x32_bf16 v[164:167], a[84:87], a[4:7], v[164:167]
    ds_read_b64_tr_b16 a[146:147], v12 offset:9120
    v_mfma_f32_16x16x32_bf16 v[160:163], a[84:87], a[0:3], v[160:163]
    s_add_u32 m0, s85, 46080
    v_mfma_f32_16x16x32_bf16 v[176:179], a[88:91], a[0:3], v[176:179]
    ds_read_b64_tr_b16 a[148:149], v12 offset:7360
    v_mfma_f32_16x16x32_bf16 v[180:183], a[88:91], a[4:7], v[180:183]
    ds_read_b64_tr_b16 a[150:151], v12 offset:9152
    v_mfma_f32_16x16x32_bf16 v[184:187], a[88:91], a[8:11], v[184:187]
    s_mov_b64 exec, s[86:87]
    buffer_load_dwordx4 v7, s[56:59], s82 offen lds
    s_mov_b64 exec, -1
    s_add_u32 s82, s82, 458752
    v_mfma_f32_16x16x32_bf16 v[188:191], a[88:91], a[12:15], v[188:191]
    v_mfma_f32_16x16x32_bf16 v[204:207], a[92:95], a[12:15], v[204:207]
    buffer_load_dwordx4 a[60:63], v2, s[44:47], s80 offen offset:3072 sc1
    s_add_u32 s80, s80, 131072
    v_mfma_f32_16x16x32_bf16 v[200:203], a[92:95], a[8:11], v[200:203]
    v_mfma_f32_16x16x32_bf16 v[196:199], a[92:95], a[4:7], v[196:199]
    v_mfma_f32_16x16x32_bf16 v[192:195], a[92:95], a[0:3], v[192:195]
    v_mfma_f32_16x16x32_bf16 v[208:211], a[96:99], a[0:3], v[208:211]
    v_mfma_f32_16x16x32_bf16 v[212:215], a[96:99], a[4:7], v[212:215]
    v_mfma_f32_16x16x32_bf16 v[216:219], a[96:99], a[8:11], v[216:219]
    v_mfma_f32_16x16x32_bf16 v[220:223], a[96:99], a[12:15], v[220:223]
    v_mfma_f32_16x16x32_bf16 v[236:239], a[100:103], a[12:15], v[236:239]
    v_mfma_f32_16x16x32_bf16 v[232:235], a[100:103], a[8:11], v[232:235]
    v_mfma_f32_16x16x32_bf16 v[228:231], a[100:103], a[4:7], v[228:231]
    v_mfma_f32_16x16x32_bf16 v[224:227], a[100:103], a[0:3], v[224:227]
    v_mfma_f32_16x16x32_bf16 v[240:243], a[104:107], a[0:3], v[240:243]
    v_mfma_f32_16x16x32_bf16 v[244:247], a[104:107], a[4:7], v[244:247]
    v_mfma_f32_16x16x32_bf16 v[248:251], a[104:107], a[8:11], v[248:251]
    v_mfma_f32_16x16x32_bf16 v[252:255], a[104:107], a[12:15], v[252:255]
    s_waitcnt vmcnt(16)
    s_barrier
    s_waitcnt vmcnt(14) lgkmcnt(0)
    v_mfma_f32_16x16x32_bf16 v[80:83], a[16:19], a[108:111], v[80:83]
    ds_read_b128 a[64:67], v8 offset:22528
    v_mfma_f32_16x16x32_bf16 v[84:87], a[20:23], a[108:111], v[84:87]
    ds_read_b128 a[68:71], v8 offset:24576
    v_mfma_f32_16x16x32_bf16 v[88:91], a[24:27], a[108:111], v[88:91]
    buffer_load_dwordx4 a[0:3], v2, s[44:47], s80 offen offset:0 sc1
    v_mfma_f32_16x16x32_bf16 v[92:95], a[28:31], a[108:111], v[92:95]
    ds_read_b128 a[72:75], v8 offset:26624
    v_mfma_f32_16x16x32_bf16 v[108:111], a[28:31], a[112:115], v[108:111]
    ds_read_b128 a[76:79], v8 offset:28672
    v_mfma_f32_16x16x32_bf16 v[104:107], a[24:27], a[112:115], v[104:107]
    s_add_u32 m0, s83, 68608
    v_mfma_f32_16x16x32_bf16 v[100:103], a[20:23], a[112:115], v[100:103]
    ds_read_b64_tr_b16 a[80:81], v12 offset:22528
    v_mfma_f32_16x16x32_bf16 v[96:99], a[16:19], a[112:115], v[96:99]
    ds_read_b64_tr_b16 a[82:83], v12 offset:24320
    v_mfma_f32_16x16x32_bf16 v[112:115], a[16:19], a[116:119], v[112:115]
    buffer_load_dwordx4 v3, s[48:51], s81 offen lds
    v_mfma_f32_16x16x32_bf16 v[116:119], a[20:23], a[116:119], v[116:119]
    ds_read_b64_tr_b16 a[84:85], v12 offset:22560
    v_mfma_f32_16x16x32_bf16 v[120:123], a[24:27], a[116:119], v[120:123]
    ds_read_b64_tr_b16 a[86:87], v12 offset:24352
    v_mfma_f32_16x16x32_bf16 v[124:127], a[28:31], a[116:119], v[124:127]
    buffer_load_dwordx4 a[4:7], v2, s[44:47], s80 offen offset:1024 sc1
    v_mfma_f32_16x16x32_bf16 v[140:143], a[28:31], a[120:123], v[140:143]
    ds_read_b64_tr_b16 a[88:89], v12 offset:22592
    v_mfma_f32_16x16x32_bf16 v[136:139], a[24:27], a[120:123], v[136:139]
    ds_read_b64_tr_b16 a[90:91], v12 offset:24384
    v_mfma_f32_16x16x32_bf16 v[132:135], a[20:23], a[120:123], v[132:135]
    s_add_u32 m0, s83, 72704
    v_mfma_f32_16x16x32_bf16 v[128:131], a[16:19], a[120:123], v[128:131]
    ds_read_b64_tr_b16 a[92:93], v12 offset:22624
    v_mfma_f32_16x16x32_bf16 v[144:147], a[124:127], a[16:19], v[144:147]
    ds_read_b64_tr_b16 a[94:95], v12 offset:24416
    v_mfma_f32_16x16x32_bf16 v[148:151], a[124:127], a[20:23], v[148:151]
    buffer_load_dwordx4 v3, s[52:55], s81 offen lds
    v_mfma_f32_16x16x32_bf16 v[152:155], a[124:127], a[24:27], v[152:155]
    ds_read_b64_tr_b16 a[96:97], v12 offset:22656
    v_mfma_f32_16x16x32_bf16 v[156:159], a[124:127], a[28:31], v[156:159]
    ds_read_b64_tr_b16 a[98:99], v12 offset:24448
    v_mfma_f32_16x16x32_bf16 v[172:175], a[128:131], a[28:31], v[172:175]
    buffer_load_dwordx4 a[8:11], v2, s[44:47], s80 offen offset:2048 sc1
    v_mfma_f32_16x16x32_bf16 v[168:171], a[128:131], a[24:27], v[168:171]
    ds_read_b64_tr_b16 a[100:101], v12 offset:22688
    v_mfma_f32_16x16x32_bf16 v[164:167], a[128:131], a[20:23], v[164:167]
    ds_read_b64_tr_b16 a[102:103], v12 offset:24480
    v_mfma_f32_16x16x32_bf16 v[160:163], a[128:131], a[16:19], v[160:163]
    s_add_u32 m0, s84, 68608
    s_add_u32 s81, s81, 128
    v_mfma_f32_16x16x32_bf16 v[176:179], a[132:135], a[16:19], v[176:179]
    ds_read_b64_tr_b16 a[104:105], v12 offset:22720
    v_mfma_f32_16x16x32_bf16 v[180:183], a[132:135], a[20:23], v[180:183]
    ds_read_b64_tr_b16 a[106:107], v12 offset:24512
    v_mfma_f32_16x16x32_bf16 v[184:187], a[132:135], a[24:27], v[184:187]
    buffer_load_dwordx4 v4, s[56:59], s82 offen lds
    v_mfma_f32_16x16x32_bf16 v[188:191], a[132:135], a[28:31], v[188:191]
    v_mfma_f32_16x16x32_bf16 v[204:207], a[136:139], a[28:31], v[204:207]
    buffer_load_dwordx4 a[12:15], v2, s[44:47], s80 offen offset:3072 sc1
    s_add_u32 s80, s80, 131072
    v_mfma_f32_16x16x32_bf16 v[200:203], a[136:139], a[24:27], v[200:203]
    v_mfma_f32_16x16x32_bf16 v[196:199], a[136:139], a[20:23], v[196:199]
    v_mfma_f32_16x16x32_bf16 v[192:195], a[136:139], a[16:19], v[192:195]
    v_mfma_f32_16x16x32_bf16 v[208:211], a[140:143], a[16:19], v[208:211]
    v_mfma_f32_16x16x32_bf16 v[212:215], a[140:143], a[20:23], v[212:215]
    v_mfma_f32_16x16x32_bf16 v[216:219], a[140:143], a[24:27], v[216:219]
    v_mfma_f32_16x16x32_bf16 v[220:223], a[140:143], a[28:31], v[220:223]
    buffer_load_dword v43, v49, s[24:27], s22 offen
    s_add_u32 s22, s22, s23
    v_mfma_f32_16x16x32_bf16 v[236:239], a[144:147], a[28:31], v[236:239]
    v_mfma_f32_16x16x32_bf16 v[232:235], a[144:147], a[24:27], v[232:235]
    v_mfma_f32_16x16x32_bf16 v[228:231], a[144:147], a[20:23], v[228:231]
    buffer_store_dwordx4 v[56:59], v55, s[60:63], s13 offen sc1
    s_add_u32 s13, s13, 1024
    v_mfma_f32_16x16x32_bf16 v[224:227], a[144:147], a[16:19], v[224:227]
    v_mfma_f32_16x16x32_bf16 v[240:243], a[148:151], a[16:19], v[240:243]
    v_mfma_f32_16x16x32_bf16 v[244:247], a[148:151], a[20:23], v[244:247]
    v_mfma_f32_16x16x32_bf16 v[248:251], a[148:151], a[24:27], v[248:251]
    v_mfma_f32_16x16x32_bf16 v[252:255], a[148:151], a[28:31], v[252:255]
    s_waitcnt vmcnt(16) lgkmcnt(0)
    v_mfma_f32_16x16x32_bf16 v[80:83], a[32:35], a[64:67], v[80:83]
    ds_read_b128 a[108:111], v9 offset:22528
    v_mfma_f32_16x16x32_bf16 v[84:87], a[36:39], a[64:67], v[84:87]
    ds_read_b128 a[112:115], v9 offset:24576
    v_mfma_f32_16x16x32_bf16 v[88:91], a[40:43], a[64:67], v[88:91]
    buffer_load_dwordx4 a[16:19], v2, s[44:47], s80 offen offset:0 sc1
    v_mfma_f32_16x16x32_bf16 v[92:95], a[44:47], a[64:67], v[92:95]
    ds_read_b128 a[116:119], v9 offset:26624
    v_mfma_f32_16x16x32_bf16 v[108:111], a[44:47], a[68:71], v[108:111]
    ds_read_b128 a[120:123], v9 offset:28672
    v_mfma_f32_16x16x32_bf16 v[104:107], a[40:43], a[68:71], v[104:107]
    s_add_u32 m0, s84, 69632
    v_mfma_f32_16x16x32_bf16 v[100:103], a[36:39], a[68:71], v[100:103]
    ds_read_b64_tr_b16 a[124:125], v12 offset:29696
    v_mfma_f32_16x16x32_bf16 v[96:99], a[32:35], a[68:71], v[96:99]
    ds_read_b64_tr_b16 a[126:127], v12 offset:31488
    v_mfma_f32_16x16x32_bf16 v[112:115], a[32:35], a[72:75], v[112:115]
    buffer_load_dwordx4 v5, s[56:59], s82 offen lds
    v_mfma_f32_16x16x32_bf16 v[116:119], a[36:39], a[72:75], v[116:119]
    ds_read_b64_tr_b16 a[128:129], v12 offset:29728
    v_mfma_f32_16x16x32_bf16 v[120:123], a[40:43], a[72:75], v[120:123]
    ds_read_b64_tr_b16 a[130:131], v12 offset:31520
    v_mfma_f32_16x16x32_bf16 v[124:127], a[44:47], a[72:75], v[124:127]
    buffer_load_dwordx4 a[20:23], v2, s[44:47], s80 offen offset:1024 sc1
    v_mfma_f32_16x16x32_bf16 v[140:143], a[44:47], a[76:79], v[140:143]
    ds_read_b64_tr_b16 a[132:133], v12 offset:29760
    v_mfma_f32_16x16x32_bf16 v[136:139], a[40:43], a[76:79], v[136:139]
    ds_read_b64_tr_b16 a[134:135], v12 offset:31552
    v_mfma_f32_16x16x32_bf16 v[132:135], a[36:39], a[76:79], v[132:135]
    s_add_u32 m0, s84, 70656
    v_mfma_f32_16x16x32_bf16 v[128:131], a[32:35], a[76:79], v[128:131]
    ds_read_b64_tr_b16 a[136:137], v12 offset:29792
    v_mfma_f32_16x16x32_bf16 v[144:147], a[80:83], a[32:35], v[144:147]
    ds_read_b64_tr_b16 a[138:139], v12 offset:31584
    v_mfma_f32_16x16x32_bf16 v[148:151], a[80:83], a[36:39], v[148:151]
    buffer_load_dwordx4 v6, s[56:59], s82 offen lds
    v_mfma_f32_16x16x32_bf16 v[152:155], a[80:83], a[40:43], v[152:155]
    ds_read_b64_tr_b16 a[140:141], v12 offset:29824
    v_mfma_f32_16x16x32_bf16 v[156:159], a[80:83], a[44:47], v[156:159]
    ds_read_b64_tr_b16 a[142:143], v12 offset:31616
    v_mfma_f32_16x16x32_bf16 v[172:175], a[84:87], a[44:47], v[172:175]
    buffer_load_dwordx4 a[24:27], v2, s[44:47], s80 offen offset:2048 sc1
    v_mfma_f32_16x16x32_bf16 v[168:171], a[84:87], a[40:43], v[168:171]
    ds_read_b64_tr_b16 a[144:145], v12 offset:29856
    v_mfma_f32_16x16x32_bf16 v[164:167], a[84:87], a[36:39], v[164:167]
    ds_read_b64_tr_b16 a[146:147], v12 offset:31648
    v_mfma_f32_16x16x32_bf16 v[160:163], a[84:87], a[32:35], v[160:163]
    s_add_u32 m0, s85, 68608
    v_mfma_f32_16x16x32_bf16 v[176:179], a[88:91], a[32:35], v[176:179]
    ds_read_b64_tr_b16 a[148:149], v12 offset:29888
    v_mfma_f32_16x16x32_bf16 v[180:183], a[88:91], a[36:39], v[180:183]
    ds_read_b64_tr_b16 a[150:151], v12 offset:31680
    v_mfma_f32_16x16x32_bf16 v[184:187], a[88:91], a[40:43], v[184:187]
    s_mov_b64 exec, s[86:87]
    buffer_load_dwordx4 v7, s[56:59], s82 offen lds
    s_mov_b64 exec, -1
    s_add_u32 s82, s82, 458752
    v_mfma_f32_16x16x32_bf16 v[188:191], a[88:91], a[44:47], v[188:191]
    v_mfma_f32_16x16x32_bf16 v[204:207], a[92:95], a[44:47], v[204:207]
    buffer_load_dwordx4 a[28:31], v2, s[44:47], s80 offen offset:3072 sc1
    s_add_u32 s80, s80, 131072
    v_mfma_f32_16x16x32_bf16 v[200:203], a[92:95], a[40:43], v[200:203]
    v_mfma_f32_16x16x32_bf16 v[196:199], a[92:95], a[36:39], v[196:199]
    v_mfma_f32_16x16x32_bf16 v[192:195], a[92:95], a[32:35], v[192:195]
    v_mfma_f32_16x16x32_bf16 v[208:211], a[96:99], a[32:35], v[208:211]
    v_mfma_f32_16x16x32_bf16 v[212:215], a[96:99], a[36:39], v[212:215]
    v_mfma_f32_16x16x32_bf16 v[216:219], a[96:99], a[40:43], v[216:219]
    v_mfma_f32_16x16x32_bf16 v[220:223], a[96:99], a[44:47], v[220:223]
    v_mfma_f32_16x16x32_bf16 v[236:239], a[100:103], a[44:47], v[236:239]
    v_mfma_f32_16x16x32_bf16 v[232:235], a[100:103], a[40:43], v[232:235]
    v_mfma_f32_16x16x32_bf16 v[228:231], a[100:103], a[36:39], v[228:231]
    v_mfma_f32_16x16x32_bf16 v[224:227], a[100:103], a[32:35], v[224:227]
    v_mfma_f32_16x16x32_bf16 v[240:243], a[104:107], a[32:35], v[240:243]
    v_mfma_f32_16x16x32_bf16 v[244:247], a[104:107], a[36:39], v[244:247]
    v_mfma_f32_16x16x32_bf16 v[248:251], a[104:107], a[40:43], v[248:251]
    v_mfma_f32_16x16x32_bf16 v[252:255], a[104:107], a[44:47], v[252:255]
    s_waitcnt vmcnt(17)
    s_barrier
    s_waitcnt vmcnt(16) lgkmcnt(0)
    v_mfma_f32_16x16x32_bf16 v[80:83], a[48:51], a[108:111], v[80:83]
    ds_read_b128 a[64:67], v10 offset:0
    v_mfma_f32_16x16x32_bf16 v[84:87], a[52:55], a[108:111], v[84:87]
    ds_read_b128 a[68:71], v10 offset:2048
    v_mfma_f32_16x16x32_bf16 v[88:91], a[56:59], a[108:111], v[88:91]
    buffer_load_dwordx4 a[32:35], v2, s[44:47], s80 offen offset:0 sc1
    v_mfma_f32_16x16x32_bf16 v[92:95], a[60:63], a[108:111], v[92:95]
    ds_read_b128 a[72:75], v10 offset:4096
    v_mfma_f32_16x16x32_bf16 v[108:111], a[60:63], a[112:115], v[108:111]
    ds_read_b128 a[76:79], v10 offset:6144
    v_mfma_f32_16x16x32_bf16 v[104:107], a[56:59], a[112:115], v[104:107]
    s_add_u32 m0, s83, 1024
    v_mfma_f32_16x16x32_bf16 v[100:103], a[52:55], a[112:115], v[100:103]
    ds_read_b64_tr_b16 a[80:81], v13 offset:0
    v_mfma_f32_16x16x32_bf16 v[96:99], a[48:51], a[112:115], v[96:99]
    ds_read_b64_tr_b16 a[82:83], v13 offset:1792
    v_mfma_f32_16x16x32_bf16 v[112:115], a[48:51], a[116:119], v[112:115]
    buffer_load_dwordx4 v3, s[48:51], s81 offen lds
    v_mfma_f32_16x16x32_bf16 v[116:119], a[52:55], a[116:119], v[116:119]
    ds_read_b64_tr_b16 a[84:85], v13 offset:32
    v_mfma_f32_16x16x32_bf16 v[120:123], a[56:59], a[116:119], v[120:123]
    ds_read_b64_tr_b16 a[86:87], v13 offset:1824
    v_mfma_f32_16x16x32_bf16 v[124:127], a[60:63], a[116:119], v[124:127]
    buffer_load_dwordx4 a[36:39], v2, s[44:47], s80 offen offset:1024 sc1
    v_mfma_f32_16x16x32_bf16 v[140:143], a[60:63], a[120:123], v[140:143]
    ds_read_b64_tr_b16 a[88:89], v13 offset:64
    v_mfma_f32_16x16x32_bf16 v[136:139], a[56:59], a[120:123], v[136:139]
    ds_read_b64_tr_b16 a[90:91], v13 offset:1856
    v_mfma_f32_16x16x32_bf16 v[132:135], a[52:55], a[120:123], v[132:135]
    s_add_u32 m0, s83, 5120
    v_mfma_f32_16x16x32_bf16 v[128:131], a[48:51], a[120:123], v[128:131]
    ds_read_b64_tr_b16 a[92:93], v13 offset:96
    v_mfma_f32_16x16x32_bf16 v[144:147], a[124:127], a[48:51], v[144:147]
    ds_read_b64_tr_b16 a[94:95], v13 offset:1888
    v_mfma_f32_16x16x32_bf16 v[148:151], a[124:127], a[52:55], v[148:151]
    buffer_load_dwordx4 v3, s[52:55], s81 offen lds
    v_mfma_f32_16x16x32_bf16 v[152:155], a[124:127], a[56:59], v[152:155]
    ds_read_b64_tr_b16 a[96:97], v13 offset:128
    v_mfma_f32_16x16x32_bf16 v[156:159], a[124:127], a[60:63], v[156:159]
    ds_read_b64_tr_b16 a[98:99], v13 offset:1920
    v_mfma_f32_16x16x32_bf16 v[172:175], a[128:131], a[60:63], v[172:175]
    buffer_load_dwordx4 a[40:43], v2, s[44:47], s80 offen offset:2048 sc1
    v_mfma_f32_16x16x32_bf16 v[168:171], a[128:131], a[56:59], v[168:171]
    ds_read_b64_tr_b16 a[100:101], v13 offset:160
    v_mfma_f32_16x16x32_bf16 v[164:167], a[128:131], a[52:55], v[164:167]
    ds_read_b64_tr_b16 a[102:103], v13 offset:1952
    v_mfma_f32_16x16x32_bf16 v[160:163], a[128:131], a[48:51], v[160:163]
    s_add_u32 m0, s84, 1024
    s_add_u32 s81, s81, 128
    v_mfma_f32_16x16x32_bf16 v[176:179], a[132:135], a[48:51], v[176:179]
    ds_read_b64_tr_b16 a[104:105], v13 offset:192
    v_mfma_f32_16x16x32_bf16 v[180:183], a[132:135], a[52:55], v[180:183]
    ds_read_b64_tr_b16 a[106:107], v13 offset:1984
    v_mfma_f32_16x16x32_bf16 v[184:187], a[132:135], a[56:59], v[184:187]
    buffer_load_dwordx4 v4, s[56:59], s82 offen lds
    v_mfma_f32_16x16x32_bf16 v[188:191], a[132:135], a[60:63], v[188:191]
    v_mfma_f32_16x16x32_bf16 v[204:207], a[136:139], a[60:63], v[204:207]
    buffer_load_dwordx4 a[44:47], v2, s[44:47], s80 offen offset:3072 sc1
    s_add_u32 s80, s80, 131072
    v_mfma_f32_16x16x32_bf16 v[200:203], a[136:139], a[56:59], v[200:203]
    v_mfma_f32_16x16x32_bf16 v[196:199], a[136:139], a[52:55], v[196:199]
    v_mfma_f32_16x16x32_bf16 v[192:195], a[136:139], a[48:51], v[192:195]
    s_cmp_eq_u32 s88, s89
    s_cselect_b32 s90, 0, 1073741824
    v_mfma_f32_16x16x32_bf16 v[208:211], a[140:143], a[48:51], v[208:211]
    v_mfma_f32_16x16x32_bf16 v[212:215], a[140:143], a[52:55], v[212:215]
    buffer_load_dword v43, v30, s[64:67], s90 offen
    v_mfma_f32_16x16x32_bf16 v[216:219], a[140:143], a[56:59], v[216:219]
    v_mfma_f32_16x16x32_bf16 v[220:223], a[140:143], a[60:63], v[220:223]
    v_mfma_f32_16x16x32_bf16 v[236:239], a[144:147], a[60:63], v[236:239]
    v_mfma_f32_16x16x32_bf16 v[232:235], a[144:147], a[56:59], v[232:235]
    v_mfma_f32_16x16x32_bf16 v[228:231], a[144:147], a[52:55], v[228:231]
    buffer_store_dwordx4 v[56:59], v55, s[60:63], s13 offen sc1
    s_add_u32 s13, s13, 1024
    v_mfma_f32_16x16x32_bf16 v[224:227], a[144:147], a[48:51], v[224:227]
    v_mfma_f32_16x16x32_bf16 v[240:243], a[148:151], a[48:51], v[240:243]
    v_mfma_f32_16x16x32_bf16 v[244:247], a[148:151], a[52:55], v[244:247]
    v_mfma_f32_16x16x32_bf16 v[248:251], a[148:151], a[56:59], v[248:251]
    v_mfma_f32_16x16x32_bf16 v[252:255], a[148:151], a[60:63], v[252:255]
    s_waitcnt vmcnt(18) lgkmcnt(0)
    v_mfma_f32_16x16x32_bf16 v[80:83], a[0:3], a[64:67], v[80:83]
    ds_read_b128 a[108:111], v11 offset:0
    v_mfma_f32_16x16x32_bf16 v[84:87], a[4:7], a[64:67], v[84:87]
    ds_read_b128 a[112:115], v11 offset:2048
    v_mfma_f32_16x16x32_bf16 v[88:91], a[8:11], a[64:67], v[88:91]
    buffer_load_dwordx4 a[48:51], v2, s[44:47], s80 offen offset:0 sc1
    v_mfma_f32_16x16x32_bf16 v[92:95], a[12:15], a[64:67], v[92:95]
    ds_read_b128 a[116:119], v11 offset:4096
    v_mfma_f32_16x16x32_bf16 v[108:111], a[12:15], a[68:71], v[108:111]
    ds_read_b128 a[120:123], v11 offset:6144
    v_mfma_f32_16x16x32_bf16 v[104:107], a[8:11], a[68:71], v[104:107]
    s_add_u32 m0, s84, 2048
    v_mfma_f32_16x16x32_bf16 v[100:103], a[4:7], a[68:71], v[100:103]
    ds_read_b64_tr_b16 a[124:125], v13 offset:7168
    v_mfma_f32_16x16x32_bf16 v[96:99], a[0:3], a[68:71], v[96:99]
    ds_read_b64_tr_b16 a[126:127], v13 offset:8960
    v_mfma_f32_16x16x32_bf16 v[112:115], a[0:3], a[72:75], v[112:115]
    buffer_load_dwordx4 v5, s[56:59], s82 offen lds
    v_mfma_f32_16x16x32_bf16 v[116:119], a[4:7], a[72:75], v[116:119]
    ds_read_b64_tr_b16 a[128:129], v13 offset:7200
    v_mfma_f32_16x16x32_bf16 v[120:123], a[8:11], a[72:75], v[120:123]
    ds_read_b64_tr_b16 a[130:131], v13 offset:8992
    v_mfma_f32_16x16x32_bf16 v[124:127], a[12:15], a[72:75], v[124:127]
    buffer_load_dwordx4 a[52:55], v2, s[44:47], s80 offen offset:1024 sc1
    v_mfma_f32_16x16x32_bf16 v[140:143], a[12:15], a[76:79], v[140:143]
    ds_read_b64_tr_b16 a[132:133], v13 offset:7232
    v_mfma_f32_16x16x32_bf16 v[136:139], a[8:11], a[76:79], v[136:139]
    ds_read_b64_tr_b16 a[134:135], v13 offset:9024
    v_mfma_f32_16x16x32_bf16 v[132:135], a[4:7], a[76:79], v[132:135]
    s_add_u32 m0, s84, 3072
    v_mfma_f32_16x16x32_bf16 v[128:131], a[0:3], a[76:79], v[128:131]
    ds_read_b64_tr_b16 a[136:137], v13 offset:7264
    v_mfma_f32_16x16x32_bf16 v[144:147], a[80:83], a[0:3], v[144:147]
    ds_read_b64_tr_b16 a[138:139], v13 offset:9056
    v_mfma_f32_16x16x32_bf16 v[148:151], a[80:83], a[4:7], v[148:151]
    buffer_load_dwordx4 v6, s[56:59], s82 offen lds
    v_mfma_f32_16x16x32_bf16 v[152:155], a[80:83], a[8:11], v[152:155]
    ds_read_b64_tr_b16 a[140:141], v13 offset:7296
    v_mfma_f32_16x16x32_bf16 v[156:159], a[80:83], a[12:15], v[156:159]
    ds_read_b64_tr_b16 a[142:143], v13 offset:9088
    v_mfma_f32_16x16x32_bf16 v[172:175], a[84:87], a[12:15], v[172:175]
    buffer_load_dwordx4 a[56:59], v2, s[44:47], s80 offen offset:2048 sc1
    v_mfma_f32_16x16x32_bf16 v[168:171], a[84:87], a[8:11], v[168:171]
    ds_read_b64_tr_b16 a[144:145], v13 offset:7328
    v_mfma_f32_16x16x32_bf16 v[164:167], a[84:87], a[4:7], v[164:167]
    ds_read_b64_tr_b16 a[146:147], v13 offset:9120
    v_mfma_f32_16x16x32_bf16 v[160:163], a[84:87], a[0:3], v[160:163]
    s_add_u32 m0, s85, 1024
    v_mfma_f32_16x16x32_bf16 v[176:179], a[88:91], a[0:3], v[176:179]
    ds_read_b64_tr_b16 a[148:149], v13 offset:7360
    v_mfma_f32_16x16x32_bf16 v[180:183], a[88:91], a[4:7], v[180:183]
    ds_read_b64_tr_b16 a[150:151], v13 offset:9152
    v_mfma_f32_16x16x32_bf16 v[184:187], a[88:91], a[8:11], v[184:187]
    s_mov_b64 exec, s[86:87]
    buffer_load_dwordx4 v7, s[56:59], s82 offen lds
    s_mov_b64 exec, -1
    s_add_u32 s82, s82, 458752
    v_mfma_f32_16x16x32_bf16 v[188:191], a[88:91], a[12:15], v[188:191]
    v_mfma_f32_16x16x32_bf16 v[204:207], a[92:95], a[12:15], v[204:207]
    buffer_load_dwordx4 a[60:63], v2, s[44:47], s80 offen offset:3072 sc1
    s_add_u32 s80, s80, 131072
    v_mfma_f32_16x16x32_bf16 v[200:203], a[92:95], a[8:11], v[200:203]
    v_mfma_f32_16x16x32_bf16 v[196:199], a[92:95], a[4:7], v[196:199]
    v_mfma_f32_16x16x32_bf16 v[192:195], a[92:95], a[0:3], v[192:195]
    v_mfma_f32_16x16x32_bf16 v[208:211], a[96:99], a[0:3], v[208:211]
    v_mfma_f32_16x16x32_bf16 v[212:215], a[96:99], a[4:7], v[212:215]
    v_mfma_f32_16x16x32_bf16 v[216:219], a[96:99], a[8:11], v[216:219]
    v_mfma_f32_16x16x32_bf16 v[220:223], a[96:99], a[12:15], v[220:223]
    v_mfma_f32_16x16x32_bf16 v[236:239], a[100:103], a[12:15], v[236:239]
    v_mfma_f32_16x16x32_bf16 v[232:235], a[100:103], a[8:11], v[232:235]
    v_mfma_f32_16x16x32_bf16 v[228:231], a[100:103], a[4:7], v[228:231]
    v_mfma_f32_16x16x32_bf16 v[224:227], a[100:103], a[0:3], v[224:227]
    v_mfma_f32_16x16x32_bf16 v[240:243], a[104:107], a[0:3], v[240:243]
    v_mfma_f32_16x16x32_bf16 v[244:247], a[104:107], a[4:7], v[244:247]
    v_mfma_f32_16x16x32_bf16 v[248:251], a[104:107], a[8:11], v[248:251]
    v_mfma_f32_16x16x32_bf16 v[252:255], a[104:107], a[12:15], v[252:255]
    s_waitcnt vmcnt(17)
    s_barrier
    s_waitcnt vmcnt(16) lgkmcnt(0)
    v_mfma_f32_16x16x32_bf16 v[80:83], a[16:19], a[108:111], v[80:83]
    ds_read_b128 a[64:67], v10 offset:22528
    v_mfma_f32_16x16x32_bf16 v[84:87], a[20:23], a[108:111], v[84:87]
    ds_read_b128 a[68:71], v10 offset:24576
    v_mfma_f32_16x16x32_bf16 v[88:91], a[24:27], a[108:111], v[88:91]
    buffer_load_dwordx4 a[0:3], v2, s[44:47], s80 offen offset:0 sc1
    v_mfma_f32_16x16x32_bf16 v[92:95], a[28:31], a[108:111], v[92:95]
    ds_read_b128 a[72:75], v10 offset:26624
    v_mfma_f32_16x16x32_bf16 v[108:111], a[28:31], a[112:115], v[108:111]
    ds_read_b128 a[76:79], v10 offset:28672
    v_mfma_f32_16x16x32_bf16 v[104:107], a[24:27], a[112:115], v[104:107]
    s_add_u32 m0, s83, 23552
    v_mfma_f32_16x16x32_bf16 v[100:103], a[20:23], a[112:115], v[100:103]
    ds_read_b64_tr_b16 a[80:81], v13 offset:22528
    v_mfma_f32_16x16x32_bf16 v[96:99], a[16:19], a[112:115], v[96:99]
    ds_read_b64_tr_b16 a[82:83], v13 offset:24320
    v_mfma_f32_16x16x32_bf16 v[112:115], a[16:19], a[116:119], v[112:115]
    buffer_load_dwordx4 v3, s[48:51], s81 offen lds
    v_mfma_f32_16x16x32_bf16 v[116:119], a[20:23], a[116:119], v[116:119]
    ds_read_b64_tr_b16 a[84:85], v13 offset:22560
    v_mfma_f32_16x16x32_bf16 v[120:123], a[24:27], a[116:119], v[120:123]
    ds_read_b64_tr_b16 a[86:87], v13 offset:24352
    v_mfma_f32_16x16x32_bf16 v[124:127], a[28:31], a[116:119], v[124:127]
    buffer_load_dwordx4 a[4:7], v2, s[44:47], s80 offen offset:1024 sc1
    v_mfma_f32_16x16x32_bf16 v[140:143], a[28:31], a[120:123], v[140:143]
    ds_read_b64_tr_b16 a[88:89], v13 offset:22592
    v_mfma_f32_16x16x32_bf16 v[136:139], a[24:27], a[120:123], v[136:139]
    ds_read_b64_tr_b16 a[90:91], v13 offset:24384
    v_mfma_f32_16x16x32_bf16 v[132:135], a[20:23], a[120:123], v[132:135]
    s_add_u32 m0, s83, 27648
    v_mfma_f32_16x16x32_bf16 v[128:131], a[16:19], a[120:123], v[128:131]
    ds_read_b64_tr_b16 a[92:93], v13 offset:22624
    v_mfma_f32_16x16x32_bf16 v[144:147], a[124:127], a[16:19], v[144:147]
    ds_read_b64_tr_b16 a[94:95], v13 offset:24416
    v_mfma_f32_16x16x32_bf16 v[148:151], a[124:127], a[20:23], v[148:151]
    buffer_load_dwordx4 v3, s[52:55], s81 offen lds
    v_mfma_f32_16x16x32_bf16 v[152:155], a[124:127], a[24:27], v[152:155]
    ds_read_b64_tr_b16 a[96:97], v13 offset:22656
    v_mfma_f32_16x16x32_bf16 v[156:159], a[124:127], a[28:31], v[156:159]
    ds_read_b64_tr_b16 a[98:99], v13 offset:24448
    v_mfma_f32_16x16x32_bf16 v[172:175], a[128:131], a[28:31], v[172:175]
    buffer_load_dwordx4 a[8:11], v2, s[44:47], s80 offen offset:2048 sc1
    v_mfma_f32_16x16x32_bf16 v[168:171], a[128:131], a[24:27], v[168:171]
    ds_read_b64_tr_b16 a[100:101], v13 offset:22688
    v_mfma_f32_16x16x32_bf16 v[164:167], a[128:131], a[20:23], v[164:167]
    ds_read_b64_tr_b16 a[102:103], v13 offset:24480
    v_mfma_f32_16x16x32_bf16 v[160:163], a[128:131], a[16:19], v[160:163]
    s_add_u32 m0, s84, 23552
    s_add_u32 s81, s81, 128
    v_mfma_f32_16x16x32_bf16 v[176:179], a[132:135], a[16:19], v[176:179]
    ds_read_b64_tr_b16 a[104:105], v13 offset:22720
    v_mfma_f32_16x16x32_bf16 v[180:183], a[132:135], a[20:23], v[180:183]
    ds_read_b64_tr_b16 a[106:107], v13 offset:24512
    v_mfma_f32_16x16x32_bf16 v[184:187], a[132:135], a[24:27], v[184:187]
    buffer_load_dwordx4 v4, s[56:59], s82 offen lds
    v_mfma_f32_16x16x32_bf16 v[188:191], a[132:135], a[28:31], v[188:191]
    v_mfma_f32_16x16x32_bf16 v[204:207], a[136:139], a[28:31], v[204:207]
    buffer_load_dwordx4 a[12:15], v2, s[44:47], s80 offen offset:3072 sc1
    s_add_u32 s80, s80, 131072
    v_mfma_f32_16x16x32_bf16 v[200:203], a[136:139], a[24:27], v[200:203]
    v_mfma_f32_16x16x32_bf16 v[196:199], a[136:139], a[20:23], v[196:199]
    v_mfma_f32_16x16x32_bf16 v[192:195], a[136:139], a[16:19], v[192:195]
    s_cmp_eq_u32 s88, s89
    s_cselect_b32 s90, 0, 1073741824
    v_mfma_f32_16x16x32_bf16 v[208:211], a[140:143], a[16:19], v[208:211]
    v_mfma_f32_16x16x32_bf16 v[212:215], a[140:143], a[20:23], v[212:215]
    buffer_load_dword v43, v31, s[68:71], s90 offen
    v_mfma_f32_16x16x32_bf16 v[216:219], a[140:143], a[24:27], v[216:219]
    v_mfma_f32_16x16x32_bf16 v[220:223], a[140:143], a[28:31], v[220:223]
    v_mfma_f32_16x16x32_bf16 v[236:239], a[144:147], a[28:31], v[236:239]
    v_mfma_f32_16x16x32_bf16 v[232:235], a[144:147], a[24:27], v[232:235]
    v_mfma_f32_16x16x32_bf16 v[228:231], a[144:147], a[20:23], v[228:231]
    buffer_store_dwordx4 v[56:59], v55, s[60:63], s13 offen sc1
    s_add_u32 s13, s13, 1024
    v_mfma_f32_16x16x32_bf16 v[224:227], a[144:147], a[16:19], v[224:227]
    v_mfma_f32_16x16x32_bf16 v[240:243], a[148:151], a[16:19], v[240:243]
    v_mfma_f32_16x16x32_bf16 v[244:247], a[148:151], a[20:23], v[244:247]
    v_mfma_f32_16x16x32_bf16 v[248:251], a[148:151], a[24:27], v[248:251]
    v_mfma_f32_16x16x32_bf16 v[252:255], a[148:151], a[28:31], v[252:255]
    s_waitcnt vmcnt(18) lgkmcnt(0)
    v_mfma_f32_16x16x32_bf16 v[80:83], a[32:35], a[64:67], v[80:83]
    ds_read_b128 a[108:111], v11 offset:22528
    v_mfma_f32_16x16x32_bf16 v[84:87], a[36:39], a[64:67], v[84:87]
    ds_read_b128 a[112:115], v11 offset:24576
    v_mfma_f32_16x16x32_bf16 v[88:91], a[40:43], a[64:67], v[88:91]
    buffer_load_dwordx4 a[16:19], v2, s[44:47], s80 offen offset:0 sc1
    v_mfma_f32_16x16x32_bf16 v[92:95], a[44:47], a[64:67], v[92:95]
    ds_read_b128 a[116:119], v11 offset:26624
    v_mfma_f32_16x16x32_bf16 v[108:111], a[44:47], a[68:71], v[108:111]
    ds_read_b128 a[120:123], v11 offset:28672
    v_mfma_f32_16x16x32_bf16 v[104:107], a[40:43], a[68:71], v[104:107]
    s_add_u32 m0, s84, 24576
    v_mfma_f32_16x16x32_bf16 v[100:103], a[36:39], a[68:71], v[100:103]
    ds_read_b64_tr_b16 a[124:125], v13 offset:29696
    v_mfma_f32_16x16x32_bf16 v[96:99], a[32:35], a[68:71], v[96:99]
    ds_read_b64_tr_b16 a[126:127], v13 offset:31488
    v_mfma_f32_16x16x32_bf16 v[112:115], a[32:35], a[72:75], v[112:115]
    buffer_load_dwordx4 v5, s[56:59], s82 offen lds
    v_mfma_f32_16x16x32_bf16 v[116:119], a[36:39], a[72:75], v[116:119]
    ds_read_b64_tr_b16 a[128:129], v13 offset:29728
    v_mfma_f32_16x16x32_bf16 v[120:123], a[40:43], a[72:75], v[120:123]
    ds_read_b64_tr_b16 a[130:131], v13 offset:31520
    v_mfma_f32_16x16x32_bf16 v[124:127], a[44:47], a[72:75], v[124:127]
    buffer_load_dwordx4 a[20:23], v2, s[44:47], s80 offen offset:1024 sc1
    v_mfma_f32_16x16x32_bf16 v[140:143], a[44:47], a[76:79], v[140:143]
    ds_read_b64_tr_b16 a[132:133], v13 offset:29760
    v_mfma_f32_16x16x32_bf16 v[136:139], a[40:43], a[76:79], v[136:139]
    ds_read_b64_tr_b16 a[134:135], v13 offset:31552
    v_mfma_f32_16x16x32_bf16 v[132:135], a[36:39], a[76:79], v[132:135]
    s_add_u32 m0, s84, 25600
    v_mfma_f32_16x16x32_bf16 v[128:131], a[32:35], a[76:79], v[128:131]
    ds_read_b64_tr_b16 a[136:137], v13 offset:29792
    v_mfma_f32_16x16x32_bf16 v[144:147], a[80:83], a[32:35], v[144:147]
    ds_read_b64_tr_b16 a[138:139], v13 offset:31584
    v_mfma_f32_16x16x32_bf16 v[148:151], a[80:83], a[36:39], v[148:151]
    buffer_load_dwordx4 v6, s[56:59], s82 offen lds
    v_mfma_f32_16x16x32_bf16 v[152:155], a[80:83], a[40:43], v[152:155]
    ds_read_b64_tr_b16 a[140:141], v13 offset:29824
    v_mfma_f32_16x16x32_bf16 v[156:159], a[80:83], a[44:47], v[156:159]
    ds_read_b64_tr_b16 a[142:143], v13 offset:31616
    v_mfma_f32_16x16x32_bf16 v[172:175], a[84:87], a[44:47], v[172:175]
    buffer_load_dwordx4 a[24:27], v2, s[44:47], s80 offen offset:2048 sc1
    v_mfma_f32_16x16x32_bf16 v[168:171], a[84:87], a[40:43], v[168:171]
    ds_read_b64_tr_b16 a[144:145], v13 offset:29856
    v_mfma_f32_16x16x32_bf16 v[164:167], a[84:87], a[36:39], v[164:167]
    ds_read_b64_tr_b16 a[146:147], v13 offset:31648
    v_mfma_f32_16x16x32_bf16 v[160:163], a[84:87], a[32:35], v[160:163]
    s_add_u32 m0, s85, 23552
    v_mfma_f32_16x16x32_bf16 v[176:179], a[88:91], a[32:35], v[176:179]
    ds_read_b64_tr_b16 a[148:149], v13 offset:29888
    v_mfma_f32_16x16x32_bf16 v[180:183], a[88:91], a[36:39], v[180:183]
    ds_read_b64_tr_b16 a[150:151], v13 offset:31680
    v_mfma_f32_16x16x32_bf16 v[184:187], a[88:91], a[40:43], v[184:187]
    s_mov_b64 exec, s[86:87]
    buffer_load_dwordx4 v7, s[56:59], s82 offen lds
    s_mov_b64 exec, -1
    s_add_u32 s82, s82, 458752
    v_mfma_f32_16x16x32_bf16 v[188:191], a[88:91], a[44:47], v[188:191]
    v_mfma_f32_16x16x32_bf16 v[204:207], a[92:95], a[44:47], v[204:207]
    buffer_load_dwordx4 a[28:31], v2, s[44:47], s80 offen offset:3072 sc1
    s_add_u32 s80, s80, 131072
    v_mfma_f32_16x16x32_bf16 v[200:203], a[92:95], a[40:43], v[200:203]
    v_mfma_f32_16x16x32_bf16 v[196:199], a[92:95], a[36:39], v[196:199]
    v_mfma_f32_16x16x32_bf16 v[192:195], a[92:95], a[32:35], v[192:195]
    v_mfma_f32_16x16x32_bf16 v[208:211], a[96:99], a[32:35], v[208:211]
    v_mfma_f32_16x16x32_bf16 v[212:215], a[96:99], a[36:39], v[212:215]
    v_mfma_f32_16x16x32_bf16 v[216:219], a[96:99], a[40:43], v[216:219]
    v_mfma_f32_16x16x32_bf16 v[220:223], a[96:99], a[44:47], v[220:223]
    v_mfma_f32_16x16x32_bf16 v[236:239], a[100:103], a[44:47], v[236:239]
    v_mfma_f32_16x16x32_bf16 v[232:235], a[100:103], a[40:43], v[232:235]
    v_mfma_f32_16x16x32_bf16 v[228:231], a[100:103], a[36:39], v[228:231]
    v_mfma_f32_16x16x32_bf16 v[224:227], a[100:103], a[32:35], v[224:227]
    v_mfma_f32_16x16x32_bf16 v[240:243], a[104:107], a[32:35], v[240:243]
    v_mfma_f32_16x16x32_bf16 v[244:247], a[104:107], a[36:39], v[244:247]
    v_mfma_f32_16x16x32_bf16 v[248:251], a[104:107], a[40:43], v[248:251]
    v_mfma_f32_16x16x32_bf16 v[252:255], a[104:107], a[44:47], v[252:255]
    s_waitcnt vmcnt(17)
    s_barrier
    s_waitcnt vmcnt(16) lgkmcnt(0)
    v_mfma_f32_16x16x32_bf16 v[80:83], a[48:51], a[108:111], v[80:83]
    ds_read_b128 a[64:67], v8 offset:0
    v_mfma_f32_16x16x32_bf16 v[84:87], a[52:55], a[108:111], v[84:87]
    ds_read_b128 a[68:71], v8 offset:2048
    v_mfma_f32_16x16x32_bf16 v[88:91], a[56:59], a[108:111], v[88:91]
    buffer_load_dwordx4 a[32:35], v2, s[44:47], s80 offen offset:0 sc1
    v_mfma_f32_16x16x32_bf16 v[92:95], a[60:63], a[108:111], v[92:95]
    ds_read_b128 a[72:75], v8 offset:4096
    v_mfma_f32_16x16x32_bf16 v[108:111], a[60:63], a[112:115], v[108:111]
    ds_read_b128 a[76:79], v8 offset:6144
    v_mfma_f32_16x16x32_bf16 v[104:107], a[56:59], a[112:115], v[104:107]
    s_add_u32 m0, s83, 46080
    v_mfma_f32_16x16x32_bf16 v[100:103], a[52:55], a[112:115], v[100:103]
    ds_read_b64_tr_b16 a[80:81], v12 offset:0
    v_mfma_f32_16x16x32_bf16 v[96:99], a[48:51], a[112:115], v[96:99]
    ds_read_b64_tr_b16 a[82:83], v12 offset:1792
    v_mfma_f32_16x16x32_bf16 v[112:115], a[48:51], a[116:119], v[112:115]
    buffer_load_dwordx4 v3, s[48:51], s81 offen lds
    v_mfma_f32_16x16x32_bf16 v[116:119], a[52:55], a[116:119], v[116:119]
    ds_read_b64_tr_b16 a[84:85], v12 offset:32
    v_mfma_f32_16x16x32_bf16 v[120:123], a[56:59], a[116:119], v[120:123]
    ds_read_b64_tr_b16 a[86:87], v12 offset:1824
    v_mfma_f32_16x16x32_bf16 v[124:127], a[60:63], a[116:119], v[124:127]
    buffer_load_dwordx4 a[36:39], v2, s[44:47], s80 offen offset:1024 sc1
    v_mfma_f32_16x16x32_bf16 v[140:143], a[60:63], a[120:123], v[140:143]
    ds_read_b64_tr_b16 a[88:89], v12 offset:64
    v_mfma_f32_16x16x32_bf16 v[136:139], a[56:59], a[120:123], v[136:139]
    ds_read_b64_tr_b16 a[90:91], v12 offset:1856
    v_mfma_f32_16x16x32_bf16 v[132:135], a[52:55], a[120:123], v[132:135]
    s_add_u32 m0, s83, 50176
    v_mfma_f32_16x16x32_bf16 v[128:131], a[48:51], a[120:123], v[128:131]
    ds_read_b64_tr_b16 a[92:93], v12 offset:96
    v_mfma_f32_16x16x32_bf16 v[144:147], a[124:127], a[48:51], v[144:147]
    ds_read_b64_tr_b16 a[94:95], v12 offset:1888
    v_mfma_f32_16x16x32_bf16 v[148:151], a[124:127], a[52:55], v[148:151]
    buffer_load_dwordx4 v3, s[52:55], s81 offen lds
    v_mfma_f32_16x16x32_bf16 v[152:155], a[124:127], a[56:59], v[152:155]
    ds_read_b64_tr_b16 a[96:97], v12 offset:128
    v_mfma_f32_16x16x32_bf16 v[156:159], a[124:127], a[60:63], v[156:159]
    ds_read_b64_tr_b16 a[98:99], v12 offset:1920
    v_mfma_f32_16x16x32_bf16 v[172:175], a[128:131], a[60:63], v[172:175]
    buffer_load_dwordx4 a[40:43], v2, s[44:47], s80 offen offset:2048 sc1
    v_mfma_f32_16x16x32_bf16 v[168:171], a[128:131], a[56:59], v[168:171]
    ds_read_b64_tr_b16 a[100:101], v12 offset:160
    v_mfma_f32_16x16x32_bf16 v[164:167], a[128:131], a[52:55], v[164:167]
    ds_read_b64_tr_b16 a[102:103], v12 offset:1952
    v_mfma_f32_16x16x32_bf16 v[160:163], a[128:131], a[48:51], v[160:163]
    s_add_u32 m0, s84, 46080
    s_add_u32 s81, s81, 128
    v_mfma_f32_16x16x32_bf16 v[176:179], a[132:135], a[48:51], v[176:179]
    ds_read_b64_tr_b16 a[104:105], v12 offset:192
    v_mfma_f32_16x16x32_bf16 v[180:183], a[132:135], a[52:55], v[180:183]
    ds_read_b64_tr_b16 a[106:107], v12 offset:1984
    v_mfma_f32_16x16x32_bf16 v[184:187], a[132:135], a[56:59], v[184:187]
    buffer_load_dwordx4 v4, s[56:59], s82 offen lds
    v_mfma_f32_16x16x32_bf16 v[188:191], a[132:135], a[60:63], v[188:191]
    v_mfma_f32_16x16x32_bf16 v[204:207], a[136:139], a[60:63], v[204:207]
    buffer_load_dwordx4 a[44:47], v2, s[44:47], s80 offen offset:3072 sc1
    s_add_u32 s80, s80, 131072
    v_mfma_f32_16x16x32_bf16 v[200:203], a[136:139], a[56:59], v[200:203]
    v_mfma_f32_16x16x32_bf16 v[196:199], a[136:139], a[52:55], v[196:199]
    v_mfma_f32_16x16x32_bf16 v[192:195], a[136:139], a[48:51], v[192:195]
    v_mfma_f32_16x16x32_bf16 v[208:211], a[140:143], a[48:51], v[208:211]
    v_mfma_f32_16x16x32_bf16 v[212:215], a[140:143], a[52:55], v[212:215]
    v_mfma_f32_16x16x32_bf16 v[216:219], a[140:143], a[56:59], v[216:219]
    v_mfma_f32_16x16x32_bf16 v[220:223], a[140:143], a[60:63], v[220:223]
    v_mfma_f32_16x16x32_bf16 v[236:239], a[144:147], a[60:63], v[236:239]
    v_mfma_f32_16x16x32_bf16 v[232:235], a[144:147], a[56:59], v[232:235]
    v_mfma_f32_16x16x32_bf16 v[228:231], a[144:147], a[52:55], v[228:231]
    buffer_store_dwordx4 v[56:59], v55, s[60:63], s13 offen sc1
    s_add_u32 s13, s13, 1024
    v_mfma_f32_16x16x32_bf16 v[224:227], a[144:147], a[48:51], v[224:227]
    v_mfma_f32_16x16x32_bf16 v[240:243], a[148:151], a[48:51], v[240:243]
    v_mfma_f32_16x16x32_bf16 v[244:247], a[148:151], a[52:55], v[244:247]
    v_mfma_f32_16x16x32_bf16 v[248:251], a[148:151], a[56:59], v[248:251]
    v_mfma_f32_16x16x32_bf16 v[252:255], a[148:151], a[60:63], v[252:255]
    s_sub_u32 s88, s88, 1
    s_cmp_lg_u32 s88, 1
    s_cbranch_scc1 L_bloop
    s_waitcnt vmcnt(17) lgkmcnt(0)
    v_mfma_f32_16x16x32_bf16 v[80:83], a[0:3], a[64:67], v[80:83]
    ds_read_b128 a[108:111], v9 offset:0
    v_mfma_f32_16x16x32_bf16 v[84:87], a[4:7], a[64:67], v[84:87]
    ds_read_b128 a[112:115], v9 offset:2048
    v_mfma_f32_16x16x32_bf16 v[88:91], a[8:11], a[64:67], v[88:91]
    buffer_load_dwordx4 a[48:51], v2, s[44:47], s80 offen offset:0 sc1
    v_mfma_f32_16x16x32_bf16 v[92:95], a[12:15], a[64:67], v[92:95]
    ds_read_b128 a[116:119], v9 offset:4096
    v_mfma_f32_16x16x32_bf16 v[108:111], a[12:15], a[68:71], v[108:111]
    ds_read_b128 a[120:123], v9 offset:6144
    v_mfma_f32_16x16x32_bf16 v[104:107], a[8:11], a[68:71], v[104:107]
    s_add_u32 m0, s84, 47104
    v_mfma_f32_16x16x32_bf16 v[100:103], a[4:7], a[68:71], v[100:103]
    ds_read_b64_tr_b16 a[124:125], v12 offset:7168
    v_mfma_f32_16x16x32_bf16 v[96:99], a[0:3], a[68:71], v[96:99]
    ds_read_b64_tr_b16 a[126:127], v12 offset:8960
    v_mfma_f32_16x16x32_bf16 v[112:115], a[0:3], a[72:75], v[112:115]
    buffer_load_dwordx4 v5, s[56:59], s82 offen lds
    v_mfma_f32_16x16x32_bf16 v[116:119], a[4:7], a[72:75], v[116:119]
    ds_read_b64_tr_b16 a[128:129], v12 offset:7200
    v_mfma_f32_16x16x32_bf16 v[120:123], a[8:11], a[72:75], v[120:123]
    ds_read_b64_tr_b16 a[130:131], v12 offset:8992
    v_mfma_f32_16x16x32_bf16 v[124:127], a[12:15], a[72:75], v[124:127]
    buffer_load_dwordx4 a[52:55], v2, s[44:47], s80 offen offset:1024 sc1
    v_mfma_f32_16x16x32_bf16 v[140:143], a[12:15], a[76:79], v[140:143]
    ds_read_b64_tr_b16 a[132:133], v12 offset:7232
    v_mfma_f32_16x16x32_bf16 v[136:139], a[8:11], a[76:79], v[136:139]
    ds_read_b64_tr_b16 a[134:135], v12 offset:9024
    v_mfma_f32_16x16x32_bf16 v[132:135], a[4:7], a[76:79], v[132:135]
    s_add_u32 m0, s84, 48128
    v_mfma_f32_16x16x32_bf16 v[128:131], a[0:3], a[76:79], v[128:131]
    ds_read_b64_tr_b16 a[136:137], v12 offset:7264
    v_mfma_f32_16x16x32_bf16 v[144:147], a[80:83], a[0:3], v[144:147]
    ds_read_b64_tr_b16 a[138:139], v12 offset:9056
    v_mfma_f32_16x16x32_bf16 v[148:151], a[80:83], a[4:7], v[148:151]
    buffer_load_dwordx4 v6, s[56:59], s82 offen lds
    v_mfma_f32_16x16x32_bf16 v[152:155], a[80:83], a[8:11], v[152:155]
    ds_read_b64_tr_b16 a[140:141], v12 offset:7296
    v_mfma_f32_16x16x32_bf16 v[156:159], a[80:83], a[12:15], v[156:159]
    ds_read_b64_tr_b16 a[142:143], v12 offset:9088
    v_mfma_f32_16x16x32_bf16 v[172:175], a[84:87], a[12:15], v[172:175]
    buffer_load_dwordx4 a[56:59], v2, s[44:47], s80 offen offset:2048 sc1
    v_mfma_f32_16x16x32_bf16 v[168:171], a[84:87], a[8:11], v[168:171]
    ds_read_b64_tr_b16 a[144:145], v12 offset:7328
    v_mfma_f32_16x16x32_bf16 v[164:167], a[84:87], a[4:7], v[164:167]
    ds_read_b64_tr_b16 a[146:147], v12 offset:9120
    v_mfma_f32_16x16x32_bf16 v[160:163], a[84:87], a[0:3], v[160:163]
    s_add_u32 m0, s85, 46080
    v_mfma_f32_16x16x32_bf16 v[176:179], a[88:91], a[0:3], v[176:179]
    ds_read_b64_tr_b16 a[148:149], v12 offset:7360
    v_mfma_f32_16x16x32_bf16 v[180:183], a[88:91], a[4:7], v[180:183]
    ds_read_b64_tr_b16 a[150:151], v12 offset:9152
    v_mfma_f32_16x16x32_bf16 v[184:187], a[88:91], a[8:11], v[184:187]
    s_mov_b64 exec, s[86:87]
    buffer_load_dwordx4 v7, s[56:59], s82 offen lds
    s_mov_b64 exec, -1
    s_add_u32 s82, s82, 458752
    v_mfma_f32_16x16x32_bf16 v[188:191], a[88:91], a[12:15], v[188:191]
    s_add_u32 s60, s36, 4194304
    s_addc_u32 s61, s37, 0
    v_mfma_f32_16x16x32_bf16 v[204:207], a[92:95], a[12:15], v[204:207]
    buffer_load_dwordx4 a[60:63], v2, s[44:47], s80 offen offset:3072 sc1
    s_add_u32 s80, s80, 131072
    v_mfma_f32_16x16x32_bf16 v[200:203], a[92:95], a[8:11], v[200:203]
    v_mfma_f32_16x16x32_bf16 v[196:199], a[92:95], a[4:7], v[196:199]
    v_mfma_f32_16x16x32_bf16 v[192:195], a[92:95], a[0:3], v[192:195]
    v_mfma_f32_16x16x32_bf16 v[208:211], a[96:99], a[0:3], v[208:211]
    v_mfma_f32_16x16x32_bf16 v[212:215], a[96:99], a[4:7], v[212:215]
    v_mfma_f32_16x16x32_bf16 v[216:219], a[96:99], a[8:11], v[216:219]
    v_mfma_f32_16x16x32_bf16 v[220:223], a[96:99], a[12:15], v[220:223]
    s_mov_b32 s62, 23068672
    v_mfma_f32_16x16x32_bf16 v[236:239], a[100:103], a[12:15], v[236:239]
    v_mfma_f32_16x16x32_bf16 v[232:235], a[100:103], a[8:11], v[232:235]
    v_mfma_f32_16x16x32_bf16 v[228:231], a[100:103], a[4:7], v[228:231]
    v_mfma_f32_16x16x32_bf16 v[224:227], a[100:103], a[0:3], v[224:227]
    v_mfma_f32_16x16x32_bf16 v[240:243], a[104:107], a[0:3], v[240:243]
    v_mfma_f32_16x16x32_bf16 v[244:247], a[104:107], a[4:7], v[244:247]
    v_mfma_f32_16x16x32_bf16 v[248:251], a[104:107], a[8:11], v[248:251]
    v_mfma_f32_16x16x32_bf16 v[252:255], a[104:107], a[12:15], v[252:255]
    s_waitcnt vmcnt(16)
    s_barrier
    s_waitcnt vmcnt(15) lgkmcnt(0)
    v_mfma_f32_16x16x32_bf16 v[80:83], a[16:19], a[108:111], v[80:83]
    ds_read_b128 a[64:67], v8 offset:22528
    v_mfma_f32_16x16x32_bf16 v[84:87], a[20:23], a[108:111], v[84:87]
    ds_read_b128 a[68:71], v8 offset:24576
    v_mfma_f32_16x16x32_bf16 v[88:91], a[24:27], a[108:111], v[88:91]
    buffer_load_dwordx4 a[0:3], v2, s[44:47], s80 offen offset:0 sc1
    v_mfma_f32_16x16x32_bf16 v[92:95], a[28:31], a[108:111], v[92:95]
    ds_read_b128 a[72:75], v8 offset:26624
    v_mfma_f32_16x16x32_bf16 v[108:111], a[28:31], a[112:115], v[108:111]
    ds_read_b128 a[76:79], v8 offset:28672
    v_mfma_f32_16x16x32_bf16 v[104:107], a[24:27], a[112:115], v[104:107]
    s_add_u32 m0, s83, 68608
    v_mfma_f32_16x16x32_bf16 v[100:103], a[20:23], a[112:115], v[100:103]
    ds_read_b64_tr_b16 a[80:81], v12 offset:22528
    v_mfma_f32_16x16x32_bf16 v[96:99], a[16:19], a[112:115], v[96:99]
    ds_read_b64_tr_b16 a[82:83], v12 offset:24320
    v_mfma_f32_16x16x32_bf16 v[112:115], a[16:19], a[116:119], v[112:115]
    buffer_load_dwordx4 v3, s[48:51], s81 offen lds
    v_mfma_f32_16x16x32_bf16 v[116:119], a[20:23], a[116:119], v[116:119]
    ds_read_b64_tr_b16 a[84:85], v12 offset:22560
    v_mfma_f32_16x16x32_bf16 v[120:123], a[24:27], a[116:119], v[120:123]
    ds_read_b64_tr_b16 a[86:87], v12 offset:24352
    v_mfma_f32_16x16x32_bf16 v[124:127], a[28:31], a[116:119], v[124:127]
    buffer_load_dwordx4 a[4:7], v2, s[44:47], s80 offen offset:1024 sc1
    v_mfma_f32_16x16x32_bf16 v[140:143], a[28:31], a[120:123], v[140:143]
    ds_read_b64_tr_b16 a[88:89], v12 offset:22592
    v_mfma_f32_16x16x32_bf16 v[136:139], a[24:27], a[120:123], v[136:139]
    ds_read_b64_tr_b16 a[90:91], v12 offset:24384
    v_mfma_f32_16x16x32_bf16 v[132:135], a[20:23], a[120:123], v[132:135]
    s_add_u32 m0, s83, 72704
    v_mfma_f32_16x16x32_bf16 v[128:131], a[16:19], a[120:123], v[128:131]
    ds_read_b64_tr_b16 a[92:93], v12 offset:22624
    v_mfma_f32_16x16x32_bf16 v[144:147], a[124:127], a[16:19], v[144:147]
    ds_read_b64_tr_b16 a[94:95], v12 offset:24416
    v_mfma_f32_16x16x32_bf16 v[148:151], a[124:127], a[20:23], v[148:151]
    buffer_load_dwordx4 v3, s[52:55], s81 offen lds
    v_mfma_f32_16x16x32_bf16 v[152:155], a[124:127], a[24:27], v[152:155]
    ds_read_b64_tr_b16 a[96:97], v12 offset:22656
    v_mfma_f32_16x16x32_bf16 v[156:159], a[124:127], a[28:31], v[156:159]
    ds_read_b64_tr_b16 a[98:99], v12 offset:24448
    v_mfma_f32_16x16x32_bf16 v[172:175], a[128:131], a[28:31], v[172:175]
    buffer_load_dwordx4 a[8:11], v2, s[44:47], s80 offen offset:2048 sc1
    v_mfma_f32_16x16x32_bf16 v[168:171], a[128:131], a[24:27], v[168:171]
    ds_read_b64_tr_b16 a[100:101], v12 offset:22688
    v_mfma_f32_16x16x32_bf16 v[164:167], a[128:131], a[20:23], v[164:167]
    ds_read_b64_tr_b16 a[102:103], v12 offset:24480
    v_mfma_f32_16x16x32_bf16 v[160:163], a[128:131], a[16:19], v[160:163]
    s_add_u32 m0, s84, 68608
    s_add_u32 s81, s81, 128
    v_mfma_f32_16x16x32_bf16 v[176:179], a[132:135], a[16:19], v[176:179]
    ds_read_b64_tr_b16 a[104:105], v12 offset:22720
    v_mfma_f32_16x16x32_bf16 v[180:183], a[132:135], a[20:23], v[180:183]
    ds_read_b64_tr_b16 a[106:107], v12 offset:24512
    v_mfma_f32_16x16x32_bf16 v[184:187], a[132:135], a[24:27], v[184:187]
    buffer_load_dwordx4 v4, s[56:59], s82 offen lds
    v_mfma_f32_16x16x32_bf16 v[188:191], a[132:135], a[28:31], v[188:191]
    buffer_load_dword v43, v51, s[8:11], 0 offen
    v_mfma_f32_16x16x32_bf16 v[204:207], a[136:139], a[28:31], v[204:207]
    buffer_load_dwordx4 a[12:15], v2, s[44:47], s80 offen offset:3072 sc1
    s_add_u32 s80, s80, 131072
    v_mfma_f32_16x16x32_bf16 v[200:203], a[136:139], a[24:27], v[200:203]
    v_mfma_f32_16x16x32_bf16 v[196:199], a[136:139], a[20:23], v[196:199]
    v_mfma_f32_16x16x32_bf16 v[192:195], a[136:139], a[16:19], v[192:195]
    v_mfma_f32_16x16x32_bf16 v[208:211], a[140:143], a[16:19], v[208:211]
    v_mfma_f32_16x16x32_bf16 v[212:215], a[140:143], a[20:23], v[212:215]
    v_mfma_f32_16x16x32_bf16 v[216:219], a[140:143], a[24:27], v[216:219]
    v_mfma_f32_16x16x32_bf16 v[220:223], a[140:143], a[28:31], v[220:223]
    v_mfma_f32_16x16x32_bf16 v[236:239], a[144:147], a[28:31], v[236:239]
    v_mfma_f32_16x16x32_bf16 v[232:235], a[144:147], a[24:27], v[232:235]
    v_mfma_f32_16x16x32_bf16 v[228:231], a[144:147], a[20:23], v[228:231]
    v_mfma_f32_16x16x32_bf16 v[224:227], a[144:147], a[16:19], v[224:227]
    v_mfma_f32_16x16x32_bf16 v[240:243], a[148:151], a[16:19], v[240:243]
    v_mfma_f32_16x16x32_bf16 v[244:247], a[148:151], a[20:23], v[244:247]
    v_mfma_f32_16x16x32_bf16 v[248:251], a[148:151], a[24:27], v[248:251]
    v_mfma_f32_16x16x32_bf16 v[252:255], a[148:151], a[28:31], v[252:255]
    s_waitcnt vmcnt(16) lgkmcnt(0)
    v_mfma_f32_16x16x32_bf16 v[80:83], a[32:35], a[64:67], v[80:83]
    ds_read_b128 a[108:111], v9 offset:22528
    v_mfma_f32_16x16x32_bf16 v[84:87], a[36:39], a[64:67], v[84:87]
    ds_read_b128 a[112:115], v9 offset:24576
    v_mfma_f32_16x16x32_bf16 v[88:91], a[40:43], a[64:67], v[88:91]
    buffer_load_dwordx4 a[16:19], v2, s[44:47], s80 offen offset:0 sc1
    v_mfma_f32_16x16x32_bf16 v[92:95], a[44:47], a[64:67], v[92:95]
    ds_read_b128 a[116:119], v9 offset:26624
    v_mfma_f32_16x16x32_bf16 v[108:111], a[44:47], a[68:71], v[108:111]
    ds_read_b128 a[120:123], v9 offset:28672
    v_mfma_f32_16x16x32_bf16 v[104:107], a[40:43], a[68:71], v[104:107]
    s_add_u32 m0, s84, 69632
    v_mfma_f32_16x16x32_bf16 v[100:103], a[36:39], a[68:71], v[100:103]
    ds_read_b64_tr_b16 a[124:125], v12 offset:29696
    v_mfma_f32_16x16x32_bf16 v[96:99], a[32:35], a[68:71], v[96:99]
    ds_read_b64_tr_b16 a[126:127], v12 offset:31488
    v_mfma_f32_16x16x32_bf16 v[112:115], a[32:35], a[72:75], v[112:115]
    buffer_load_dwordx4 v5, s[56:59], s82 offen lds
    v_mfma_f32_16x16x32_bf16 v[116:119], a[36:39], a[72:75], v[116:119]
    ds_read_b64_tr_b16 a[128:129], v12 offset:29728
    v_mfma_f32_16x16x32_bf16 v[120:123], a[40:43], a[72:75], v[120:123]
    ds_read_b64_tr_b16 a[130:131], v12 offset:31520
    v_mfma_f32_16x16x32_bf16 v[124:127], a[44:47], a[72:75], v[124:127]
    buffer_load_dwordx4 a[20:23], v2, s[44:47], s80 offen offset:1024 sc1
    v_mfma_f32_16x16x32_bf16 v[140:143], a[44:47], a[76:79], v[140:143]
    ds_read_b64_tr_b16 a[132:133], v12 offset:29760
    v_mfma_f32_16x16x32_bf16 v[136:139], a[40:43], a[76:79], v[136:139]
    ds_read_b64_tr_b16 a[134:135], v12 offset:31552
    v_mfma_f32_16x16x32_bf16 v[132:135], a[36:39], a[76:79], v[132:135]
    s_add_u32 m0, s84, 70656
    v_mfma_f32_16x16x32_bf16 v[128:131], a[32:35], a[76:79], v[128:131]
    ds_read_b64_tr_b16 a[136:137], v12 offset:29792
    v_mfma_f32_16x16x32_bf16 v[144:147], a[80:83], a[32:35], v[144:147]
    ds_read_b64_tr_b16 a[138:139], v12 offset:31584
    v_mfma_f32_16x16x32_bf16 v[148:151], a[80:83], a[36:39], v[148:151]
    buffer_load_dwordx4 v6, s[56:59], s82 offen lds
    v_mfma_f32_16x16x32_bf16 v[152:155], a[80:83], a[40:43], v[152:155]
    ds_read_b64_tr_b16 a[140:141], v12 offset:29824
    v_mfma_f32_16x16x32_bf16 v[156:159], a[80:83], a[44:47], v[156:159]
    ds_read_b64_tr_b16 a[142:143], v12 offset:31616
    v_mfma_f32_16x16x32_bf16 v[172:175], a[84:87], a[44:47], v[172:175]
    buffer_load_dwordx4 a[24:27], v2, s[44:47], s80 offen offset:2048 sc1
    v_mfma_f32_16x16x32_bf16 v[168:171], a[84:87], a[40:43], v[168:171]
    ds_read_b64_tr_b16 a[144:145], v12 offset:29856
    v_mfma_f32_16x16x32_bf16 v[164:167], a[84:87], a[36:39], v[164:167]
    ds_read_b64_tr_b16 a[146:147], v12 offset:31648
    v_mfma_f32_16x16x32_bf16 v[160:163], a[84:87], a[32:35], v[160:163]
    s_add_u32 m0, s85, 68608
    v_mfma_f32_16x16x32_bf16 v[176:179], a[88:91], a[32:35], v[176:179]
    ds_read_b64_tr_b16 a[148:149], v12 offset:29888
    v_mfma_f32_16x16x32_bf16 v[180:183], a[88:91], a[36:39], v[180:183]
    ds_read_b64_tr_b16 a[150:151], v12 offset:31680
    v_mfma_f32_16x16x32_bf16 v[184:187], a[88:91], a[40:43], v[184:187]
    s_mov_b64 exec, s[86:87]
    buffer_load_dwordx4 v7, s[56:59], s82 offen lds
    s_mov_b64 exec, -1
    s_add_u32 s82, s82, 458752
    v_mfma_f32_16x16x32_bf16 v[188:191], a[88:91], a[44:47], v[188:191]
    v_mfma_f32_16x16x32_bf16 v[204:207], a[92:95], a[44:47], v[204:207]
    buffer_load_dwordx4 a[28:31], v2, s[44:47], s80 offen offset:3072 sc1
    s_add_u32 s80, s80, 131072
    v_mfma_f32_16x16x32_bf16 v[200:203], a[92:95], a[40:43], v[200:203]
    v_mfma_f32_16x16x32_bf16 v[196:199], a[92:95], a[36:39], v[196:199]
    v_mfma_f32_16x16x32_bf16 v[192:195], a[92:95], a[32:35], v[192:195]
    v_mfma_f32_16x16x32_bf16 v[208:211], a[96:99], a[32:35], v[208:211]
    v_mfma_f32_16x16x32_bf16 v[212:215], a[96:99], a[36:39], v[212:215]
    v_mfma_f32_16x16x32_bf16 v[216:219], a[96:99], a[40:43], v[216:219]
    v_mfma_f32_16x16x32_bf16 v[220:223], a[96:99], a[44:47], v[220:223]
    v_mfma_f32_16x16x32_bf16 v[236:239], a[100:103], a[44:47], v[236:239]
    v_mfma_f32_16x16x32_bf16 v[232:235], a[100:103], a[40:43], v[232:235]
    v_mfma_f32_16x16x32_bf16 v[228:231], a[100:103], a[36:39], v[228:231]
    v_mfma_f32_16x16x32_bf16 v[224:227], a[100:103], a[32:35], v[224:227]
    v_mfma_f32_16x16x32_bf16 v[240:243], a[104:107], a[32:35], v[240:243]
    v_mfma_f32_16x16x32_bf16 v[244:247], a[104:107], a[36:39], v[244:247]
    v_mfma_f32_16x16x32_bf16 v[248:251], a[104:107], a[40:43], v[248:251]
    v_mfma_f32_16x16x32_bf16 v[252:255], a[104:107], a[44:47], v[252:255]
    s_waitcnt vmcnt(16)
    s_barrier
    s_waitcnt vmcnt(15) lgkmcnt(0)
    v_mfma_f32_16x16x32_bf16 v[80:83], a[48:51], a[108:111], v[80:83]
    ds_read_b128 a[64:67], v10 offset:0
    v_mfma_f32_16x16x32_bf16 v[84:87], a[52:55], a[108:111], v[84:87]
    ds_read_b128 a[68:71], v10 offset:2048
    v_mfma_f32_16x16x32_bf16 v[88:91], a[56:59], a[108:111], v[88:91]
    buffer_load_dwordx4 a[32:35], v2, s[44:47], s80 offen offset:0 sc1
    v_mfma_f32_16x16x32_bf16 v[92:95], a[60:63], a[108:111], v[92:95]
    ds_read_b128 a[72:75], v10 offset:4096
    v_mfma_f32_16x16x32_bf16 v[108:111], a[60:63], a[112:115], v[108:111]
    ds_read_b128 a[76:79], v10 offset:6144
    v_mfma_f32_16x16x32_bf16 v[104:107], a[56:59], a[112:115], v[104:107]
    v_and_b32 v75, 31, v1
    s_mov_b32 s13, 40042496
    v_mfma_f32_16x16x32_bf16 v[100:103], a[52:55], a[112:115], v[100:103]
    ds_read_b64_tr_b16 a[80:81], v13 offset:0
    v_mfma_f32_16x16x32_bf16 v[96:99], a[48:51], a[112:115], v[96:99]
    ds_read_b64_tr_b16 a[82:83], v13 offset:1792
    v_mfma_f32_16x16x32_bf16 v[112:115], a[48:51], a[116:119], v[112:115]
    v_lshlrev_b32 v75, 7, v75
    v_mfma_f32_16x16x32_bf16 v[116:119], a[52:55], a[116:119], v[116:119]
    ds_read_b64_tr_b16 a[84:85], v13 offset:32
    v_mfma_f32_16x16x32_bf16 v[120:123], a[56:59], a[116:119], v[120:123]
    ds_read_b64_tr_b16 a[86:87], v13 offset:1824
    v_mfma_f32_16x16x32_bf16 v[124:127], a[60:63], a[116:119], v[124:127]
    buffer_load_dwordx4 a[36:39], v2, s[44:47], s80 offen offset:1024 sc1
    v_mfma_f32_16x16x32_bf16 v[140:143], a[60:63], a[120:123], v[140:143]
    ds_read_b64_tr_b16 a[88:89], v13 offset:64
    v_mfma_f32_16x16x32_bf16 v[136:139], a[56:59], a[120:123], v[136:139]
    ds_read_b64_tr_b16 a[90:91], v13 offset:1856
    v_mfma_f32_16x16x32_bf16 v[132:135], a[52:55], a[120:123], v[132:135]
    s_mov_b32 s52, s28
    v_mfma_f32_16x16x32_bf16 v[128:131], a[48:51], a[120:123], v[128:131]
    ds_read_b64_tr_b16 a[92:93], v13 offset:96
    v_mfma_f32_16x16x32_bf16 v[144:147], a[124:127], a[48:51], v[144:147]
    ds_read_b64_tr_b16 a[94:95], v13 offset:1888
    v_mfma_f32_16x16x32_bf16 v[148:151], a[124:127], a[52:55], v[148:151]
    s_mov_b32 s53, s29
    v_mfma_f32_16x16x32_bf16 v[152:155], a[124:127], a[56:59], v[152:155]
    ds_read_b64_tr_b16 a[96:97], v13 offset:128
    v_mfma_f32_16x16x32_bf16 v[156:159], a[124:127], a[60:63], v[156:159]
    ds_read_b64_tr_b16 a[98:99], v13 offset:1920
    v_mfma_f32_16x16x32_bf16 v[172:175], a[128:131], a[60:63], v[172:175]
    buffer_load_dwordx4 a[40:43], v2, s[44:47], s80 offen offset:2048 sc1
    v_mfma_f32_16x16x32_bf16 v[168:171], a[128:131], a[56:59], v[168:171]
    ds_read_b64_tr_b16 a[100:101], v13 offset:160
    v_mfma_f32_16x16x32_bf16 v[164:167], a[128:131], a[52:55], v[164:167]
    ds_read_b64_tr_b16 a[102:103], v13 offset:1952
    v_mfma_f32_16x16x32_bf16 v[160:163], a[128:131], a[48:51], v[160:163]
    s_mov_b32 s54, 7340032
    buffer_load_dword v74, v75, s[40:43], s13 offen sc1
    v_mfma_f32_16x16x32_bf16 v[176:179], a[132:135], a[48:51], v[176:179]
    ds_read_b64_tr_b16 a[104:105], v13 offset:192
    v_mfma_f32_16x16x32_bf16 v[180:183], a[132:135], a[52:55], v[180:183]
    ds_read_b64_tr_b16 a[106:107], v13 offset:1984
    v_mfma_f32_16x16x32_bf16 v[184:187], a[132:135], a[56:59], v[184:187]
    s_lshl_b32 s83, s38, 12
    v_mfma_f32_16x16x32_bf16 v[188:191], a[132:135], a[60:63], v[188:191]
    s_add_u32 s83, s83, 91136
    v_mfma_f32_16x16x32_bf16 v[204:207], a[136:139], a[60:63], v[204:207]
    buffer_load_dwordx4 a[44:47], v2, s[44:47], s80 offen offset:3072 sc1
    s_add_u32 s80, s80, 131072
    v_mfma_f32_16x16x32_bf16 v[200:203], a[136:139], a[56:59], v[200:203]
    s_lshl_b32 s91, s38, 4
    v_mfma_f32_16x16x32_bf16 v[196:199], a[136:139], a[52:55], v[196:199]
    v_add_u32 v44, s91, v41
    v_lshlrev_b32 v44, 11, v44
    v_mfma_f32_16x16x32_bf16 v[192:195], a[136:139], a[48:51], v[192:195]
    s_lshl_b32 s91, s78, 8
    v_mfma_f32_16x16x32_bf16 v[208:211], a[140:143], a[48:51], v[208:211]
    v_add_u32 v44, s91, v44
    v_mfma_f32_16x16x32_bf16 v[212:215], a[140:143], a[52:55], v[212:215]
    v_lshrrev_b32 v45, 1, v42
    v_mfma_f32_16x16x32_bf16 v[216:219], a[140:143], a[56:59], v[216:219]
    v_xor_b32 v45, v45, v41
    v_lshl_add_u32 v44, v45, 5, v44
    v_mfma_f32_16x16x32_bf16 v[220:223], a[140:143], a[60:63], v[220:223]
    v_and_b32 v45, 1, v42
    v_mfma_f32_16x16x32_bf16 v[236:239], a[144:147], a[60:63], v[236:239]
    v_lshl_add_u32 v3, v45, 4, v44
    v_mfma_f32_16x16x32_bf16 v[232:235], a[144:147], a[56:59], v[232:235]
    v_xor_b32 v4, 128, v3
    v_mfma_f32_16x16x32_bf16 v[228:231], a[144:147], a[52:55], v[228:231]
    v_add_u32 v4, 0x2000, v4
    v_add_u32 v5, 14336, v3
    v_mfma_f32_16x16x32_bf16 v[224:227], a[144:147], a[48:51], v[224:227]
    v_add_u32 v6, 13312, v4
    v_mfma_f32_16x16x32_bf16 v[240:243], a[148:151], a[48:51], v[240:243]
    v_subrev_u32 v4, 1024, v4
    v_mfma_f32_16x16x32_bf16 v[244:247], a[148:151], a[52:55], v[244:247]
    v_lshl_add_u32 v47, v41, 3, s91
    v_mfma_f32_16x16x32_bf16 v[248:251], a[148:151], a[56:59], v[248:251]
    s_cmp_eq_u32 s76, 0
    s_cselect_b32 s82, 0, 1835008
    v_mfma_f32_16x16x32_bf16 v[252:255], a[148:151], a[60:63], v[252:255]
    s_waitcnt vmcnt(12) lgkmcnt(0)
    v_mfma_f32_16x16x32_bf16 v[80:83], a[0:3], a[64:67], v[80:83]
    ds_read_b128 a[108:111], v11 offset:0
    v_mfma_f32_16x16x32_bf16 v[84:87], a[4:7], a[64:67], v[84:87]
    ds_read_b128 a[112:115], v11 offset:2048
    v_mfma_f32_16x16x32_bf16 v[88:91], a[8:11], a[64:67], v[88:91]
    buffer_load_dwordx4 a[48:51], v2, s[44:47], s80 offen offset:0 sc1
    v_mfma_f32_16x16x32_bf16 v[92:95], a[12:15], a[64:67], v[92:95]
    ds_read_b128 a[116:119], v11 offset:4096
    v_mfma_f32_16x16x32_bf16 v[108:111], a[12:15], a[68:71], v[108:111]
    ds_read_b128 a[120:123], v11 offset:6144
    v_mfma_f32_16x16x32_bf16 v[104:107], a[8:11], a[68:71], v[104:107]
    s_add_u32 m0, s83, 0
    s_nop 0
    buffer_load_dwordx4 v3, s[52:55], s82 offen offset:0 lds
    v_mfma_f32_16x16x32_bf16 v[100:103], a[4:7], a[68:71], v[100:103]
    ds_read_b64_tr_b16 a[124:125], v13 offset:7168
    v_mfma_f32_16x16x32_bf16 v[96:99], a[0:3], a[68:71], v[96:99]
    ds_read_b64_tr_b16 a[126:127], v13 offset:8960
    v_mfma_f32_16x16x32_bf16 v[112:115], a[0:3], a[72:75], v[112:115]
    v_mfma_f32_16x16x32_bf16 v[116:119], a[4:7], a[72:75], v[116:119]
    ds_read_b64_tr_b16 a[128:129], v13 offset:7200
    v_mfma_f32_16x16x32_bf16 v[120:123], a[8:11], a[72:75], v[120:123]
    ds_read_b64_tr_b16 a[130:131], v13 offset:8992
    v_mfma_f32_16x16x32_bf16 v[124:127], a[12:15], a[72:75], v[124:127]
    buffer_load_dwordx4 a[52:55], v2, s[44:47], s80 offen offset:1024 sc1
    v_mfma_f32_16x16x32_bf16 v[140:143], a[12:15], a[76:79], v[140:143]
    ds_read_b64_tr_b16 a[132:133], v13 offset:7232
    v_mfma_f32_16x16x32_bf16 v[136:139], a[8:11], a[76:79], v[136:139]
    ds_read_b64_tr_b16 a[134:135], v13 offset:9024
    v_mfma_f32_16x16x32_bf16 v[132:135], a[4:7], a[76:79], v[132:135]
    v_mfma_f32_16x16x32_bf16 v[128:131], a[0:3], a[76:79], v[128:131]
    ds_read_b64_tr_b16 a[136:137], v13 offset:7264
    v_mfma_f32_16x16x32_bf16 v[144:147], a[80:83], a[0:3], v[144:147]
    ds_read_b64_tr_b16 a[138:139], v13 offset:9056
    v_mfma_f32_16x16x32_bf16 v[148:151], a[80:83], a[4:7], v[148:151]
    s_nop 0
    buffer_load_dwordx4 v4, s[52:55], s82 offen offset:1024 lds
    v_mfma_f32_16x16x32_bf16 v[152:155], a[80:83], a[8:11], v[152:155]
    ds_read_b64_tr_b16 a[140:141], v13 offset:7296
    v_mfma_f32_16x16x32_bf16 v[156:159], a[80:83], a[12:15], v[156:159]
    ds_read_b64_tr_b16 a[142:143], v13 offset:9088
    v_mfma_f32_16x16x32_bf16 v[172:175], a[84:87], a[12:15], v[172:175]
    buffer_load_dwordx4 a[56:59], v2, s[44:47], s80 offen offset:2048 sc1
    v_mfma_f32_16x16x32_bf16 v[168:171], a[84:87], a[8:11], v[168:171]
    ds_read_b64_tr_b16 a[144:145], v13 offset:7328
    v_mfma_f32_16x16x32_bf16 v[164:167], a[84:87], a[4:7], v[164:167]
    ds_read_b64_tr_b16 a[146:147], v13 offset:9120
    v_mfma_f32_16x16x32_bf16 v[160:163], a[84:87], a[0:3], v[160:163]
    v_mfma_f32_16x16x32_bf16 v[176:179], a[88:91], a[0:3], v[176:179]
    ds_read_b64_tr_b16 a[148:149], v13 offset:7360
    v_mfma_f32_16x16x32_bf16 v[180:183], a[88:91], a[4:7], v[180:183]
    ds_read_b64_tr_b16 a[150:151], v13 offset:9152
    v_mfma_f32_16x16x32_bf16 v[184:187], a[88:91], a[8:11], v[184:187]
    v_mfma_f32_16x16x32_bf16 v[188:191], a[88:91], a[12:15], v[188:191]
    v_mfma_f32_16x16x32_bf16 v[204:207], a[92:95], a[12:15], v[204:207]
    buffer_load_dwordx4 a[60:63], v2, s[44:47], s80 offen offset:3072 sc1
    s_add_u32 s80, s80, 131072
    v_mfma_f32_16x16x32_bf16 v[200:203], a[92:95], a[8:11], v[200:203]
    s_nop 0
    buffer_load_dwordx4 v5, s[52:55], s82 offen offset:2048 lds
    v_mfma_f32_16x16x32_bf16 v[196:199], a[92:95], a[4:7], v[196:199]
    v_mfma_f32_16x16x32_bf16 v[192:195], a[92:95], a[0:3], v[192:195]
    v_mfma_f32_16x16x32_bf16 v[208:211], a[96:99], a[0:3], v[208:211]
    s_nop 0
    buffer_load_dwordx4 v6, s[52:55], s82 offen offset:3072 lds
    s_add_u32 s82, s82, 131072
    v_mfma_f32_16x16x32_bf16 v[212:215], a[96:99], a[4:7], v[212:215]
    v_mfma_f32_16x16x32_bf16 v[216:219], a[96:99], a[8:11], v[216:219]
    v_mfma_f32_16x16x32_bf16 v[220:223], a[96:99], a[12:15], v[220:223]
    v_mfma_f32_16x16x32_bf16 v[236:239], a[100:103], a[12:15], v[236:239]
    s_cmp_eq_u32 s76, 0
    s_cselect_b32 s93, s20, s30
    s_cselect_b32 s94, s21, s31
    v_mfma_f32_16x16x32_bf16 v[232:235], a[100:103], a[8:11], v[232:235]
    v_mfma_f32_16x16x32_bf16 v[228:231], a[100:103], a[4:7], v[228:231]
    v_mfma_f32_16x16x32_bf16 v[224:227], a[100:103], a[0:3], v[224:227]
    s_mov_b32 s20, s93
    s_mov_b32 s21, s94
    v_mfma_f32_16x16x32_bf16 v[240:243], a[104:107], a[0:3], v[240:243]
    v_mfma_f32_16x16x32_bf16 v[244:247], a[104:107], a[4:7], v[244:247]
    v_mfma_f32_16x16x32_bf16 v[248:251], a[104:107], a[8:11], v[248:251]
    v_mfma_f32_16x16x32_bf16 v[252:255], a[104:107], a[12:15], v[252:255]
    s_waitcnt vmcnt(14)
    s_barrier
    s_waitcnt vmcnt(13) lgkmcnt(0)
    s_waitcnt vmcnt(9)
    s_mov_b32 s95, 1048576
L_pollK:
    v_cmp_gt_u32 vcc, 8, v74
    s_sub_u32 s95, s95, 1
    s_cselect_b64 vcc, 0, vcc
    s_cbranch_vccz L_gotK
    buffer_load_dword v74, v75, s[40:43], s13 offen sc1
    s_waitcnt vmcnt(0)
    s_branch L_pollK
L_gotK:
    v_mfma_f32_16x16x32_bf16 v[80:83], a[16:19], a[108:111], v[80:83]
    ds_read_b128 a[64:67], v10 offset:22528
    v_mfma_f32_16x16x32_bf16 v[84:87], a[20:23], a[108:111], v[84:87]
    ds_read_b128 a[68:71], v10 offset:24576
    v_mfma_f32_16x16x32_bf16 v[88:91], a[24:27], a[108:111], v[88:91]
    s_add_u32 m0, s83, 16384
    s_nop 0
    buffer_load_dwordx4 v3, s[52:55], s82 offen offset:0 lds
    v_mfma_f32_16x16x32_bf16 v[92:95], a[28:31], a[108:111], v[92:95]
    ds_read_b128 a[72:75], v10 offset:26624
    v_mfma_f32_16x16x32_bf16 v[108:111], a[28:31], a[112:115], v[108:111]
    ds_read_b128 a[76:79], v10 offset:28672
    v_mfma_f32_16x16x32_bf16 v[104:107], a[24:27], a[112:115], v[104:107]
    s_nop 0
    buffer_load_dwordx4 v4, s[52:55], s82 offen offset:1024 lds
    v_mfma_f32_16x16x32_bf16 v[100:103], a[20:23], a[112:115], v[100:103]
    ds_read_b64_tr_b16 a[80:81], v13 offset:22528
    v_mfma_f32_16x16x32_bf16 v[96:99], a[16:19], a[112:115], v[96:99]
    ds_read_b64_tr_b16 a[82:83], v13 offset:24320
    v_mfma_f32_16x16x32_bf16 v[112:115], a[16:19], a[116:119], v[112:115]
    s_nop 0
    buffer_load_dwordx4 v5, s[52:55], s82 offen offset:2048 lds
    v_mfma_f32_16x16x32_bf16 v[116:119], a[20:23], a[116:119], v[116:119]
    ds_read_b64_tr_b16 a[84:85], v13 offset:22560
    v_mfma_f32_16x16x32_bf16 v[120:123], a[24:27], a[116:119], v[120:123]
    ds_read_b64_tr_b16 a[86:87], v13 offset:24352
    v_mfma_f32_16x16x32_bf16 v[124:127], a[28:31], a[116:119], v[124:127]
    v_mfma_f32_16x16x32_bf16 v[140:143], a[28:31], a[120:123], v[140:143]
    ds_read_b64_tr_b16 a[88:89], v13 offset:22592
    v_mfma_f32_16x16x32_bf16 v[136:139], a[24:27], a[120:123], v[136:139]
    ds_read_b64_tr_b16 a[90:91], v13 offset:24384
    v_mfma_f32_16x16x32_bf16 v[132:135], a[20:23], a[120:123], v[132:135]
    s_nop 0
    buffer_load_dwordx4 v6, s[52:55], s82 offen offset:3072 lds
    s_add_u32 s82, s82, 131072
    v_mfma_f32_16x16x32_bf16 v[128:131], a[16:19], a[120:123], v[128:131]
    ds_read_b64_tr_b16 a[92:93], v13 offset:22624
    v_mfma_f32_16x16x32_bf16 v[144:147], a[124:127], a[16:19], v[144:147]
    ds_read_b64_tr_b16 a[94:95], v13 offset:24416
    v_mfma_f32_16x16x32_bf16 v[148:151], a[124:127], a[20:23], v[148:151]
    s_lshl_b32 s93, s77, 13
    v_mfma_f32_16x16x32_bf16 v[152:155], a[124:127], a[24:27], v[152:155]
    ds_read_b64_tr_b16 a[96:97], v13 offset:22656
    v_mfma_f32_16x16x32_bf16 v[156:159], a[124:127], a[28:31], v[156:159]
    ds_read_b64_tr_b16 a[98:99], v13 offset:24448
    v_mfma_f32_16x16x32_bf16 v[172:175], a[128:131], a[28:31], v[172:175]
    s_lshl_b32 s94, s38, 11
    v_mfma_f32_16x16x32_bf16 v[168:171], a[128:131], a[24:27], v[168:171]
    ds_read_b64_tr_b16 a[100:101], v13 offset:22688
    v_mfma_f32_16x16x32_bf16 v[164:167], a[128:131], a[20:23], v[164:167]
    ds_read_b64_tr_b16 a[102:103], v13 offset:24480
    v_mfma_f32_16x16x32_bf16 v[160:163], a[128:131], a[16:19], v[160:163]
    v_mfma_f32_16x16x32_bf16 v[176:179], a[132:135], a[16:19], v[176:179]
    ds_read_b64_tr_b16 a[104:105], v13 offset:22720
    v_mfma_f32_16x16x32_bf16 v[180:183], a[132:135], a[20:23], v[180:183]
    ds_read_b64_tr_b16 a[106:107], v13 offset:24512
    v_mfma_f32_16x16x32_bf16 v[184:187], a[132:135], a[24:27], v[184:187]
    s_add_u32 s93, s93, s94
    v_mfma_f32_16x16x32_bf16 v[188:191], a[132:135], a[28:31], v[188:191]
    s_lshl_b32 s94, s78, 19
    v_mfma_f32_16x16x32_bf16 v[204:207], a[136:139], a[28:31], v[204:207]
    v_mfma_f32_16x16x32_bf16 v[200:203], a[136:139], a[24:27], v[200:203]
    s_add_u32 s93, s93, s94
    v_mfma_f32_16x16x32_bf16 v[196:199], a[136:139], a[20:23], v[196:199]
    v_lshrrev_b32 v46, 1, v41
    v_mfma_f32_16x16x32_bf16 v[192:195], a[136:139], a[16:19], v[192:195]
    v_lshl_add_u32 v46, v46, 4, v42
    v_mfma_f32_16x16x32_bf16 v[208:211], a[140:143], a[16:19], v[208:211]
    v_mfma_f32_16x16x32_bf16 v[212:215], a[140:143], a[20:23], v[212:215]
    v_lshlrev_b32 v46, 4, v46
    v_mfma_f32_16x16x32_bf16 v[216:219], a[140:143], a[24:27], v[216:219]
    v_and_b32 v44, 1, v41
    v_mfma_f32_16x16x32_bf16 v[220:223], a[140:143], a[28:31], v[220:223]
    v_mfma_f32_16x16x32_bf16 v[236:239], a[144:147], a[28:31], v[236:239]
    v_lshl_add_u32 v46, v44, 3, v46
    v_mfma_f32_16x16x32_bf16 v[232:235], a[144:147], a[24:27], v[232:235]
    v_add_u32 v46, s93, v46
    v_mfma_f32_16x16x32_bf16 v[228:231], a[144:147], a[20:23], v[228:231]
    s_cmp_eq_u32 s76, 0
    s_cselect_b32 s46, 0x400000, 0
    v_mfma_f32_16x16x32_bf16 v[224:227], a[144:147], a[16:19], v[224:227]
    v_mfma_f32_16x16x32_bf16 v[240:243], a[148:151], a[16:19], v[240:243]
    s_mov_b32 s93, 0x20000
    s_mov_b32 s94, 0x40000
    v_mfma_f32_16x16x32_bf16 v[244:247], a[148:151], a[20:23], v[244:247]
    s_mov_b32 s95, 0x60000
    v_mfma_f32_16x16x32_bf16 v[248:251], a[148:151], a[24:27], v[248:251]
    v_mfma_f32_16x16x32_bf16 v[252:255], a[148:151], a[28:31], v[252:255]
    s_waitcnt vmcnt(12) lgkmcnt(0)
    v_mfma_f32_16x16x32_bf16 v[80:83], a[32:35], a[64:67], v[80:83]
    ds_read_b128 a[108:111], v11 offset:22528
    v_mfma_f32_16x16x32_bf16 v[84:87], a[36:39], a[64:67], v[84:87]
    ds_read_b128 a[112:115], v11 offset:24576
    v_mfma_f32_16x16x32_bf16 v[88:91], a[40:43], a[64:67], v[88:91]
    s_add_u32 m0, s83, 32768
    s_nop 0
    buffer_load_dwordx4 v3, s[52:55], s82 offen offset:0 lds
    v_mfma_f32_16x16x32_bf16 v[92:95], a[44:47], a[64:67], v[92:95]
    ds_read_b128 a[116:119], v11 offset:26624
    v_mfma_f32_16x16x32_bf16 v[108:111], a[44:47], a[68:71], v[108:111]
    ds_read_b128 a[120:123], v11 offset:28672
    v_mfma_f32_16x16x32_bf16 v[104:107], a[40:43], a[68:71], v[104:107]
    v_mfma_f32_16x16x32_bf16 v[100:103], a[36:39], a[68:71], v[100:103]
    ds_read_b64_tr_b16 a[124:125], v13 offset:29696
    v_mfma_f32_16x16x32_bf16 v[96:99], a[32:35], a[68:71], v[96:99]
    ds_read_b64_tr_b16 a[126:127], v13 offset:31488
    v_mfma_f32_16x16x32_bf16 v[112:115], a[32:35], a[72:75], v[112:115]
    s_nop 0
    buffer_load_dwordx4 v4, s[52:55], s82 offen offset:1024 lds
    v_mfma_f32_16x16x32_bf16 v[116:119], a[36:39], a[72:75], v[116:119]
    ds_read_b64_tr_b16 a[128:129], v13 offset:29728
    v_mfma_f32_16x16x32_bf16 v[120:123], a[40:43], a[72:75], v[120:123]
    ds_read_b64_tr_b16 a[130:131], v13 offset:31520
    v_mfma_f32_16x16x32_bf16 v[124:127], a[44:47], a[72:75], v[124:127]
    v_mfma_f32_16x16x32_bf16 v[140:143], a[44:47], a[76:79], v[140:143]
    ds_read_b64_tr_b16 a[132:133], v13 offset:29760
    v_mfma_f32_16x16x32_bf16 v[136:139], a[40:43], a[76:79], v[136:139]
    ds_read_b64_tr_b16 a[134:135], v13 offset:31552
    v_mfma_f32_16x16x32_bf16 v[132:135], a[36:39], a[76:79], v[132:135]
    v_mfma_f32_16x16x32_bf16 v[128:131], a[32:35], a[76:79], v[128:131]
    ds_read_b64_tr_b16 a[136:137], v13 offset:29792
    v_mfma_f32_16x16x32_bf16 v[144:147], a[80:83], a[32:35], v[144:147]
    ds_read_b64_tr_b16 a[138:139], v13 offset:31584
    v_mfma_f32_16x16x32_bf16 v[148:151], a[80:83], a[36:39], v[148:151]
    global_load_dwordx2 a[184:185], v47, s[20:21] offset:0
    v_mfma_f32_16x16x32_bf16 v[152:155], a[80:83], a[40:43], v[152:155]
    ds_read_b64_tr_b16 a[140:141], v13 offset:29824
    v_mfma_f32_16x16x32_bf16 v[156:159], a[80:83], a[44:47], v[156:159]
    ds_read_b64_tr_b16 a[142:143], v13 offset:31616
    v_mfma_f32_16x16x32_bf16 v[172:175], a[84:87], a[44:47], v[172:175]
    v_mfma_f32_16x16x32_bf16 v[168:171], a[84:87], a[40:43], v[168:171]
    ds_read_b64_tr_b16 a[144:145], v13 offset:29856
    v_mfma_f32_16x16x32_bf16 v[164:167], a[84:87], a[36:39], v[164:167]
    ds_read_b64_tr_b16 a[146:147], v13 offset:31648
    v_mfma_f32_16x16x32_bf16 v[160:163], a[84:87], a[32:35], v[160:163]
    global_load_dwordx2 a[186:187], v47, s[20:21] offset:32
    v_mfma_f32_16x16x32_bf16 v[176:179], a[88:91], a[32:35], v[176:179]
    ds_read_b64_tr_b16 a[148:149], v13 offset:29888
    v_mfma_f32_16x16x32_bf16 v[180:183], a[88:91], a[36:39], v[180:183]
    ds_read_b64_tr_b16 a[150:151], v13 offset:31680
    v_mfma_f32_16x16x32_bf16 v[184:187], a[88:91], a[40:43], v[184:187]
    v_mfma_f32_16x16x32_bf16 v[188:191], a[88:91], a[44:47], v[188:191]
    v_mfma_f32_16x16x32_bf16 v[204:207], a[92:95], a[44:47], v[204:207]
    global_load_dwordx2 a[188:189], v47, s[20:21] offset:64
    v_mfma_f32_16x16x32_bf16 v[200:203], a[92:95], a[40:43], v[200:203]
    v_mfma_f32_16x16x32_bf16 v[196:199], a[92:95], a[36:39], v[196:199]
    global_load_dwordx2 a[190:191], v47, s[20:21] offset:96
    v_mfma_f32_16x16x32_bf16 v[192:195], a[92:95], a[32:35], v[192:195]
    v_mfma_f32_16x16x32_bf16 v[208:211], a[96:99], a[32:35], v[208:211]
    v_mfma_f32_16x16x32_bf16 v[212:215], a[96:99], a[36:39], v[212:215]
    global_load_dwordx2 a[192:193], v47, s[20:21] offset:128
    v_mfma_f32_16x16x32_bf16 v[216:219], a[96:99], a[40:43], v[216:219]
    v_mfma_f32_16x16x32_bf16 v[220:223], a[96:99], a[44:47], v[220:223]
    global_load_dwordx2 a[194:195], v47, s[20:21] offset:160
    v_mfma_f32_16x16x32_bf16 v[236:239], a[100:103], a[44:47], v[236:239]
    v_mfma_f32_16x16x32_bf16 v[232:235], a[100:103], a[40:43], v[232:235]
    v_mfma_f32_16x16x32_bf16 v[228:231], a[100:103], a[36:39], v[228:231]
    global_load_dwordx2 a[196:197], v47, s[20:21] offset:192
    v_mfma_f32_16x16x32_bf16 v[224:227], a[100:103], a[32:35], v[224:227]
    v_mfma_f32_16x16x32_bf16 v[240:243], a[104:107], a[32:35], v[240:243]
    global_load_dwordx2 a[198:199], v47, s[20:21] offset:224
    v_mfma_f32_16x16x32_bf16 v[244:247], a[104:107], a[36:39], v[244:247]
    v_mfma_f32_16x16x32_bf16 v[248:251], a[104:107], a[40:43], v[248:251]
    v_mfma_f32_16x16x32_bf16 v[252:255], a[104:107], a[44:47], v[252:255]
    s_waitcnt vmcnt(16) lgkmcnt(0)
    v_mfma_f32_16x16x32_bf16 v[80:83], a[48:51], a[108:111], v[80:83]
    buffer_load_dwordx2 a[152:153], v46, s[44:47], 0 offen offset:0 sc1
    v_mfma_f32_16x16x32_bf16 v[84:87], a[52:55], a[108:111], v[84:87]
    v_mfma_f32_16x16x32_bf16 v[88:91], a[56:59], a[108:111], v[88:91]
    buffer_load_dwordx2 a[154:155], v46, s[44:47], 0 offen offset:1024 sc1
    v_mfma_f32_16x16x32_bf16 v[92:95], a[60:63], a[108:111], v[92:95]
    v_mfma_f32_16x16x32_bf16 v[108:111], a[60:63], a[112:115], v[108:111]
    v_mfma_f32_16x16x32_bf16 v[104:107], a[56:59], a[112:115], v[104:107]
    buffer_load_dwordx2 a[156:157], v46, s[44:47], 0 offen offset:512 sc1
    v_mfma_f32_16x16x32_bf16 v[100:103], a[52:55], a[112:115], v[100:103]
    v_mfma_f32_16x16x32_bf16 v[96:99], a[48:51], a[112:115], v[96:99]
    v_mfma_f32_16x16x32_bf16 v[112:115], a[48:51], a[116:119], v[112:115]
    buffer_load_dwordx2 a[158:159], v46, s[44:47], 0 offen offset:1536 sc1
    v_mfma_f32_16x16x32_bf16 v[116:119], a[52:55], a[116:119], v[116:119]
    v_mfma_f32_16x16x32_bf16 v[120:123], a[56:59], a[116:119], v[120:123]
    buffer_load_dwordx2 a[160:161], v46, s[44:47], s93 offen offset:0 sc1
    v_mfma_f32_16x16x32_bf16 v[124:127], a[60:63], a[116:119], v[124:127]
    v_mfma_f32_16x16x32_bf16 v[140:143], a[60:63], a[120:123], v[140:143]
    v_mfma_f32_16x16x32_bf16 v[136:139], a[56:59], a[120:123], v[136:139]
    buffer_load_dwordx2 a[162:163], v46, s[44:47], s93 offen offset:1024 sc1
    v_mfma_f32_16x16x32_bf16 v[132:135], a[52:55], a[120:123], v[132:135]
    v_mfma_f32_16x16x32_bf16 v[128:131], a[48:51], a[120:123], v[128:131]
    v_mfma_f32_16x16x32_bf16 v[144:147], a[124:127], a[48:51], v[144:147]
    buffer_load_dwordx2 a[164:165], v46, s[44:47], s93 offen offset:512 sc1
    v_mfma_f32_16x16x32_bf16 v[148:151], a[124:127], a[52:55], v[148:151]
    v_mfma_f32_16x16x32_bf16 v[152:155], a[124:127], a[56:59], v[152:155]
    buffer_load_dwordx2 a[166:167], v46, s[44:47], s93 offen offset:1536 sc1
    v_mfma_f32_16x16x32_bf16 v[156:159], a[124:127], a[60:63], v[156:159]
    v_mfma_f32_16x16x32_bf16 v[172:175], a[128:131], a[60:63], v[172:175]
    v_mfma_f32_16x16x32_bf16 v[168:171], a[128:131], a[56:59], v[168:171]
    buffer_load_dwordx2 a[168:169], v46, s[44:47], s94 offen offset:0 sc1
    v_mfma_f32_16x16x32_bf16 v[164:167], a[128:131], a[52:55], v[164:167]
    v_mfma_f32_16x16x32_bf16 v[160:163], a[128:131], a[48:51], v[160:163]
    v_mfma_f32_16x16x32_bf16 v[176:179], a[132:135], a[48:51], v[176:179]
    buffer_load_dwordx2 a[170:171], v46, s[44:47], s94 offen offset:1024 sc1
    v_mfma_f32_16x16x32_bf16 v[180:183], a[132:135], a[52:55], v[180:183]
    v_mfma_f32_16x16x32_bf16 v[184:187], a[132:135], a[56:59], v[184:187]
    buffer_load_dwordx2 a[172:173], v46, s[44:47], s94 offen offset:512 sc1
    v_mfma_f32_16x16x32_bf16 v[188:191], a[132:135], a[60:63], v[188:191]
    v_mfma_f32_16x16x32_bf16 v[204:207], a[136:139], a[60:63], v[204:207]
    v_mfma_f32_16x16x32_bf16 v[200:203], a[136:139], a[56:59], v[200:203]
    buffer_load_dwordx2 a[174:175], v46, s[44:47], s94 offen offset:1536 sc1
    v_mfma_f32_16x16x32_bf16 v[196:199], a[136:139], a[52:55], v[196:199]
    v_mfma_f32_16x16x32_bf16 v[192:195], a[136:139], a[48:51], v[192:195]
    v_mfma_f32_16x16x32_bf16 v[208:211], a[140:143], a[48:51], v[208:211]
    buffer_load_dwordx2 a[176:177], v46, s[44:47], s95 offen offset:0 sc1
    v_mfma_f32_16x16x32_bf16 v[212:215], a[140:143], a[52:55], v[212:215]
    v_mfma_f32_16x16x32_bf16 v[216:219], a[140:143], a[56:59], v[216:219]
    buffer_load_dwordx2 a[178:179], v46, s[44:47], s95 offen offset:1024 sc1
    v_mfma_f32_16x16x32_bf16 v[220:223], a[140:143], a[60:63], v[220:223]
    v_mfma_f32_16x16x32_bf16 v[236:239], a[144:147], a[60:63], v[236:239]
    v_mfma_f32_16x16x32_bf16 v[232:235], a[144:147], a[56:59], v[232:235]
    buffer_load_dwordx2 a[180:181], v46, s[44:47], s95 offen offset:512 sc1
    v_mfma_f32_16x16x32_bf16 v[228:231], a[144:147], a[52:55], v[228:231]
    v_mfma_f32_16x16x32_bf16 v[224:227], a[144:147], a[48:51], v[224:227]
    v_mfma_f32_16x16x32_bf16 v[240:243], a[148:151], a[48:51], v[240:243]
    buffer_load_dwordx2 a[182:183], v46, s[44:47], s95 offen offset:1536 sc1
    v_mfma_f32_16x16x32_bf16 v[244:247], a[148:151], a[52:55], v[244:247]
    v_mfma_f32_16x16x32_bf16 v[248:251], a[148:151], a[56:59], v[248:251]
    v_mfma_f32_16x16x32_bf16 v[252:255], a[148:151], a[60:63], v[252:255]
L_pfc_b:
    s_mov_b32 s84, 0xc0135761
    s_mov_b32 s85, 0xbdd2d3e8
    v_lshlrev_b32 v78, 4, v41
    s_lshl_b32 s91, s38, 10
    s_add_u32 s91, s91, 156928
    v_lshlrev_b32 v76, 8, v41
    ds_read_b128 v[56:59], v78 offset:0
    v_lshl_add_u32 v76, v42, 3, v76
    v_add_u32 v76, s91, v76
    v_and_b32 v77, 31, v1
    v_lshlrev_b32 v77, 3, v77
    v_add_u32 v40, 156928, v77
    s_mul_i32 s86, s73, 7
    s_add_u32 s86, s86, s75
    s_lshr_b32 s86, s86, 1
    s_add_u32 s94, s86, 67
    s_add_u32 s95, s86, 63
    s_cmp_eq_u32 s75, 0
    s_cselect_b32 s87, s94, s95
    s_lshl_b32 s87, s87, 17
    s_add_u32 s86, s86, 64
    s_lshl_b32 s86, s86, 17
    s_lshl_b32 s95, s75, 3
    v_add_u32 v0, s95, v2
    v_pk_mul_f32 v[44:45], v[80:81], v[20:21] op_sel:[0,1] op_sel_hi:[1,1]
    v_pk_mul_f32 v[80:81], v[80:81], v[20:21] op_sel_hi:[1,0]
    v_pk_fma_f32 v[80:81], v[112:113], v[20:21], v[80:81] op_sel:[0,1,0] op_sel_hi:[1,1,1] neg_lo:[0,1,0] neg_hi:[0,1,0]
    v_pk_fma_f32 v[112:113], v[112:113], v[20:21], v[44:45] op_sel_hi:[1,0,1]
    v_pk_mul_f32 v[46:47], v[82:83], v[20:21] op_sel:[0,1] op_sel_hi:[1,1]
    v_pk_mul_f32 v[82:83], v[82:83], v[20:21] op_sel_hi:[1,0]
    v_pk_fma_f32 v[82:83], v[114:115], v[20:21], v[82:83] op_sel:[0,1,0] op_sel_hi:[1,1,1] neg_lo:[0,1,0] neg_hi:[0,1,0]
    v_pk_fma_f32 v[114:115], v[114:115], v[20:21], v[46:47] op_sel_hi:[1,0,1]
    v_pk_mul_f32 v[44:45], v[84:85], v[20:21] op_sel:[0,1] op_sel_hi:[1,1]
    v_pk_mul_f32 v[84:85], v[84:85], v[20:21] op_sel_hi:[1,0]
    v_pk_fma_f32 v[84:85], v[116:117], v[20:21], v[84:85] op_sel:[0,1,0] op_sel_hi:[1,1,1] neg_lo:[0,1,0] neg_hi:[0,1,0]
    v_pk_fma_f32 v[116:117], v[116:117], v[20:21], v[44:45] op_sel_hi:[1,0,1]
    v_pk_mul_f32 v[46:47], v[86:87], v[20:21] op_sel:[0,1] op_sel_hi:[1,1]
    v_pk_mul_f32 v[86:87], v[86:87], v[20:21] op_sel_hi:[1,0]
    v_pk_fma_f32 v[86:87], v[118:119], v[20:21], v[86:87] op_sel:[0,1,0] op_sel_hi:[1,1,1] neg_lo:[0,1,0] neg_hi:[0,1,0]
    v_pk_fma_f32 v[118:119], v[118:119], v[20:21], v[46:47] op_sel_hi:[1,0,1]
    v_pk_mul_f32 v[44:45], v[88:89], v[20:21] op_sel:[0,1] op_sel_hi:[1,1]
    v_pk_mul_f32 v[88:89], v[88:89], v[20:21] op_sel_hi:[1,0]
    v_pk_fma_f32 v[88:89], v[120:121], v[20:21], v[88:89] op_sel:[0,1,0] op_sel_hi:[1,1,1] neg_lo:[0,1,0] neg_hi:[0,1,0]
    v_pk_fma_f32 v[120:121], v[120:121], v[20:21], v[44:45] op_sel_hi:[1,0,1]
    v_pk_mul_f32 v[46:47], v[90:91], v[20:21] op_sel:[0,1] op_sel_hi:[1,1]
    v_pk_mul_f32 v[90:91], v[90:91], v[20:21] op_sel_hi:[1,0]
    v_pk_fma_f32 v[90:91], v[122:123], v[20:21], v[90:91] op_sel:[0,1,0] op_sel_hi:[1,1,1] neg_lo:[0,1,0] neg_hi:[0,1,0]
    v_pk_fma_f32 v[122:123], v[122:123], v[20:21], v[46:47] op_sel_hi:[1,0,1]
    v_pk_mul_f32 v[44:45], v[92:93], v[20:21] op_sel:[0,1] op_sel_hi:[1,1]
    v_pk_mul_f32 v[92:93], v[92:93], v[20:21] op_sel_hi:[1,0]
    v_pk_fma_f32 v[92:93], v[124:125], v[20:21], v[92:93] op_sel:[0,1,0] op_sel_hi:[1,1,1] neg_lo:[0,1,0] neg_hi:[0,1,0]
    v_pk_fma_f32 v[124:125], v[124:125], v[20:21], v[44:45] op_sel_hi:[1,0,1]
    v_pk_mul_f32 v[46:47], v[94:95], v[20:21] op_sel:[0,1] op_sel_hi:[1,1]
    v_pk_mul_f32 v[94:95], v[94:95], v[20:21] op_sel_hi:[1,0]
    v_pk_fma_f32 v[94:95], v[126:127], v[20:21], v[94:95] op_sel:[0,1,0] op_sel_hi:[1,1,1] neg_lo:[0,1,0] neg_hi:[0,1,0]
    v_pk_fma_f32 v[126:127], v[126:127], v[20:21], v[46:47] op_sel_hi:[1,0,1]
    v_pk_mul_f32 v[44:45], v[96:97], v[22:23] op_sel:[0,1] op_sel_hi:[1,1]
    v_pk_mul_f32 v[96:97], v[96:97], v[22:23] op_sel_hi:[1,0]
    v_pk_fma_f32 v[96:97], v[128:129], v[22:23], v[96:97] op_sel:[0,1,0] op_sel_hi:[1,1,1] neg_lo:[0,1,0] neg_hi:[0,1,0]
    v_pk_fma_f32 v[128:129], v[128:129], v[22:23], v[44:45] op_sel_hi:[1,0,1]
    v_pk_mul_f32 v[46:47], v[98:99], v[22:23] op_sel:[0,1] op_sel_hi:[1,1]
    v_pk_mul_f32 v[98:99], v[98:99], v[22:23] op_sel_hi:[1,0]
    v_pk_fma_f32 v[98:99], v[130:131], v[22:23], v[98:99] op_sel:[0,1,0] op_sel_hi:[1,1,1] neg_lo:[0,1,0] neg_hi:[0,1,0]
    v_pk_fma_f32 v[130:131], v[130:131], v[22:23], v[46:47] op_sel_hi:[1,0,1]
    v_pk_mul_f32 v[44:45], v[100:101], v[22:23] op_sel:[0,1] op_sel_hi:[1,1]
    v_pk_mul_f32 v[100:101], v[100:101], v[22:23] op_sel_hi:[1,0]
    v_pk_fma_f32 v[100:101], v[132:133], v[22:23], v[100:101] op_sel:[0,1,0] op_sel_hi:[1,1,1] neg_lo:[0,1,0] neg_hi:[0,1,0]
    v_pk_fma_f32 v[132:133], v[132:133], v[22:23], v[44:45] op_sel_hi:[1,0,1]
    v_pk_mul_f32 v[46:47], v[102:103], v[22:23] op_sel:[0,1] op_sel_hi:[1,1]
    v_pk_mul_f32 v[102:103], v[102:103], v[22:23] op_sel_hi:[1,0]
    v_pk_fma_f32 v[102:103], v[134:135], v[22:23], v[102:103] op_sel:[0,1,0] op_sel_hi:[1,1,1] neg_lo:[0,1,0] neg_hi:[0,1,0]
    v_pk_fma_f32 v[134:135], v[134:135], v[22:23], v[46:47] op_sel_hi:[1,0,1]
    v_pk_mul_f32 v[44:45], v[104:105], v[22:23] op_sel:[0,1] op_sel_hi:[1,1]
    v_pk_mul_f32 v[104:105], v[104:105], v[22:23] op_sel_hi:[1,0]
    v_pk_fma_f32 v[104:105], v[136:137], v[22:23], v[104:105] op_sel:[0,1,0] op_sel_hi:[1,1,1] neg_lo:[0,1,0] neg_hi:[0,1,0]
    v_pk_fma_f32 v[136:137], v[136:137], v[22:23], v[44:45] op_sel_hi:[1,0,1]
    v_pk_mul_f32 v[46:47], v[106:107], v[22:23] op_sel:[0,1] op_sel_hi:[1,1]
    v_pk_mul_f32 v[106:107], v[106:107], v[22:23] op_sel_hi:[1,0]
    v_pk_fma_f32 v[106:107], v[138:139], v[22:23], v[106:107] op_sel:[0,1,0] op_sel_hi:[1,1,1] neg_lo:[0,1,0] neg_hi:[0,1,0]
    v_pk_fma_f32 v[138:139], v[138:139], v[22:23], v[46:47] op_sel_hi:[1,0,1]
    v_pk_mul_f32 v[44:45], v[108:109], v[22:23] op_sel:[0,1] op_sel_hi:[1,1]
    v_pk_mul_f32 v[108:109], v[108:109], v[22:23] op_sel_hi:[1,0]
    v_pk_fma_f32 v[108:109], v[140:141], v[22:23], v[108:109] op_sel:[0,1,0] op_sel_hi:[1,1,1] neg_lo:[0,1,0] neg_hi:[0,1,0]
    v_pk_fma_f32 v[140:141], v[140:141], v[22:23], v[44:45] op_sel_hi:[1,0,1]
    v_pk_mul_f32 v[46:47], v[110:111], v[22:23] op_sel:[0,1] op_sel_hi:[1,1]
    v_pk_mul_f32 v[110:111], v[110:111], v[22:23] op_sel_hi:[1,0]
    v_pk_fma_f32 v[110:111], v[142:143], v[22:23], v[110:111] op_sel:[0,1,0] op_sel_hi:[1,1,1] neg_lo:[0,1,0] neg_hi:[0,1,0]
    v_pk_fma_f32 v[142:143], v[142:143], v[22:23], v[46:47] op_sel_hi:[1,0,1]
    v_fma_f32 v46, v14, v80, v81
    v_fma_f32 v47, v14, v112, v113
    v_fma_f32 v50, v17, v96, v97
    v_fma_f32 v51, v17, v128, v129
    v_fmac_f32 v46, v16, v112
    v_fmac_f32 v47, v15, v80
    v_fmac_f32 v50, v19, v128
    v_fmac_f32 v51, v18, v96
    v_fma_f32 v44, v14, v46, v82
    v_fma_f32 v45, v14, v47, v114
    v_fma_f32 v48, v17, v50, v98
    v_fma_f32 v49, v17, v51, v130
    v_fmac_f32 v44, v16, v47
    v_fmac_f32 v45, v15, v46
    v_fmac_f32 v48, v19, v51
    v_fmac_f32 v49, v18, v50
    v_fma_f32 v46, v14, v44, v83
    v_fma_f32 v47, v14, v45, v115
    v_fma_f32 v50, v17, v48, v99
    v_fma_f32 v51, v17, v49, v131
    v_fmac_f32 v46, v16, v45
    v_fmac_f32 v47, v15, v44
    v_fmac_f32 v50, v19, v49
    v_fmac_f32 v51, v18, v48
    v_fma_f32 v44, v14, v46, v84
    v_fma_f32 v45, v14, v47, v116
    v_fma_f32 v48, v17, v50, v100
    v_fma_f32 v49, v17, v51, v132
    v_fmac_f32 v44, v16, v47
    v_fmac_f32 v45, v15, v46
    v_fmac_f32 v48, v19, v51
    v_fmac_f32 v49, v18, v50
    v_fma_f32 v46, v14, v44, v85
    v_fma_f32 v47, v14, v45, v117
    v_fma_f32 v50, v17, v48, v101
    v_fma_f32 v51, v17, v49, v133
    v_fmac_f32 v46, v16, v45
    v_fmac_f32 v47, v15, v44
    v_fmac_f32 v50, v19, v49
    v_fmac_f32 v51, v18, v48
    v_fma_f32 v44, v14, v46, v86
    v_fma_f32 v45, v14, v47, v118
    v_fma_f32 v48, v17, v50, v102
    v_fma_f32 v49, v17, v51, v134
    v_fmac_f32 v44, v16, v47
    v_fmac_f32 v45, v15, v46
    v_fmac_f32 v48, v19, v51
    v_fmac_f32 v49, v18, v50
    v_fma_f32 v46, v14, v44, v87
    v_fma_f32 v47, v14, v45, v119
    v_fma_f32 v50, v17, v48, v103
    v_fma_f32 v51, v17, v49, v135
    v_fmac_f32 v46, v16, v45
    v_fmac_f32 v47, v15, v44
    v_fmac_f32 v50, v19, v49
    v_fmac_f32 v51, v18, v48
    v_fma_f32 v44, v14, v46, v88
    v_fma_f32 v45, v14, v47, v120
    v_fma_f32 v48, v17, v50, v104
    v_fma_f32 v49, v17, v51, v136
    v_fmac_f32 v44, v16, v47
    v_fmac_f32 v45, v15, v46
    v_fmac_f32 v48, v19, v51
    v_fmac_f32 v49, v18, v50
    v_fma_f32 v46, v14, v44, v89
    v_fma_f32 v47, v14, v45, v121
    v_fma_f32 v50, v17, v48, v105
    v_fma_f32 v51, v17, v49, v137
    v_fmac_f32 v46, v16, v45
    v_fmac_f32 v47, v15, v44
    v_fmac_f32 v50, v19, v49
    v_fmac_f32 v51, v18, v48
    v_fma_f32 v44, v14, v46, v90
    v_fma_f32 v45, v14, v47, v122
    v_fma_f32 v48, v17, v50, v106
    v_fma_f32 v49, v17, v51, v138
    v_fmac_f32 v44, v16, v47
    v_fmac_f32 v45, v15, v46
    v_fmac_f32 v48, v19, v51
    v_fmac_f32 v49, v18, v50
    v_fma_f32 v46, v14, v44, v91
    v_fma_f32 v47, v14, v45, v123
    v_fma_f32 v50, v17, v48, v107
    v_fma_f32 v51, v17, v49, v139
    v_fmac_f32 v46, v16, v45
    v_fmac_f32 v47, v15, v44
    v_fmac_f32 v50, v19, v49
    v_fmac_f32 v51, v18, v48
    v_fma_f32 v44, v14, v46, v92
    v_fma_f32 v45, v14, v47, v124
    v_fma_f32 v48, v17, v50, v108
    v_fma_f32 v49, v17, v51, v140
    v_fmac_f32 v44, v16, v47
    v_fmac_f32 v45, v15, v46
    v_fmac_f32 v48, v19, v51
    v_fmac_f32 v49, v18, v50
    v_fma_f32 v46, v14, v44, v93
    v_fma_f32 v47, v14, v45, v125
    v_fma_f32 v50, v17, v48, v109
    v_fma_f32 v51, v17, v49, v141
    v_fmac_f32 v46, v16, v45
    v_fmac_f32 v47, v15, v44
    v_fmac_f32 v50, v19, v49
    v_fmac_f32 v51, v18, v48
    v_fma_f32 v44, v14, v46, v94
    v_fma_f32 v45, v14, v47, v126
    v_fma_f32 v48, v17, v50, v110
    v_fma_f32 v49, v17, v51, v142
    v_fmac_f32 v44, v16, v47
    v_fmac_f32 v45, v15, v46
    v_fmac_f32 v48, v19, v51
    v_fmac_f32 v49, v18, v50
    v_fma_f32 v46, v14, v44, v95
    v_fma_f32 v47, v14, v45, v127
    v_fma_f32 v50, v17, v48, v111
    v_fma_f32 v51, v17, v49, v143
    v_fmac_f32 v46, v16, v45
    v_fmac_f32 v47, v15, v44
    v_fmac_f32 v50, v19, v49
    v_fmac_f32 v51, v18, v48
    ds_write_b64 v76, v[46:47]
    ds_write_b64 v76, v[50:51] offset:128
    s_waitcnt lgkmcnt(0)
    s_barrier
    s_add_u32 s64, s36, 0x2610000
    s_addc_u32 s65, s37, 0
    s_mov_b32 s66, 0x10000
    s_mov_b32 s67, 0x20000
    s_cmp_lg_u32 s38, 0
    s_cbranch_scc1 L_nopub
    ds_read_b64 v[60:61], v40 offset:0
    ds_read_b64 v[62:63], v40 offset:256
    ds_read_b64 v[64:65], v40 offset:512
    ds_read_b64 v[66:67], v40 offset:768
    ds_read_b64 v[68:69], v40 offset:1024
    ds_read_b64 v[70:71], v40 offset:1280
    ds_read_b64 v[72:73], v40 offset:1536
    ds_read_b64 v[74:75], v40 offset:1792
    ds_read_b64 v[44:45], v40 offset:2048
    ds_read_b64 v[46:47], v40 offset:2304
    ds_read_b64 v[48:49], v40 offset:2560
    ds_read_b64 v[50:51], v40 offset:2816
    ds_read_b64 v[52:53], v40 offset:3072
    ds_read_b64 v[54:55], v40 offset:3328
    ds_read_b64 v[12:13], v40 offset:3584
    ds_read_b64 v[30:31], v40 offset:3840
    s_waitcnt lgkmcnt(0)
    v_fmac_f32 v62, v24, v60
    v_fmac_f32 v63, v24, v61
    v_fmac_f32 v62, v26, v61
    v_fmac_f32 v63, v25, v60
    v_fmac_f32 v64, v24, v62
    v_fmac_f32 v65, v24, v63
    v_fmac_f32 v64, v26, v63
    v_fmac_f32 v65, v25, v62
    v_fmac_f32 v66, v24, v64
    v_fmac_f32 v67, v24, v65
    v_fmac_f32 v66, v26, v65
    v_fmac_f32 v67, v25, v64
    v_fmac_f32 v68, v24, v66
    v_fmac_f32 v69, v24, v67
    v_fmac_f32 v68, v26, v67
    v_fmac_f32 v69, v25, v66
    v_fmac_f32 v70, v24, v68
    v_fmac_f32 v71, v24, v69
    v_fmac_f32 v70, v26, v69
    v_fmac_f32 v71, v25, v68
    v_fmac_f32 v72, v24, v70
    v_fmac_f32 v73, v24, v71
    v_fmac_f32 v72, v26, v71
    v_fmac_f32 v73, v25, v70
    v_fmac_f32 v74, v24, v72
    v_fmac_f32 v75, v24, v73
    v_fmac_f32 v74, v26, v73
    v_fmac_f32 v75, v25, v72
    v_fmac_f32 v44, v24, v74
    v_fmac_f32 v45, v24, v75
    v_fmac_f32 v44, v26, v75
    v_fmac_f32 v45, v25, v74
    v_fmac_f32 v46, v24, v44
    v_fmac_f32 v47, v24, v45
    v_fmac_f32 v46, v26, v45
    v_fmac_f32 v47, v25, v44
    v_fmac_f32 v48, v24, v46
    v_fmac_f32 v49, v24, v47
    v_fmac_f32 v48, v26, v47
    v_fmac_f32 v49, v25, v46
    v_fmac_f32 v50, v24, v48
    v_fmac_f32 v51, v24, v49
    v_fmac_f32 v50, v26, v49
    v_fmac_f32 v51, v25, v48
    v_fmac_f32 v52, v24, v50
    v_fmac_f32 v53, v24, v51
    v_fmac_f32 v52, v26, v51
    v_fmac_f32 v53, v25, v50
    v_fmac_f32 v54, v24, v52
    v_fmac_f32 v55, v24, v53
    v_fmac_f32 v54, v26, v53
    v_fmac_f32 v55, v25, v52
    v_fmac_f32 v12, v24, v54
    v_fmac_f32 v13, v24, v55
    v_fmac_f32 v12, v26, v55
    v_fmac_f32 v13, v25, v54
    v_fmac_f32 v30, v24, v12
    v_fmac_f32 v31, v24, v13
    v_fmac_f32 v30, v26, v13
    v_fmac_f32 v31, v25, v12
    s_lshl_b32 s91, s73, 3
    s_add_u32 s91, s91, s72
    s_lshl_b32 s91, s91, 8
    v_mov_b32 v43, 0x7fc00000
    v_cmp_eq_u32 vcc, -1, v30
    v_cmp_eq_u32 s[22:23], -1, v31
    s_nop 1
    v_cndmask_b32 v30, v30, v43, vcc
    v_cndmask_b32 v31, v31, v43, s[22:23]
    s_mov_b32 exec_hi, 0
    buffer_store_dwordx2 v[30:31], v77, s[64:67], s91 offen sc1
    s_mov_b32 exec_hi, -1
    s_nop 0
L_nopub:
    s_waitcnt lgkmcnt(0)
    ds_read_b128 v[52:55], v78 offset:64
    v_pk_fma_f32 v[144:145], v[144:145], v[32:33], v[56:57] op_sel_hi:[1,0,1]
    v_pk_fma_f32 v[146:147], v[146:147], v[32:33], v[58:59] op_sel_hi:[1,0,1]
    v_pk_fma_f32 v[148:149], v[148:149], v[32:33], v[56:57] op_sel:[0,1,0] op_sel_hi:[1,1,1]
    v_pk_fma_f32 v[150:151], v[150:151], v[32:33], v[58:59] op_sel:[0,1,0] op_sel_hi:[1,1,1]
    v_pk_mul_f32 v[44:45], v[144:145], v[144:145]
    v_pk_mul_f32 v[46:47], v[146:147], v[146:147]
    v_pk_mul_f32 v[48:49], v[148:149], v[148:149]
    v_pk_mul_f32 v[50:51], v[150:151], v[150:151]
    v_pk_fma_f32 v[44:45], v[44:45], s[84:85], s[84:85] op_sel:[0,1,0] op_sel_hi:[1,1,0]
    v_pk_fma_f32 v[46:47], v[46:47], s[84:85], s[84:85] op_sel:[0,1,0] op_sel_hi:[1,1,0]
    v_pk_fma_f32 v[48:49], v[48:49], s[84:85], s[84:85] op_sel:[0,1,0] op_sel_hi:[1,1,0]
    v_pk_fma_f32 v[50:51], v[50:51], s[84:85], s[84:85] op_sel:[0,1,0] op_sel_hi:[1,1,0]
    v_pk_mul_f32 v[44:45], v[44:45], v[144:145]
    v_pk_mul_f32 v[46:47], v[46:47], v[146:147]
    v_pk_mul_f32 v[48:49], v[48:49], v[148:149]
    v_pk_mul_f32 v[50:51], v[50:51], v[150:151]
    v_exp_f32 v44, v44
    v_exp_f32 v45, v45
    v_exp_f32 v46, v46
    v_exp_f32 v47, v47
    v_exp_f32 v48, v48
    v_exp_f32 v49, v49
    v_exp_f32 v50, v50
    v_exp_f32 v51, v51
    v_pk_add_f32 v[44:45], v[44:45], 1.0 op_sel_hi:[1,0]
    v_pk_add_f32 v[46:47], v[46:47], 1.0 op_sel_hi:[1,0]
    v_pk_add_f32 v[48:49], v[48:49], 1.0 op_sel_hi:[1,0]
    v_pk_add_f32 v[50:51], v[50:51], 1.0 op_sel_hi:[1,0]
    v_rcp_f32 v44, v44
    v_rcp_f32 v45, v45
    v_rcp_f32 v46, v46
    v_rcp_f32 v47, v47
    v_rcp_f32 v48, v48
    v_rcp_f32 v49, v49
    v_rcp_f32 v50, v50
    v_rcp_f32 v51, v51
    v_pk_mul_f32 v[144:145], v[144:145], v[44:45]
    v_pk_mul_f32 v[146:147], v[146:147], v[46:47]
    v_pk_mul_f32 v[148:149], v[148:149], v[48:49]
    v_pk_mul_f32 v[150:151], v[150:151], v[50:51]
    v_cvt_pk_bf16_f32 v144, v144, v145
    v_cvt_pk_bf16_f32 v145, v146, v147
    v_cvt_pk_bf16_f32 v148, v148, v149
    v_cvt_pk_bf16_f32 v149, v150, v151
    v_pk_fma_f32 v[152:153], v[152:153], v[34:35], v[56:57] op_sel_hi:[1,0,1]
    v_pk_fma_f32 v[154:155], v[154:155], v[34:35], v[58:59] op_sel_hi:[1,0,1]
    v_pk_fma_f32 v[156:157], v[156:157], v[34:35], v[56:57] op_sel:[0,1,0] op_sel_hi:[1,1,1]
    v_pk_fma_f32 v[158:159], v[158:159], v[34:35], v[58:59] op_sel:[0,1,0] op_sel_hi:[1,1,1]
    v_pk_mul_f32 v[44:45], v[152:153], v[152:153]
    v_pk_mul_f32 v[46:47], v[154:155], v[154:155]
    v_pk_mul_f32 v[48:49], v[156:157], v[156:157]
    v_pk_mul_f32 v[50:51], v[158:159], v[158:159]
    v_pk_fma_f32 v[44:45], v[44:45], s[84:85], s[84:85] op_sel:[0,1,0] op_sel_hi:[1,1,0]
    v_pk_fma_f32 v[46:47], v[46:47], s[84:85], s[84:85] op_sel:[0,1,0] op_sel_hi:[1,1,0]
    v_pk_fma_f32 v[48:49], v[48:49], s[84:85], s[84:85] op_sel:[0,1,0] op_sel_hi:[1,1,0]
    v_pk_fma_f32 v[50:51], v[50:51], s[84:85], s[84:85] op_sel:[0,1,0] op_sel_hi:[1,1,0]
    v_pk_mul_f32 v[44:45], v[44:45], v[152:153]
    v_pk_mul_f32 v[46:47], v[46:47], v[154:155]
    v_pk_mul_f32 v[48:49], v[48:49], v[156:157]
    v_pk_mul_f32 v[50:51], v[50:51], v[158:159]
    v_exp_f32 v44, v44
    v_exp_f32 v45, v45
    v_exp_f32 v46, v46
    v_exp_f32 v47, v47
    v_exp_f32 v48, v48
    v_exp_f32 v49, v49
    v_exp_f32 v50, v50
    v_exp_f32 v51, v51
    v_pk_add_f32 v[44:45], v[44:45], 1.0 op_sel_hi:[1,0]
    v_pk_add_f32 v[46:47], v[46:47], 1.0 op_sel_hi:[1,0]
    v_pk_add_f32 v[48:49], v[48:49], 1.0 op_sel_hi:[1,0]
    v_pk_add_f32 v[50:51], v[50:51], 1.0 op_sel_hi:[1,0]
    v_rcp_f32 v44, v44
    v_rcp_f32 v45, v45
    v_rcp_f32 v46, v46
    v_rcp_f32 v47, v47
    v_rcp_f32 v48, v48
    v_rcp_f32 v49, v49
    v_rcp_f32 v50, v50
    v_rcp_f32 v51, v51
    v_pk_mul_f32 v[152:153], v[152:153], v[44:45]
    v_pk_mul_f32 v[154:155], v[154:155], v[46:47]
    v_pk_mul_f32 v[156:157], v[156:157], v[48:49]
    v_pk_mul_f32 v[158:159], v[158:159], v[50:51]
    v_cvt_pk_bf16_f32 v152, v152, v153
    v_cvt_pk_bf16_f32 v153, v154, v155
    v_cvt_pk_bf16_f32 v156, v156, v157
    v_cvt_pk_bf16_f32 v157, v158, v159
    s_waitcnt lgkmcnt(0)
    ds_read_b128 v[56:59], v78 offset:128
    v_pk_fma_f32 v[160:161], v[160:161], v[32:33], v[52:53] op_sel_hi:[1,0,1]
    v_pk_fma_f32 v[162:163], v[162:163], v[32:33], v[54:55] op_sel_hi:[1,0,1]
    v_pk_fma_f32 v[164:165], v[164:165], v[32:33], v[52:53] op_sel:[0,1,0] op_sel_hi:[1,1,1]
    v_pk_fma_f32 v[166:167], v[166:167], v[32:33], v[54:55] op_sel:[0,1,0] op_sel_hi:[1,1,1]
    v_pk_mul_f32 v[44:45], v[160:161], v[160:161]
    v_pk_mul_f32 v[46:47], v[162:163], v[162:163]
    v_pk_mul_f32 v[48:49], v[164:165], v[164:165]
    v_pk_mul_f32 v[50:51], v[166:167], v[166:167]
    v_pk_fma_f32 v[44:45], v[44:45], s[84:85], s[84:85] op_sel:[0,1,0] op_sel_hi:[1,1,0]
    v_pk_fma_f32 v[46:47], v[46:47], s[84:85], s[84:85] op_sel:[0,1,0] op_sel_hi:[1,1,0]
    v_pk_fma_f32 v[48:49], v[48:49], s[84:85], s[84:85] op_sel:[0,1,0] op_sel_hi:[1,1,0]
    v_pk_fma_f32 v[50:51], v[50:51], s[84:85], s[84:85] op_sel:[0,1,0] op_sel_hi:[1,1,0]
    v_pk_mul_f32 v[44:45], v[44:45], v[160:161]
    v_pk_mul_f32 v[46:47], v[46:47], v[162:163]
    v_pk_mul_f32 v[48:49], v[48:49], v[164:165]
    v_pk_mul_f32 v[50:51], v[50:51], v[166:167]
    v_exp_f32 v44, v44
    v_exp_f32 v45, v45
    v_exp_f32 v46, v46
    v_exp_f32 v47, v47
    v_exp_f32 v48, v48
    v_exp_f32 v49, v49
    v_exp_f32 v50, v50
    v_exp_f32 v51, v51
    v_pk_add_f32 v[44:45], v[44:45], 1.0 op_sel_hi:[1,0]
    v_pk_add_f32 v[46:47], v[46:47], 1.0 op_sel_hi:[1,0]
    v_pk_add_f32 v[48:49], v[48:49], 1.0 op_sel_hi:[1,0]
    v_pk_add_f32 v[50:51], v[50:51], 1.0 op_sel_hi:[1,0]
    v_rcp_f32 v44, v44
    v_rcp_f32 v45, v45
    v_rcp_f32 v46, v46
    v_rcp_f32 v47, v47
    v_rcp_f32 v48, v48
    v_rcp_f32 v49, v49
    v_rcp_f32 v50, v50
    v_rcp_f32 v51, v51
    v_pk_mul_f32 v[160:161], v[160:161], v[44:45]
    v_pk_mul_f32 v[162:163], v[162:163], v[46:47]
    v_pk_mul_f32 v[164:165], v[164:165], v[48:49]
    v_pk_mul_f32 v[166:167], v[166:167], v[50:51]
    v_cvt_pk_bf16_f32 v146, v160, v161
    v_cvt_pk_bf16_f32 v147, v162, v163
    v_cvt_pk_bf16_f32 v150, v164, v165
    v_cvt_pk_bf16_f32 v151, v166, v167
    buffer_store_dwordx4 v[144:147], v2, s[60:63], s86 offen offset:0 sc1
    buffer_store_dwordx4 v[148:151], v2, s[60:63], s86 offen offset:1024 sc1
    v_pk_fma_f32 v[168:169], v[168:169], v[34:35], v[52:53] op_sel_hi:[1,0,1]
    v_pk_fma_f32 v[170:171], v[170:171], v[34:35], v[54:55] op_sel_hi:[1,0,1]
    v_pk_fma_f32 v[172:173], v[172:173], v[34:35], v[52:53] op_sel:[0,1,0] op_sel_hi:[1,1,1]
    v_pk_fma_f32 v[174:175], v[174:175], v[34:35], v[54:55] op_sel:[0,1,0] op_sel_hi:[1,1,1]
    v_pk_mul_f32 v[44:45], v[168:169], v[168:169]
    v_pk_mul_f32 v[46:47], v[170:171], v[170:171]
    v_pk_mul_f32 v[48:49], v[172:173], v[172:173]
    v_pk_mul_f32 v[50:51], v[174:175], v[174:175]
    v_pk_fma_f32 v[44:45], v[44:45], s[84:85], s[84:85] op_sel:[0,1,0] op_sel_hi:[1,1,0]
    v_pk_fma_f32 v[46:47], v[46:47], s[84:85], s[84:85] op_sel:[0,1,0] op_sel_hi:[1,1,0]
    v_pk_fma_f32 v[48:49], v[48:49], s[84:85], s[84:85] op_sel:[0,1,0] op_sel_hi:[1,1,0]
    v_pk_fma_f32 v[50:51], v[50:51], s[84:85], s[84:85] op_sel:[0,1,0] op_sel_hi:[1,1,0]
    v_pk_mul_f32 v[44:45], v[44:45], v[168:169]
    v_pk_mul_f32 v[46:47], v[46:47], v[170:171]
    v_pk_mul_f32 v[48:49], v[48:49], v[172:173]
    v_pk_mul_f32 v[50:51], v[50:51], v[174:175]
    v_exp_f32 v44, v44
    v_exp_f32 v45, v45
    v_exp_f32 v46, v46
    v_exp_f32 v47, v47
    v_exp_f32 v48, v48
    v_exp_f32 v49, v49
    v_exp_f32 v50, v50
    v_exp_f32 v51, v51
    v_pk_add_f32 v[44:45], v[44:45], 1.0 op_sel_hi:[1,0]
    v_pk_add_f32 v[46:47], v[46:47], 1.0 op_sel_hi:[1,0]
    v_pk_add_f32 v[48:49], v[48:49], 1.0 op_sel_hi:[1,0]
    v_pk_add_f32 v[50:51], v[50:51], 1.0 op_sel_hi:[1,0]
    v_rcp_f32 v44, v44
    v_rcp_f32 v45, v45
    v_rcp_f32 v46, v46
    v_rcp_f32 v47, v47
    v_rcp_f32 v48, v48
    v_rcp_f32 v49, v49
    v_rcp_f32 v50, v50
    v_rcp_f32 v51, v51
    v_pk_mul_f32 v[168:169], v[168:169], v[44:45]
    v_pk_mul_f32 v[170:171], v[170:171], v[46:47]
    v_pk_mul_f32 v[172:173], v[172:173], v[48:49]
    v_pk_mul_f32 v[174:175], v[174:175], v[50:51]
    v_cvt_pk_bf16_f32 v154, v168, v169
    v_cvt_pk_bf16_f32 v155, v170, v171
    v_cvt_pk_bf16_f32 v158, v172, v173
    v_cvt_pk_bf16_f32 v159, v174, v175
    buffer_store_dwordx4 v[152:155], v2, s[60:63], s86 offen offset:2048 sc1
    buffer_store_dwordx4 v[156:159], v2, s[60:63], s86 offen offset:3072 sc1
    s_add_u32 s86, s86, 131072
    s_waitcnt lgkmcnt(0)
    ds_read_b128 v[52:55], v78 offset:192
    v_pk_fma_f32 v[176:177], v[176:177], v[32:33], v[56:57] op_sel_hi:[1,0,1]
    v_pk_fma_f32 v[178:179], v[178:179], v[32:33], v[58:59] op_sel_hi:[1,0,1]
    v_pk_fma_f32 v[180:181], v[180:181], v[32:33], v[56:57] op_sel:[0,1,0] op_sel_hi:[1,1,1]
    v_pk_fma_f32 v[182:183], v[182:183], v[32:33], v[58:59] op_sel:[0,1,0] op_sel_hi:[1,1,1]
    v_pk_mul_f32 v[44:45], v[176:177], v[176:177]
    v_pk_mul_f32 v[46:47], v[178:179], v[178:179]
    v_pk_mul_f32 v[48:49], v[180:181], v[180:181]
    v_pk_mul_f32 v[50:51], v[182:183], v[182:183]
    v_pk_fma_f32 v[44:45], v[44:45], s[84:85], s[84:85] op_sel:[0,1,0] op_sel_hi:[1,1,0]
    v_pk_fma_f32 v[46:47], v[46:47], s[84:85], s[84:85] op_sel:[0,1,0] op_sel_hi:[1,1,0]
    v_pk_fma_f32 v[48:49], v[48:49], s[84:85], s[84:85] op_sel:[0,1,0] op_sel_hi:[1,1,0]
    v_pk_fma_f32 v[50:51], v[50:51], s[84:85], s[84:85] op_sel:[0,1,0] op_sel_hi:[1,1,0]
    v_pk_mul_f32 v[44:45], v[44:45], v[176:177]
    v_pk_mul_f32 v[46:47], v[46:47], v[178:179]
    v_pk_mul_f32 v[48:49], v[48:49], v[180:181]
    v_pk_mul_f32 v[50:51], v[50:51], v[182:183]
    v_exp_f32 v44, v44
    v_exp_f32 v45, v45
    v_exp_f32 v46, v46
    v_exp_f32 v47, v47
    v_exp_f32 v48, v48
    v_exp_f32 v49, v49
    v_exp_f32 v50, v50
    v_exp_f32 v51, v51
    v_pk_add_f32 v[44:45], v[44:45], 1.0 op_sel_hi:[1,0]
    v_pk_add_f32 v[46:47], v[46:47], 1.0 op_sel_hi:[1,0]
    v_pk_add_f32 v[48:49], v[48:49], 1.0 op_sel_hi:[1,0]
    v_pk_add_f32 v[50:51], v[50:51], 1.0 op_sel_hi:[1,0]
    v_rcp_f32 v44, v44
    v_rcp_f32 v45, v45
    v_rcp_f32 v46, v46
    v_rcp_f32 v47, v47
    v_rcp_f32 v48, v48
    v_rcp_f32 v49, v49
    v_rcp_f32 v50, v50
    v_rcp_f32 v51, v51
    v_pk_mul_f32 v[176:177], v[176:177], v[44:45]
    v_pk_mul_f32 v[178:179], v[178:179], v[46:47]
    v_pk_mul_f32 v[180:181], v[180:181], v[48:49]
    v_pk_mul_f32 v[182:183], v[182:183], v[50:51]
    v_cvt_pk_bf16_f32 v176, v176, v177
    v_cvt_pk_bf16_f32 v177, v178, v179
    v_cvt_pk_bf16_f32 v180, v180, v181
    v_cvt_pk_bf16_f32 v181, v182, v183
    v_pk_fma_f32 v[184:185], v[184:185], v[34:35], v[56:57] op_sel_hi:[1,0,1]
    v_pk_fma_f32 v[186:187], v[186:187], v[34:35], v[58:59] op_sel_hi:[1,0,1]
    v_pk_fma_f32 v[188:189], v[188:189], v[34:35], v[56:57] op_sel:[0,1,0] op_sel_hi:[1,1,1]
    v_pk_fma_f32 v[190:191], v[190:191], v[34:35], v[58:59] op_sel:[0,1,0] op_sel_hi:[1,1,1]
    v_pk_mul_f32 v[44:45], v[184:185], v[184:185]
    v_pk_mul_f32 v[46:47], v[186:187], v[186:187]
    v_pk_mul_f32 v[48:49], v[188:189], v[188:189]
    v_pk_mul_f32 v[50:51], v[190:191], v[190:191]
    v_pk_fma_f32 v[44:45], v[44:45], s[84:85], s[84:85] op_sel:[0,1,0] op_sel_hi:[1,1,0]
    v_pk_fma_f32 v[46:47], v[46:47], s[84:85], s[84:85] op_sel:[0,1,0] op_sel_hi:[1,1,0]
    v_pk_fma_f32 v[48:49], v[48:49], s[84:85], s[84:85] op_sel:[0,1,0] op_sel_hi:[1,1,0]
    v_pk_fma_f32 v[50:51], v[50:51], s[84:85], s[84:85] op_sel:[0,1,0] op_sel_hi:[1,1,0]
    v_pk_mul_f32 v[44:45], v[44:45], v[184:185]
    v_pk_mul_f32 v[46:47], v[46:47], v[186:187]
    v_pk_mul_f32 v[48:49], v[48:49], v[188:189]
    v_pk_mul_f32 v[50:51], v[50:51], v[190:191]
    v_exp_f32 v44, v44
    v_exp_f32 v45, v45
    v_exp_f32 v46, v46
    v_exp_f32 v47, v47
    v_exp_f32 v48, v48
    v_exp_f32 v49, v49
    v_exp_f32 v50, v50
    v_exp_f32 v51, v51
    v_pk_add_f32 v[44:45], v[44:45], 1.0 op_sel_hi:[1,0]
    v_pk_add_f32 v[46:47], v[46:47], 1.0 op_sel_hi:[1,0]
    v_pk_add_f32 v[48:49], v[48:49], 1.0 op_sel_hi:[1,0]
    v_pk_add_f32 v[50:51], v[50:51], 1.0 op_sel_hi:[1,0]
    v_rcp_f32 v44, v44
    v_rcp_f32 v45, v45
    v_rcp_f32 v46, v46
    v_rcp_f32 v47, v47
    v_rcp_f32 v48, v48
    v_rcp_f32 v49, v49
    v_rcp_f32 v50, v50
    v_rcp_f32 v51, v51
    v_pk_mul_f32 v[184:185], v[184:185], v[44:45]
    v_pk_mul_f32 v[186:187], v[186:187], v[46:47]
    v_pk_mul_f32 v[188:189], v[188:189], v[48:49]
    v_pk_mul_f32 v[190:191], v[190:191], v[50:51]
    v_cvt_pk_bf16_f32 v184, v184, v185
    v_cvt_pk_bf16_f32 v185, v186, v187
    v_cvt_pk_bf16_f32 v188, v188, v189
    v_cvt_pk_bf16_f32 v189, v190, v191
    s_waitcnt lgkmcnt(0)
    ds_read_b128 v[56:59], v78 offset:256
    v_pk_fma_f32 v[192:193], v[192:193], v[32:33], v[52:53] op_sel_hi:[1,0,1]
    v_pk_fma_f32 v[194:195], v[194:195], v[32:33], v[54:55] op_sel_hi:[1,0,1]
    v_pk_fma_f32 v[196:197], v[196:197], v[32:33], v[52:53] op_sel:[0,1,0] op_sel_hi:[1,1,1]
    v_pk_fma_f32 v[198:199], v[198:199], v[32:33], v[54:55] op_sel:[0,1,0] op_sel_hi:[1,1,1]
    v_pk_mul_f32 v[44:45], v[192:193], v[192:193]
    v_pk_mul_f32 v[46:47], v[194:195], v[194:195]
    v_pk_mul_f32 v[48:49], v[196:197], v[196:197]
    v_pk_mul_f32 v[50:51], v[198:199], v[198:199]
    v_pk_fma_f32 v[44:45], v[44:45], s[84:85], s[84:85] op_sel:[0,1,0] op_sel_hi:[1,1,0]
    v_pk_fma_f32 v[46:47], v[46:47], s[84:85], s[84:85] op_sel:[0,1,0] op_sel_hi:[1,1,0]
    v_pk_fma_f32 v[48:49], v[48:49], s[84:85], s[84:85] op_sel:[0,1,0] op_sel_hi:[1,1,0]
    v_pk_fma_f32 v[50:51], v[50:51], s[84:85], s[84:85] op_sel:[0,1,0] op_sel_hi:[1,1,0]
    v_pk_mul_f32 v[44:45], v[44:45], v[192:193]
    v_pk_mul_f32 v[46:47], v[46:47], v[194:195]
    v_pk_mul_f32 v[48:49], v[48:49], v[196:197]
    v_pk_mul_f32 v[50:51], v[50:51], v[198:199]
    v_exp_f32 v44, v44
    v_exp_f32 v45, v45
    v_exp_f32 v46, v46
    v_exp_f32 v47, v47
    v_exp_f32 v48, v48
    v_exp_f32 v49, v49
    v_exp_f32 v50, v50
    v_exp_f32 v51, v51
    v_pk_add_f32 v[44:45], v[44:45], 1.0 op_sel_hi:[1,0]
    v_pk_add_f32 v[46:47], v[46:47], 1.0 op_sel_hi:[1,0]
    v_pk_add_f32 v[48:49], v[48:49], 1.0 op_sel_hi:[1,0]
    v_pk_add_f32 v[50:51], v[50:51], 1.0 op_sel_hi:[1,0]
    v_rcp_f32 v44, v44
    v_rcp_f32 v45, v45
    v_rcp_f32 v46, v46
    v_rcp_f32 v47, v47
    v_rcp_f32 v48, v48
    v_rcp_f32 v49, v49
    v_rcp_f32 v50, v50
    v_rcp_f32 v51, v51
    v_pk_mul_f32 v[192:193], v[192:193], v[44:45]
    v_pk_mul_f32 v[194:195], v[194:195], v[46:47]
    v_pk_mul_f32 v[196:197], v[196:197], v[48:49]
    v_pk_mul_f32 v[198:199], v[198:199], v[50:51]
    v_cvt_pk_bf16_f32 v178, v192, v193
    v_cvt_pk_bf16_f32 v179, v194, v195
    v_cvt_pk_bf16_f32 v182, v196, v197
    v_cvt_pk_bf16_f32 v183, v198, v199
    buffer_store_dwordx4 v[176:179], v2, s[60:63], s86 offen offset:0 sc1
    buffer_store_dwordx4 v[180:183], v2, s[60:63], s86 offen offset:1024 sc1
    v_pk_fma_f32 v[200:201], v[200:201], v[34:35], v[52:53] op_sel_hi:[1,0,1]
    v_pk_fma_f32 v[202:203], v[202:203], v[34:35], v[54:55] op_sel_hi:[1,0,1]
    v_pk_fma_f32 v[204:205], v[204:205], v[34:35], v[52:53] op_sel:[0,1,0] op_sel_hi:[1,1,1]
    v_pk_fma_f32 v[206:207], v[206:207], v[34:35], v[54:55] op_sel:[0,1,0] op_sel_hi:[1,1,1]
    v_pk_mul_f32 v[44:45], v[200:201], v[200:201]
    v_pk_mul_f32 v[46:47], v[202:203], v[202:203]
    v_pk_mul_f32 v[48:49], v[204:205], v[204:205]
    v_pk_mul_f32 v[50:51], v[206:207], v[206:207]
    v_pk_fma_f32 v[44:45], v[44:45], s[84:85], s[84:85] op_sel:[0,1,0] op_sel_hi:[1,1,0]
    v_pk_fma_f32 v[46:47], v[46:47], s[84:85], s[84:85] op_sel:[0,1,0] op_sel_hi:[1,1,0]
    v_pk_fma_f32 v[48:49], v[48:49], s[84:85], s[84:85] op_sel:[0,1,0] op_sel_hi:[1,1,0]
    v_pk_fma_f32 v[50:51], v[50:51], s[84:85], s[84:85] op_sel:[0,1,0] op_sel_hi:[1,1,0]
    v_pk_mul_f32 v[44:45], v[44:45], v[200:201]
    v_pk_mul_f32 v[46:47], v[46:47], v[202:203]
    v_pk_mul_f32 v[48:49], v[48:49], v[204:205]
    v_pk_mul_f32 v[50:51], v[50:51], v[206:207]
    v_exp_f32 v44, v44
    v_exp_f32 v45, v45
    v_exp_f32 v46, v46
    v_exp_f32 v47, v47
    v_exp_f32 v48, v48
    v_exp_f32 v49, v49
    v_exp_f32 v50, v50
    v_exp_f32 v51, v51
    v_pk_add_f32 v[44:45], v[44:45], 1.0 op_sel_hi:[1,0]
    v_pk_add_f32 v[46:47], v[46:47], 1.0 op_sel_hi:[1,0]
    v_pk_add_f32 v[48:49], v[48:49], 1.0 op_sel_hi:[1,0]
    v_pk_add_f32 v[50:51], v[50:51], 1.0 op_sel_hi:[1,0]
    v_rcp_f32 v44, v44
    v_rcp_f32 v45, v45
    v_rcp_f32 v46, v46
    v_rcp_f32 v47, v47
    v_rcp_f32 v48, v48
    v_rcp_f32 v49, v49
    v_rcp_f32 v50, v50
    v_rcp_f32 v51, v51
    v_pk_mul_f32 v[200:201], v[200:201], v[44:45]
    v_pk_mul_f32 v[202:203], v[202:203], v[46:47]
    v_pk_mul_f32 v[204:205], v[204:205], v[48:49]
    v_pk_mul_f32 v[206:207], v[206:207], v[50:51]
    v_cvt_pk_bf16_f32 v186, v200, v201
    v_cvt_pk_bf16_f32 v187, v202, v203
    v_cvt_pk_bf16_f32 v190, v204, v205
    v_cvt_pk_bf16_f32 v191, v206, v207
    buffer_store_dwordx4 v[184:187], v2, s[60:63], s86 offen offset:2048 sc1
    buffer_store_dwordx4 v[188:191], v2, s[60:63], s86 offen offset:3072 sc1
    s_add_u32 s86, s86, 131072
    s_waitcnt lgkmcnt(0)
    ds_read_b128 v[52:55], v78 offset:320
    v_pk_fma_f32 v[208:209], v[208:209], v[32:33], v[56:57] op_sel_hi:[1,0,1]
    v_pk_fma_f32 v[210:211], v[210:211], v[32:33], v[58:59] op_sel_hi:[1,0,1]
    v_pk_fma_f32 v[212:213], v[212:213], v[32:33], v[56:57] op_sel:[0,1,0] op_sel_hi:[1,1,1]
    v_pk_fma_f32 v[214:215], v[214:215], v[32:33], v[58:59] op_sel:[0,1,0] op_sel_hi:[1,1,1]
    v_pk_mul_f32 v[44:45], v[208:209], v[208:209]
    v_pk_mul_f32 v[46:47], v[210:211], v[210:211]
    v_pk_mul_f32 v[48:49], v[212:213], v[212:213]
    v_pk_mul_f32 v[50:51], v[214:215], v[214:215]
    v_pk_fma_f32 v[44:45], v[44:45], s[84:85], s[84:85] op_sel:[0,1,0] op_sel_hi:[1,1,0]
    v_pk_fma_f32 v[46:47], v[46:47], s[84:85], s[84:85] op_sel:[0,1,0] op_sel_hi:[1,1,0]
    v_pk_fma_f32 v[48:49], v[48:49], s[84:85], s[84:85] op_sel:[0,1,0] op_sel_hi:[1,1,0]
    v_pk_fma_f32 v[50:51], v[50:51], s[84:85], s[84:85] op_sel:[0,1,0] op_sel_hi:[1,1,0]
    v_pk_mul_f32 v[44:45], v[44:45], v[208:209]
    v_pk_mul_f32 v[46:47], v[46:47], v[210:211]
    v_pk_mul_f32 v[48:49], v[48:49], v[212:213]
    v_pk_mul_f32 v[50:51], v[50:51], v[214:215]
    v_exp_f32 v44, v44
    v_exp_f32 v45, v45
    v_exp_f32 v46, v46
    v_exp_f32 v47, v47
    v_exp_f32 v48, v48
    v_exp_f32 v49, v49
    v_exp_f32 v50, v50
    v_exp_f32 v51, v51
    v_pk_add_f32 v[44:45], v[44:45], 1.0 op_sel_hi:[1,0]
    v_pk_add_f32 v[46:47], v[46:47], 1.0 op_sel_hi:[1,0]
    v_pk_add_f32 v[48:49], v[48:49], 1.0 op_sel_hi:[1,0]
    v_pk_add_f32 v[50:51], v[50:51], 1.0 op_sel_hi:[1,0]
    v_rcp_f32 v44, v44
    v_rcp_f32 v45, v45
    v_rcp_f32 v46, v46
    v_rcp_f32 v47, v47
    v_rcp_f32 v48, v48
    v_rcp_f32 v49, v49
    v_rcp_f32 v50, v50
    v_rcp_f32 v51, v51
    v_pk_mul_f32 v[208:209], v[208:209], v[44:45]
    v_pk_mul_f32 v[210:211], v[210:211], v[46:47]
    v_pk_mul_f32 v[212:213], v[212:213], v[48:49]
    v_pk_mul_f32 v[214:215], v[214:215], v[50:51]
    v_cvt_pk_bf16_f32 v208, v208, v209
    v_cvt_pk_bf16_f32 v209, v210, v211
    v_cvt_pk_bf16_f32 v212, v212, v213
    v_cvt_pk_bf16_f32 v213, v214, v215
    v_pk_fma_f32 v[216:217], v[216:217], v[34:35], v[56:57] op_sel_hi:[1,0,1]
    v_pk_fma_f32 v[218:219], v[218:219], v[34:35], v[58:59] op_sel_hi:[1,0,1]
    v_pk_fma_f32 v[220:221], v[220:221], v[34:35], v[56:57] op_sel:[0,1,0] op_sel_hi:[1,1,1]
    v_pk_fma_f32 v[222:223], v[222:223], v[34:35], v[58:59] op_sel:[0,1,0] op_sel_hi:[1,1,1]
    v_pk_mul_f32 v[44:45], v[216:217], v[216:217]
    v_pk_mul_f32 v[46:47], v[218:219], v[218:219]
    v_pk_mul_f32 v[48:49], v[220:221], v[220:221]
    v_pk_mul_f32 v[50:51], v[222:223], v[222:223]
    v_pk_fma_f32 v[44:45], v[44:45], s[84:85], s[84:85] op_sel:[0,1,0] op_sel_hi:[1,1,0]
    v_pk_fma_f32 v[46:47], v[46:47], s[84:85], s[84:85] op_sel:[0,1,0] op_sel_hi:[1,1,0]
    v_pk_fma_f32 v[48:49], v[48:49], s[84:85], s[84:85] op_sel:[0,1,0] op_sel_hi:[1,1,0]
    v_pk_fma_f32 v[50:51], v[50:51], s[84:85], s[84:85] op_sel:[0,1,0] op_sel_hi:[1,1,0]
    v_pk_mul_f32 v[44:45], v[44:45], v[216:217]
    v_pk_mul_f32 v[46:47], v[46:47], v[218:219]
    v_pk_mul_f32 v[48:49], v[48:49], v[220:221]
    v_pk_mul_f32 v[50:51], v[50:51], v[222:223]
    v_exp_f32 v44, v44
    v_exp_f32 v45, v45
    v_exp_f32 v46, v46
    v_exp_f32 v47, v47
    v_exp_f32 v48, v48
    v_exp_f32 v49, v49
    v_exp_f32 v50, v50
    v_exp_f32 v51, v51
    v_pk_add_f32 v[44:45], v[44:45], 1.0 op_sel_hi:[1,0]
    v_pk_add_f32 v[46:47], v[46:47], 1.0 op_sel_hi:[1,0]
    v_pk_add_f32 v[48:49], v[48:49], 1.0 op_sel_hi:[1,0]
    v_pk_add_f32 v[50:51], v[50:51], 1.0 op_sel_hi:[1,0]
    v_rcp_f32 v44, v44
    v_rcp_f32 v45, v45
    v_rcp_f32 v46, v46
    v_rcp_f32 v47, v47
    v_rcp_f32 v48, v48
    v_rcp_f32 v49, v49
    v_rcp_f32 v50, v50
    v_rcp_f32 v51, v51
    v_pk_mul_f32 v[216:217], v[216:217], v[44:45]
    v_pk_mul_f32 v[218:219], v[218:219], v[46:47]
    v_pk_mul_f32 v[220:221], v[220:221], v[48:49]
    v_pk_mul_f32 v[222:223], v[222:223], v[50:51]
    v_cvt_pk_bf16_f32 v216, v216, v217
    v_cvt_pk_bf16_f32 v217, v218, v219
    v_cvt_pk_bf16_f32 v220, v220, v221
    v_cvt_pk_bf16_f32 v221, v222, v223
    s_waitcnt lgkmcnt(0)
    ds_read_b128 v[56:59], v78 offset:384
    v_pk_fma_f32 v[224:225], v[224:225], v[32:33], v[52:53] op_sel_hi:[1,0,1]
    v_pk_fma_f32 v[226:227], v[226:227], v[32:33], v[54:55] op_sel_hi:[1,0,1]
    v_pk_fma_f32 v[228:229], v[228:229], v[32:33], v[52:53] op_sel:[0,1,0] op_sel_hi:[1,1,1]
    v_pk_fma_f32 v[230:231], v[230:231], v[32:33], v[54:55] op_sel:[0,1,0] op_sel_hi:[1,1,1]
    v_pk_mul_f32 v[44:45], v[224:225], v[224:225]
    v_pk_mul_f32 v[46:47], v[226:227], v[226:227]
    v_pk_mul_f32 v[48:49], v[228:229], v[228:229]
    v_pk_mul_f32 v[50:51], v[230:231], v[230:231]
    v_pk_fma_f32 v[44:45], v[44:45], s[84:85], s[84:85] op_sel:[0,1,0] op_sel_hi:[1,1,0]
    v_pk_fma_f32 v[46:47], v[46:47], s[84:85], s[84:85] op_sel:[0,1,0] op_sel_hi:[1,1,0]
    v_pk_fma_f32 v[48:49], v[48:49], s[84:85], s[84:85] op_sel:[0,1,0] op_sel_hi:[1,1,0]
    v_pk_fma_f32 v[50:51], v[50:51], s[84:85], s[84:85] op_sel:[0,1,0] op_sel_hi:[1,1,0]
    v_pk_mul_f32 v[44:45], v[44:45], v[224:225]
    v_pk_mul_f32 v[46:47], v[46:47], v[226:227]
    v_pk_mul_f32 v[48:49], v[48:49], v[228:229]
    v_pk_mul_f32 v[50:51], v[50:51], v[230:231]
    v_exp_f32 v44, v44
    v_exp_f32 v45, v45
    v_exp_f32 v46, v46
    v_exp_f32 v47, v47
    v_exp_f32 v48, v48
    v_exp_f32 v49, v49
    v_exp_f32 v50, v50
    v_exp_f32 v51, v51
    v_pk_add_f32 v[44:45], v[44:45], 1.0 op_sel_hi:[1,0]
    v_pk_add_f32 v[46:47], v[46:47], 1.0 op_sel_hi:[1,0]
    v_pk_add_f32 v[48:49], v[48:49], 1.0 op_sel_hi:[1,0]
    v_pk_add_f32 v[50:51], v[50:51], 1.0 op_sel_hi:[1,0]
    v_rcp_f32 v44, v44
    v_rcp_f32 v45, v45
    v_rcp_f32 v46, v46
    v_rcp_f32 v47, v47
    v_rcp_f32 v48, v48
    v_rcp_f32 v49, v49
    v_rcp_f32 v50, v50
    v_rcp_f32 v51, v51
    v_pk_mul_f32 v[224:225], v[224:225], v[44:45]
    v_pk_mul_f32 v[226:227], v[226:227], v[46:47]
    v_pk_mul_f32 v[228:229], v[228:229], v[48:49]
    v_pk_mul_f32 v[230:231], v[230:231], v[50:51]
    v_cvt_pk_bf16_f32 v210, v224, v225
    v_cvt_pk_bf16_f32 v211, v226, v227
    v_cvt_pk_bf16_f32 v214, v228, v229
    v_cvt_pk_bf16_f32 v215, v230, v231
    buffer_store_dwordx4 v[208:211], v2, s[60:63], s86 offen offset:0 sc1
    buffer_store_dwordx4 v[212:215], v2, s[60:63], s86 offen offset:1024 sc1
    v_pk_fma_f32 v[232:233], v[232:233], v[34:35], v[52:53] op_sel_hi:[1,0,1]
    v_pk_fma_f32 v[234:235], v[234:235], v[34:35], v[54:55] op_sel_hi:[1,0,1]
    v_pk_fma_f32 v[236:237], v[236:237], v[34:35], v[52:53] op_sel:[0,1,0] op_sel_hi:[1,1,1]
    v_pk_fma_f32 v[238:239], v[238:239], v[34:35], v[54:55] op_sel:[0,1,0] op_sel_hi:[1,1,1]
    v_pk_mul_f32 v[44:45], v[232:233], v[232:233]
    v_pk_mul_f32 v[46:47], v[234:235], v[234:235]
    v_pk_mul_f32 v[48:49], v[236:237], v[236:237]
    v_pk_mul_f32 v[50:51], v[238:239], v[238:239]
    v_pk_fma_f32 v[44:45], v[44:45], s[84:85], s[84:85] op_sel:[0,1,0] op_sel_hi:[1,1,0]
    v_pk_fma_f32 v[46:47], v[46:47], s[84:85], s[84:85] op_sel:[0,1,0] op_sel_hi:[1,1,0]
    v_pk_fma_f32 v[48:49], v[48:49], s[84:85], s[84:85] op_sel:[0,1,0] op_sel_hi:[1,1,0]
    v_pk_fma_f32 v[50:51], v[50:51], s[84:85], s[84:85] op_sel:[0,1,0] op_sel_hi:[1,1,0]
    v_pk_mul_f32 v[44:45], v[44:45], v[232:233]
    v_pk_mul_f32 v[46:47], v[46:47], v[234:235]
    v_pk_mul_f32 v[48:49], v[48:49], v[236:237]
    v_pk_mul_f32 v[50:51], v[50:51], v[238:239]
    v_exp_f32 v44, v44
    v_exp_f32 v45, v45
    v_exp_f32 v46, v46
    v_exp_f32 v47, v47
    v_exp_f32 v48, v48
    v_exp_f32 v49, v49
    v_exp_f32 v50, v50
    v_exp_f32 v51, v51
    v_pk_add_f32 v[44:45], v[44:45], 1.0 op_sel_hi:[1,0]
    v_pk_add_f32 v[46:47], v[46:47], 1.0 op_sel_hi:[1,0]
    v_pk_add_f32 v[48:49], v[48:49], 1.0 op_sel_hi:[1,0]
    v_pk_add_f32 v[50:51], v[50:51], 1.0 op_sel_hi:[1,0]
    v_rcp_f32 v44, v44
    v_rcp_f32 v45, v45
    v_rcp_f32 v46, v46
    v_rcp_f32 v47, v47
    v_rcp_f32 v48, v48
    v_rcp_f32 v49, v49
    v_rcp_f32 v50, v50
    v_rcp_f32 v51, v51
    v_pk_mul_f32 v[232:233], v[232:233], v[44:45]
    v_pk_mul_f32 v[234:235], v[234:235], v[46:47]
    v_pk_mul_f32 v[236:237], v[236:237], v[48:49]
    v_pk_mul_f32 v[238:239], v[238:239], v[50:51]
    v_cvt_pk_bf16_f32 v218, v232, v233
    v_cvt_pk_bf16_f32 v219, v234, v235
    v_cvt_pk_bf16_f32 v222, v236, v237
    v_cvt_pk_bf16_f32 v223, v238, v239
    buffer_store_dwordx4 v[216:219], v2, s[60:63], s86 offen offset:2048 sc1
    buffer_store_dwordx4 v[220:223], v2, s[60:63], s86 offen offset:3072 sc1
    s_add_u32 s86, s86, 131072
    s_cmp_lg_u32 s38, 1
    s_cbranch_scc1 L_nopoll
    s_lshl_b32 s95, s73, 3
    s_add_u32 s95, s95, s72
    s_sub_u32 s22, s95, 1
    s_lshl_b32 s22, s22, 8
    s_cmp_ge_u32 s72, 1
    s_cselect_b32 s6, s22, 0x20000
    s_sub_u32 s22, s95, 2
    s_lshl_b32 s22, s22, 8
    s_cmp_ge_u32 s72, 2
    s_cselect_b32 s7, s22, 0x20000
    s_sub_u32 s22, s95, 3
    s_lshl_b32 s22, s22, 8
    s_cmp_ge_u32 s72, 3
    s_cselect_b32 s8, s22, 0x20000
    s_sub_u32 s22, s95, 4
    s_lshl_b32 s22, s22, 8
    s_cmp_ge_u32 s72, 4
    s_cselect_b32 s9, s22, 0x20000
    s_sub_u32 s22, s95, 5
    s_lshl_b32 s22, s22, 8
    s_cmp_ge_u32 s72, 5
    s_cselect_b32 s10, s22, 0x20000
    s_sub_u32 s22, s95, 6
    s_lshl_b32 s22, s22, 8
    s_cmp_ge_u32 s72, 6
    s_cselect_b32 s11, s22, 0x20000
    s_sub_u32 s22, s95, 7
    s_lshl_b32 s22, s22, 8
    s_cmp_ge_u32 s72, 7
    s_cselect_b32 s12, s22, 0x20000
    buffer_load_dwordx2 v[60:61], v77, s[64:67], s6 offen sc1
    buffer_load_dwordx2 v[62:63], v77, s[64:67], s7 offen sc1
    buffer_load_dwordx2 v[64:65], v77, s[64:67], s8 offen sc1
    buffer_load_dwordx2 v[66:67], v77, s[64:67], s9 offen sc1
    buffer_load_dwordx2 v[68:69], v77, s[64:67], s10 offen sc1
    buffer_load_dwordx2 v[70:71], v77, s[64:67], s11 offen sc1
    buffer_load_dwordx2 v[72:73], v77, s[64:67], s12 offen sc1
L_nopoll:
    s_waitcnt lgkmcnt(0)
    v_pk_fma_f32 v[240:241], v[240:241], v[32:33], v[56:57] op_sel_hi:[1,0,1]
    v_pk_fma_f32 v[242:243], v[242:243], v[32:33], v[58:59] op_sel_hi:[1,0,1]
    v_pk_fma_f32 v[244:245], v[244:245], v[32:33], v[56:57] op_sel:[0,1,0] op_sel_hi:[1,1,1]
    v_pk_fma_f32 v[246:247], v[246:247], v[32:33], v[58:59] op_sel:[0,1,0] op_sel_hi:[1,1,1]
    v_pk_mul_f32 v[44:45], v[240:241], v[240:241]
    v_pk_mul_f32 v[46:47], v[242:243], v[242:243]
    v_pk_mul_f32 v[48:49], v[244:245], v[244:245]
    v_pk_mul_f32 v[50:51], v[246:247], v[246:247]
    v_pk_fma_f32 v[44:45], v[44:45], s[84:85], s[84:85] op_sel:[0,1,0] op_sel_hi:[1,1,0]
    v_pk_fma_f32 v[46:47], v[46:47], s[84:85], s[84:85] op_sel:[0,1,0] op_sel_hi:[1,1,0]
    v_pk_fma_f32 v[48:49], v[48:49], s[84:85], s[84:85] op_sel:[0,1,0] op_sel_hi:[1,1,0]
    v_pk_fma_f32 v[50:51], v[50:51], s[84:85], s[84:85] op_sel:[0,1,0] op_sel_hi:[1,1,0]
    v_pk_mul_f32 v[44:45], v[44:45], v[240:241]
    v_pk_mul_f32 v[46:47], v[46:47], v[242:243]
    v_pk_mul_f32 v[48:49], v[48:49], v[244:245]
    v_pk_mul_f32 v[50:51], v[50:51], v[246:247]
    v_exp_f32 v44, v44
    v_exp_f32 v45, v45
    v_exp_f32 v46, v46
    v_exp_f32 v47, v47
    v_exp_f32 v48, v48
    v_exp_f32 v49, v49
    v_exp_f32 v50, v50
    v_exp_f32 v51, v51
    v_pk_add_f32 v[44:45], v[44:45], 1.0 op_sel_hi:[1,0]
    v_pk_add_f32 v[46:47], v[46:47], 1.0 op_sel_hi:[1,0]
    v_pk_add_f32 v[48:49], v[48:49], 1.0 op_sel_hi:[1,0]
    v_pk_add_f32 v[50:51], v[50:51], 1.0 op_sel_hi:[1,0]
    v_rcp_f32 v44, v44
    v_rcp_f32 v45, v45
    v_rcp_f32 v46, v46
    v_rcp_f32 v47, v47
    v_rcp_f32 v48, v48
    v_rcp_f32 v49, v49
    v_rcp_f32 v50, v50
    v_rcp_f32 v51, v51
    v_pk_mul_f32 v[240:241], v[240:241], v[44:45]
    v_pk_mul_f32 v[242:243], v[242:243], v[46:47]
    v_pk_mul_f32 v[244:245], v[244:245], v[48:49]
    v_pk_mul_f32 v[246:247], v[246:247], v[50:51]
    v_cvt_pk_bf16_f32 v240, v240, v241
    v_cvt_pk_bf16_f32 v241, v242, v243
    v_cvt_pk_bf16_f32 v244, v244, v245
    v_cvt_pk_bf16_f32 v245, v246, v247
    buffer_store_dwordx2 v[240:241], v0, s[60:63], s87 offen offset:0 sc1
    buffer_store_dwordx2 v[244:245], v0, s[60:63], s87 offen offset:1024 sc1
    v_pk_fma_f32 v[248:249], v[248:249], v[34:35], v[56:57] op_sel_hi:[1,0,1]
    v_pk_fma_f32 v[250:251], v[250:251], v[34:35], v[58:59] op_sel_hi:[1,0,1]
    v_pk_fma_f32 v[252:253], v[252:253], v[34:35], v[56:57] op_sel:[0,1,0] op_sel_hi:[1,1,1]
    v_pk_fma_f32 v[254:255], v[254:255], v[34:35], v[58:59] op_sel:[0,1,0] op_sel_hi:[1,1,1]
    v_pk_mul_f32 v[44:45], v[248:249], v[248:249]
    v_pk_mul_f32 v[46:47], v[250:251], v[250:251]
    v_pk_mul_f32 v[48:49], v[252:253], v[252:253]
    v_pk_mul_f32 v[50:51], v[254:255], v[254:255]
    v_pk_fma_f32 v[44:45], v[44:45], s[84:85], s[84:85] op_sel:[0,1,0] op_sel_hi:[1,1,0]
    v_pk_fma_f32 v[46:47], v[46:47], s[84:85], s[84:85] op_sel:[0,1,0] op_sel_hi:[1,1,0]
    v_pk_fma_f32 v[48:49], v[48:49], s[84:85], s[84:85] op_sel:[0,1,0] op_sel_hi:[1,1,0]
    v_pk_fma_f32 v[50:51], v[50:51], s[84:85], s[84:85] op_sel:[0,1,0] op_sel_hi:[1,1,0]
    v_pk_mul_f32 v[44:45], v[44:45], v[248:249]
    v_pk_mul_f32 v[46:47], v[46:47], v[250:251]
    v_pk_mul_f32 v[48:49], v[48:49], v[252:253]
    v_pk_mul_f32 v[50:51], v[50:51], v[254:255]
    v_exp_f32 v44, v44
    v_exp_f32 v45, v45
    v_exp_f32 v46, v46
    v_exp_f32 v47, v47
    v_exp_f32 v48, v48
    v_exp_f32 v49, v49
    v_exp_f32 v50, v50
    v_exp_f32 v51, v51
    v_pk_add_f32 v[44:45], v[44:45], 1.0 op_sel_hi:[1,0]
    v_pk_add_f32 v[46:47], v[46:47], 1.0 op_sel_hi:[1,0]
    v_pk_add_f32 v[48:49], v[48:49], 1.0 op_sel_hi:[1,0]
    v_pk_add_f32 v[50:51], v[50:51], 1.0 op_sel_hi:[1,0]
    v_rcp_f32 v44, v44
    v_rcp_f32 v45, v45
    v_rcp_f32 v46, v46
    v_rcp_f32 v47, v47
    v_rcp_f32 v48, v48
    v_rcp_f32 v49, v49
    v_rcp_f32 v50, v50
    v_rcp_f32 v51, v51
    v_pk_mul_f32 v[248:249], v[248:249], v[44:45]
    v_pk_mul_f32 v[250:251], v[250:251], v[46:47]
    v_pk_mul_f32 v[252:253], v[252:253], v[48:49]
    v_pk_mul_f32 v[254:255], v[254:255], v[50:51]
    v_cvt_pk_bf16_f32 v248, v248, v249
    v_cvt_pk_bf16_f32 v249, v250, v251
    v_cvt_pk_bf16_f32 v252, v252, v253
    v_cvt_pk_bf16_f32 v253, v254, v255
    buffer_store_dwordx2 v[248:249], v0, s[60:63], s87 offen offset:2048 sc1
    buffer_store_dwordx2 v[252:253], v0, s[60:63], s87 offen offset:3072 sc1
    s_cmp_lg_u32 s38, 1
    s_cbranch_scc1 L_nocarry
    ds_read_b64 v[144:145], v40 offset:0
    ds_read_b64 v[146:147], v40 offset:256
    ds_read_b64 v[148:149], v40 offset:512
    ds_read_b64 v[150:151], v40 offset:768
    ds_read_b64 v[152:153], v40 offset:1024
    ds_read_b64 v[154:155], v40 offset:1280
    ds_read_b64 v[156:157], v40 offset:1536
    ds_read_b64 v[158:159], v40 offset:1792
    ds_read_b64 v[160:161], v40 offset:2048
    ds_read_b64 v[162:163], v40 offset:2304
    ds_read_b64 v[164:165], v40 offset:2560
    ds_read_b64 v[166:167], v40 offset:2816
    ds_read_b64 v[168:169], v40 offset:3072
    ds_read_b64 v[170:171], v40 offset:3328
    ds_read_b64 v[172:173], v40 offset:3584
    ds_read_b64 v[174:175], v40 offset:3840
    s_mov_b32 s95, 1048576
    s_waitcnt vmcnt(4)
L_pollG:
    v_max3_u32 v74, v60, v61, v62
    v_max3_u32 v75, v63, v64, v65
    v_max3_u32 v74, v66, v67, v74
    v_max3_u32 v75, v68, v69, v75
    v_max3_u32 v74, v70, v71, v74
    v_max3_u32 v75, v72, v73, v75
    v_max_u32 v74, v74, v75
    v_cmp_eq_u32 s[22:23], -1, v74
    s_sub_u32 s95, s95, 1
    s_cselect_b64 s[22:23], 0, s[22:23]
    s_cmp_eq_u64 s[22:23], 0
    s_cbranch_scc1 L_gotG
    buffer_load_dwordx2 v[60:61], v77, s[64:67], s6 offen sc1
    buffer_load_dwordx2 v[62:63], v77, s[64:67], s7 offen sc1
    buffer_load_dwordx2 v[64:65], v77, s[64:67], s8 offen sc1
    buffer_load_dwordx2 v[66:67], v77, s[64:67], s9 offen sc1
    buffer_load_dwordx2 v[68:69], v77, s[64:67], s10 offen sc1
    buffer_load_dwordx2 v[70:71], v77, s[64:67], s11 offen sc1
    buffer_load_dwordx2 v[72:73], v77, s[64:67], s12 offen sc1
    s_waitcnt vmcnt(0)
    s_branch L_pollG
L_gotG:
    v_fmac_f32 v70, v28, v72
    v_fmac_f32 v71, v28, v73
    v_fmac_f32 v70, v27, v73
    v_fmac_f32 v71, v29, v72
    v_fmac_f32 v68, v28, v70
    v_fmac_f32 v69, v28, v71
    v_fmac_f32 v68, v27, v71
    v_fmac_f32 v69, v29, v70
    v_fmac_f32 v66, v28, v68
    v_fmac_f32 v67, v28, v69
    v_fmac_f32 v66, v27, v69
    v_fmac_f32 v67, v29, v68
    v_fmac_f32 v64, v28, v66
    v_fmac_f32 v65, v28, v67
    v_fmac_f32 v64, v27, v67
    v_fmac_f32 v65, v29, v66
    v_fmac_f32 v62, v28, v64
    v_fmac_f32 v63, v28, v65
    v_fmac_f32 v62, v27, v65
    v_fmac_f32 v63, v29, v64
    v_fmac_f32 v60, v28, v62
    v_fmac_f32 v61, v28, v63
    v_fmac_f32 v60, v27, v63
    v_fmac_f32 v61, v29, v62
    v_add_u32 v40, 70656, v77
    s_waitcnt lgkmcnt(0)
    ds_write_b64 v40, v[60:61] offset:0
    v_fmac_f32 v144, v24, v60
    v_fmac_f32 v145, v24, v61
    v_fmac_f32 v144, v26, v61
    v_fmac_f32 v145, v25, v60
    ds_write_b64 v40, v[144:145] offset:256
    v_fmac_f32 v146, v24, v144
    v_fmac_f32 v147, v24, v145
    v_fmac_f32 v146, v26, v145
    v_fmac_f32 v147, v25, v144
    ds_write_b64 v40, v[146:147] offset:512
    v_fmac_f32 v148, v24, v146
    v_fmac_f32 v149, v24, v147
    v_fmac_f32 v148, v26, v147
    v_fmac_f32 v149, v25, v146
    ds_write_b64 v40, v[148:149] offset:768
    v_fmac_f32 v150, v24, v148
    v_fmac_f32 v151, v24, v149
    v_fmac_f32 v150, v26, v149
    v_fmac_f32 v151, v25, v148
    ds_write_b64 v40, v[150:151] offset:1024
    v_fmac_f32 v152, v24, v150
    v_fmac_f32 v153, v24, v151
    v_fmac_f32 v152, v26, v151
    v_fmac_f32 v153, v25, v150
    ds_write_b64 v40, v[152:153] offset:1280
    v_fmac_f32 v154, v24, v152
    v_fmac_f32 v155, v24, v153
    v_fmac_f32 v154, v26, v153
    v_fmac_f32 v155, v25, v152
    ds_write_b64 v40, v[154:155] offset:1536
    v_fmac_f32 v156, v24, v154
    v_fmac_f32 v157, v24, v155
    v_fmac_f32 v156, v26, v155
    v_fmac_f32 v157, v25, v154
    ds_write_b64 v40, v[156:157] offset:1792
    v_fmac_f32 v158, v24, v156
    v_fmac_f32 v159, v24, v157
    v_fmac_f32 v158, v26, v157
    v_fmac_f32 v159, v25, v156
    ds_write_b64 v40, v[158:159] offset:2048
    v_fmac_f32 v160, v24, v158
    v_fmac_f32 v161, v24, v159
    v_fmac_f32 v160, v26, v159
    v_fmac_f32 v161, v25, v158
    ds_write_b64 v40, v[160:161] offset:2304
    v_fmac_f32 v162, v24, v160
    v_fmac_f32 v163, v24, v161
    v_fmac_f32 v162, v26, v161
    v_fmac_f32 v163, v25, v160
    ds_write_b64 v40, v[162:163] offset:2560
    v_fmac_f32 v164, v24, v162
    v_fmac_f32 v165, v24, v163
    v_fmac_f32 v164, v26, v163
    v_fmac_f32 v165, v25, v162
    ds_write_b64 v40, v[164:165] offset:2816
    v_fmac_f32 v166, v24, v164
    v_fmac_f32 v167, v24, v165
    v_fmac_f32 v166, v26, v165
    v_fmac_f32 v167, v25, v164
    ds_write_b64 v40, v[166:167] offset:3072
    v_fmac_f32 v168, v24, v166
    v_fmac_f32 v169, v24, v167
    v_fmac_f32 v168, v26, v167
    v_fmac_f32 v169, v25, v166
    ds_write_b64 v40, v[168:169] offset:3328
    v_fmac_f32 v170, v24, v168
    v_fmac_f32 v171, v24, v169
    v_fmac_f32 v170, v26, v169
    v_fmac_f32 v171, v25, v168
    ds_write_b64 v40, v[170:171] offset:3584
    v_fmac_f32 v172, v24, v170
    v_fmac_f32 v173, v24, v171
    v_fmac_f32 v172, v26, v171
    v_fmac_f32 v173, v25, v170
    ds_write_b64 v40, v[172:173] offset:3840
    s_waitcnt lgkmcnt(0)
L_nocarry:
    s_barrier
    s_waitcnt vmcnt(0)
    s_barrier
    s_cmp_lg_u32 s38, 0
    s_cbranch_scc1 L_noarrH
    s_lshr_b32 s92, s73, 3
    s_lshl_b32 s93, s72, 2
    s_add_u32 s92, s92, s93
    s_lshl_b32 s91, s92, 7
    s_add_u32 s91, s91, 40046592
    v_mov_b32 v44, 0
    v_mov_b32 v45, 1
    s_mov_b64 exec, 1
    buffer_atomic_add v45, v44, s[40:43], s91 offen sc1
    s_mov_b64 exec, -1
L_noarrH:
    s_cmp_lg_u32 s76, 0
    s_cbranch_scc1 L_nox
    s_lshr_b32 s91, s38, 1
    s_lshl_b32 s92, s77, 1
    s_add_u32 s91, s91, s92
    s_lshl_b32 s91, s91, 6
    s_and_b32 s92, s38, 1
    s_lshl_b32 s92, s92, 3
    s_add_u32 s91, s91, s92
    v_add_u32 v12, s91, v41
    v_lshlrev_b32 v12, 11, v12
    s_lshl_b32 s91, s78, 8
    v_add_u32 v12, s91, v12
    v_xor_b32 v13, v42, v41
    v_lshl_add_u32 v12, v13, 4, v12
    s_lshl_b32 s91, s38, 13
    s_add_u32 s91, s91, 37888
    v_xor_b32 v13, 0, v12
    v_add_u32 v13, 0, v13
    s_add_u32 m0, s91, 0
    s_nop 0
    global_load_lds_dwordx4 v13, s[4:5] nt
    v_xor_b32 v13, 64, v12
    v_add_u32 v13, 32768, v13
    s_add_u32 m0, s91, 1024
    s_nop 0
    global_load_lds_dwordx4 v13, s[4:5] nt
    v_xor_b32 v13, 128, v12
    v_add_u32 v13, 65536, v13
    s_add_u32 m0, s91, 2048
    s_nop 0
    global_load_lds_dwordx4 v13, s[4:5] nt
    v_xor_b32 v13, 192, v12
    v_add_u32 v13, 98304, v13
    s_add_u32 m0, s91, 3072
    s_nop 0
    global_load_lds_dwordx4 v13, s[4:5] nt
    v_xor_b32 v13, 0, v12
    v_add_u32 v13, 8192, v13
    s_add_u32 m0, s91, 4096
    s_nop 0
    global_load_lds_dwordx4 v13, s[4:5] nt
    v_xor_b32 v13, 64, v12
    v_add_u32 v13, 40960, v13
    s_add_u32 m0, s91, 5120
    s_nop 0
    global_load_lds_dwordx4 v13, s[4:5] nt
    v_xor_b32 v13, 128, v12
    v_add_u32 v13, 73728, v13
    s_add_u32 m0, s91, 6144
    s_nop 0
    global_load_lds_dwordx4 v13, s[4:5] nt
    v_xor_b32 v13, 192, v12
    v_add_u32 v13, 106496, v13
    s_add_u32 m0, s91, 7168
    s_nop 0
    global_load_lds_dwordx4 v13, s[4:5] nt
L_nox:
    s_cmp_lg_u32 s76, 0
    s_cbranch_scc1 L_gi1
    v_mov_b64 v[176:177], 0
    v_mov_b64 v[178:179], 0
    v_mov_b64 v[180:181], 0
    v_mov_b64 v[182:183], 0
    v_mov_b64 v[184:185], 0
    v_mov_b64 v[186:187], 0
    v_mov_b64 v[188:189], 0
    v_mov_b64 v[190:191], 0
    v_mov_b64 v[192:193], 0
    v_mov_b64 v[194:195], 0
    v_mov_b64 v[196:197], 0
    v_mov_b64 v[198:199], 0
    v_mov_b64 v[200:201], 0
    v_mov_b64 v[202:203], 0
    v_mov_b64 v[204:205], 0
    v_mov_b64 v[206:207], 0
    v_mov_b64 v[208:209], 0
    v_mov_b64 v[210:211], 0
    v_mov_b64 v[212:213], 0
    v_mov_b64 v[214:215], 0
    v_mov_b64 v[216:217], 0
    v_mov_b64 v[218:219], 0
    v_mov_b64 v[220:221], 0
    v_mov_b64 v[222:223], 0
    v_mov_b64 v[224:225], 0
    v_mov_b64 v[226:227], 0
    v_mov_b64 v[228:229], 0
    v_mov_b64 v[230:231], 0
    v_mov_b64 v[232:233], 0
    v_mov_b64 v[234:235], 0
    v_mov_b64 v[236:237], 0
    v_mov_b64 v[238:239], 0
    s_branch L_gi2
L_gi1:
    s_mov_b32 s95, 0xffff0000
    v_accvgpr_read_b32 v177, a184
    v_accvgpr_read_b32 v179, a185
    v_lshlrev_b32 v176, 16, v177
    v_and_b32 v177, s95, v177
    v_lshlrev_b32 v178, 16, v179
    v_and_b32 v179, s95, v179
    v_mov_b64 v[180:181], v[176:177]
    v_mov_b64 v[182:183], v[178:179]
    v_accvgpr_read_b32 v185, a186
    v_accvgpr_read_b32 v187, a187
    v_lshlrev_b32 v184, 16, v185
    v_and_b32 v185, s95, v185
    v_lshlrev_b32 v186, 16, v187
    v_and_b32 v187, s95, v187
    v_mov_b64 v[188:189], v[184:185]
    v_mov_b64 v[190:191], v[186:187]
    v_accvgpr_read_b32 v193, a188
    v_accvgpr_read_b32 v195, a189
    v_lshlrev_b32 v192, 16, v193
    v_and_b32 v193, s95, v193
    v_lshlrev_b32 v194, 16, v195
    v_and_b32 v195, s95, v195
    v_mov_b64 v[196:197], v[192:193]
    v_mov_b64 v[198:199], v[194:195]
    v_accvgpr_read_b32 v201, a190
    v_accvgpr_read_b32 v203, a191
    v_lshlrev_b32 v200, 16, v201
    v_and_b32 v201, s95, v201
    v_lshlrev_b32 v202, 16, v203
    v_and_b32 v203, s95, v203
    v_mov_b64 v[204:205], v[200:201]
    v_mov_b64 v[206:207], v[202:203]
    v_accvgpr_read_b32 v209, a192
    v_accvgpr_read_b32 v211, a193
    v_lshlrev_b32 v208, 16, v209
    v_and_b32 v209, s95, v209
    v_lshlrev_b32 v210, 16, v211
    v_and_b32 v211, s95, v211
    v_mov_b64 v[212:213], v[208:209]
    v_mov_b64 v[214:215], v[210:211]
    v_accvgpr_read_b32 v217, a194
    v_accvgpr_read_b32 v219, a195
    v_lshlrev_b32 v216, 16, v217
    v_and_b32 v217, s95, v217
    v_lshlrev_b32 v218, 16, v219
    v_and_b32 v219, s95, v219
    v_mov_b64 v[220:221], v[216:217]
    v_mov_b64 v[222:223], v[218:219]
    v_accvgpr_read_b32 v225, a196
    v_accvgpr_read_b32 v227, a197
    v_lshlrev_b32 v224, 16, v225
    v_and_b32 v225, s95, v225
    v_lshlrev_b32 v226, 16, v227
    v_and_b32 v227, s95, v227
    v_mov_b64 v[228:229], v[224:225]
    v_mov_b64 v[230:231], v[226:227]
    v_accvgpr_read_b32 v233, a198
    v_accvgpr_read_b32 v235, a199
    v_lshlrev_b32 v232, 16, v233
    v_and_b32 v233, s95, v233
    v_lshlrev_b32 v234, 16, v235
    v_and_b32 v235, s95, v235
    v_mov_b64 v[236:237], v[232:233]
    v_mov_b64 v[238:239], v[234:235]
L_gi2:
    v_add_u32 v76, -86272, v76
    s_mul_i32 s93, s38, 9216
    ds_read_b64 v[44:45], v76
    ds_read_b64 v[46:47], v76 offset:128
    s_add_u32 s93, s93, 1024
    v_mul_u32_u24 v52, 144, v42
    v_lshl_add_u32 v52, v41, 5, v52
    v_add_u32 v52, s93, v52
    v_lshrrev_b32 v53, 2, v42
    v_lshl_add_u32 v53, v41, 3, v53
    v_mul_u32_u24 v53, 144, v53
    v_and_b32 v54, 3, v42
    v_lshl_add_u32 v53, v54, 5, v53
    v_add_u32 v53, s93, v53
    s_waitcnt lgkmcnt(0)
    v_fmac_f32 v80, v14, v44
    v_fmac_f32 v112, v14, v45
    v_fmac_f32 v96, v17, v46
    v_fmac_f32 v128, v17, v47
    v_fmac_f32 v80, v16, v45
    v_fmac_f32 v112, v15, v44
    v_fmac_f32 v96, v19, v47
    v_fmac_f32 v128, v18, v46
    v_fmac_f32 v81, v14, v80
    v_fmac_f32 v113, v14, v112
    v_fmac_f32 v97, v17, v96
    v_fmac_f32 v129, v17, v128
    v_fmac_f32 v81, v16, v112
    v_fmac_f32 v113, v15, v80
    v_fmac_f32 v97, v19, v128
    v_fmac_f32 v129, v18, v96
    v_fmac_f32 v82, v14, v81
    v_fmac_f32 v114, v14, v113
    v_fmac_f32 v98, v17, v97
    v_fmac_f32 v130, v17, v129
    v_fmac_f32 v82, v16, v113
    v_fmac_f32 v114, v15, v81
    v_fmac_f32 v98, v19, v129
    v_fmac_f32 v130, v18, v97
    v_fmac_f32 v83, v14, v82
    v_fmac_f32 v115, v14, v114
    v_fmac_f32 v99, v17, v98
    v_fmac_f32 v131, v17, v130
    v_fmac_f32 v83, v16, v114
    v_fmac_f32 v115, v15, v82
    v_fmac_f32 v99, v19, v130
    v_fmac_f32 v131, v18, v98
    v_fmac_f32 v84, v14, v83
    v_fmac_f32 v116, v14, v115
    v_fmac_f32 v100, v17, v99
    v_fmac_f32 v132, v17, v131
    v_fmac_f32 v84, v16, v115
    v_fmac_f32 v116, v15, v83
    v_fmac_f32 v100, v19, v131
    v_fmac_f32 v132, v18, v99
    v_fmac_f32 v85, v14, v84
    v_fmac_f32 v117, v14, v116
    v_fmac_f32 v101, v17, v100
    v_fmac_f32 v133, v17, v132
    v_fmac_f32 v85, v16, v116
    v_fmac_f32 v117, v15, v84
    v_fmac_f32 v101, v19, v132
    v_fmac_f32 v133, v18, v100
    v_fmac_f32 v86, v14, v85
    v_fmac_f32 v118, v14, v117
    v_fmac_f32 v102, v17, v101
    v_fmac_f32 v134, v17, v133
    v_fmac_f32 v86, v16, v117
    v_fmac_f32 v118, v15, v85
    v_fmac_f32 v102, v19, v133
    v_fmac_f32 v134, v18, v101
    v_fmac_f32 v87, v14, v86
    v_fmac_f32 v119, v14, v118
    v_fmac_f32 v103, v17, v102
    v_fmac_f32 v135, v17, v134
    v_fmac_f32 v87, v16, v118
    v_fmac_f32 v119, v15, v86
    v_fmac_f32 v103, v19, v134
    v_fmac_f32 v135, v18, v102
    v_fmac_f32 v88, v14, v87
    v_fmac_f32 v120, v14, v119
    v_fmac_f32 v104, v17, v103
    v_fmac_f32 v136, v17, v135
    v_fmac_f32 v88, v16, v119
    v_fmac_f32 v120, v15, v87
    v_fmac_f32 v104, v19, v135
    v_fmac_f32 v136, v18, v103
    v_fmac_f32 v89, v14, v88
    v_fmac_f32 v121, v14, v120
    v_fmac_f32 v105, v17, v104
    v_fmac_f32 v137, v17, v136
    v_fmac_f32 v89, v16, v120
    v_fmac_f32 v121, v15, v88
    v_fmac_f32 v105, v19, v136
    v_fmac_f32 v137, v18, v104
    v_fmac_f32 v90, v14, v89
    v_fmac_f32 v122, v14, v121
    v_fmac_f32 v106, v17, v105
    v_fmac_f32 v138, v17, v137
    v_fmac_f32 v90, v16, v121
    v_fmac_f32 v122, v15, v89
    v_fmac_f32 v106, v19, v137
    v_fmac_f32 v138, v18, v105
    v_fmac_f32 v91, v14, v90
    v_fmac_f32 v123, v14, v122
    v_fmac_f32 v107, v17, v106
    v_fmac_f32 v139, v17, v138
    v_fmac_f32 v91, v16, v122
    v_fmac_f32 v123, v15, v90
    v_fmac_f32 v107, v19, v138
    v_fmac_f32 v139, v18, v106
    v_fmac_f32 v92, v14, v91
    v_fmac_f32 v124, v14, v123
    v_fmac_f32 v108, v17, v107
    v_fmac_f32 v140, v17, v139
    v_fmac_f32 v92, v16, v123
    v_fmac_f32 v124, v15, v91
    v_fmac_f32 v108, v19, v139
    v_fmac_f32 v140, v18, v107
    v_fmac_f32 v93, v14, v92
    v_fmac_f32 v125, v14, v124
    v_fmac_f32 v109, v17, v108
    v_fmac_f32 v141, v17, v140
    v_fmac_f32 v93, v16, v124
    v_fmac_f32 v125, v15, v92
    v_fmac_f32 v109, v19, v140
    v_fmac_f32 v141, v18, v108
    v_fmac_f32 v94, v14, v93
    v_fmac_f32 v126, v14, v125
    v_fmac_f32 v110, v17, v109
    v_fmac_f32 v142, v17, v141
    v_fmac_f32 v94, v16, v125
    v_fmac_f32 v126, v15, v93
    v_fmac_f32 v110, v19, v141
    v_fmac_f32 v142, v18, v109
    v_fmac_f32 v95, v14, v94
    v_fmac_f32 v127, v14, v126
    v_fmac_f32 v111, v17, v110
    v_fmac_f32 v143, v17, v142
    v_fmac_f32 v95, v16, v126
    v_fmac_f32 v127, v15, v94
    v_fmac_f32 v111, v19, v142
    v_fmac_f32 v143, v18, v110
    v_cvt_pk_bf16_f32 v80, v80, v81
    v_cvt_pk_bf16_f32 v81, v82, v83
    v_cvt_pk_bf16_f32 v82, v84, v85
    v_cvt_pk_bf16_f32 v83, v86, v87
    ds_write_b128 v52, v[80:83] offset:0
    v_cvt_pk_bf16_f32 v88, v88, v89
    v_cvt_pk_bf16_f32 v89, v90, v91
    v_cvt_pk_bf16_f32 v90, v92, v93
    v_cvt_pk_bf16_f32 v91, v94, v95
    ds_write_b128 v52, v[88:91] offset:16
    v_cvt_pk_bf16_f32 v96, v96, v97
    v_cvt_pk_bf16_f32 v97, v98, v99
    v_cvt_pk_bf16_f32 v98, v100, v101
    v_cvt_pk_bf16_f32 v99, v102, v103
    ds_write_b128 v52, v[96:99] offset:2304
    v_cvt_pk_bf16_f32 v104, v104, v105
    v_cvt_pk_bf16_f32 v105, v106, v107
    v_cvt_pk_bf16_f32 v106, v108, v109
    v_cvt_pk_bf16_f32 v107, v110, v111
    ds_write_b128 v52, v[104:107] offset:2320
    v_cvt_pk_bf16_f32 v112, -v112, -v113
    v_cvt_pk_bf16_f32 v113, -v114, -v115
    v_cvt_pk_bf16_f32 v114, -v116, -v117
    v_cvt_pk_bf16_f32 v115, -v118, -v119
    ds_write_b128 v52, v[112:115] offset:4608
    v_cvt_pk_bf16_f32 v120, -v120, -v121
    v_cvt_pk_bf16_f32 v121, -v122, -v123
    v_cvt_pk_bf16_f32 v122, -v124, -v125
    v_cvt_pk_bf16_f32 v123, -v126, -v127
    ds_write_b128 v52, v[120:123] offset:4624
    v_cvt_pk_bf16_f32 v128, -v128, -v129
    v_cvt_pk_bf16_f32 v129, -v130, -v131
    v_cvt_pk_bf16_f32 v130, -v132, -v133
    v_cvt_pk_bf16_f32 v131, -v134, -v135
    ds_write_b128 v52, v[128:131] offset:6912
    v_cvt_pk_bf16_f32 v136, -v136, -v137
    v_cvt_pk_bf16_f32 v137, -v138, -v139
    v_cvt_pk_bf16_f32 v138, -v140, -v141
    v_cvt_pk_bf16_f32 v139, -v142, -v143
    ds_write_b128 v52, v[136:139] offset:6928
    s_waitcnt lgkmcnt(0)
    ds_read_b64_tr_b16 v[144:145], v53 offset:0
    ds_read_b64_tr_b16 v[146:147], v53 offset:576
    ds_read_b64_tr_b16 v[148:149], v53 offset:8
    ds_read_b64_tr_b16 v[150:151], v53 offset:584
    ds_read_b64_tr_b16 v[152:153], v53 offset:16
    ds_read_b64_tr_b16 v[154:155], v53 offset:592
    ds_read_b64_tr_b16 v[156:157], v53 offset:24
    ds_read_b64_tr_b16 v[158:159], v53 offset:600
    ds_read_b64_tr_b16 v[160:161], v53 offset:4608
    ds_read_b64_tr_b16 v[162:163], v53 offset:5184
    ds_read_b64_tr_b16 v[164:165], v53 offset:4616
    ds_read_b64_tr_b16 v[166:167], v53 offset:5192
    ds_read_b64_tr_b16 v[168:169], v53 offset:4624
    ds_read_b64_tr_b16 v[170:171], v53 offset:5200
    ds_read_b64_tr_b16 v[172:173], v53 offset:4632
    ds_read_b64_tr_b16 v[174:175], v53 offset:5208
    s_lshl_b32 s91, s73, 17
    s_add_u32 s92, s91, 4194304
    s_waitcnt lgkmcnt(0)
    buffer_store_dwordx4 v[144:147], v2, s[60:63], s91 offen offset:0 sc1
    buffer_store_dwordx4 v[148:151], v2, s[60:63], s91 offen offset:1024 sc1
    buffer_store_dwordx4 v[152:155], v2, s[60:63], s91 offen offset:2048 sc1
    buffer_store_dwordx4 v[156:159], v2, s[60:63], s91 offen offset:3072 sc1
    buffer_store_dwordx4 v[160:163], v2, s[60:63], s92 offen offset:0 sc1
    buffer_store_dwordx4 v[164:167], v2, s[60:63], s92 offen offset:1024 sc1
    buffer_store_dwordx4 v[168:171], v2, s[60:63], s92 offen offset:2048 sc1
    buffer_store_dwordx4 v[172:175], v2, s[60:63], s92 offen offset:3072 sc1
    s_mov_b32 s48, s14
    s_mov_b32 s49, s15
    s_mov_b32 s50, 0x200000
    s_mov_b32 s51, 0x20000
    v_lshrrev_b32 v44, 3, v1
    s_lshl_b32 s91, s78, 7
    s_lshl_b32 s94, s38, 5
    s_add_u32 s91, s91, s94
    v_add_u32 v44, s91, v44
    v_lshlrev_b32 v44, 11, v44
    v_and_b32 v45, 7, v1
    v_xor_b32 v45, v45, v41
    v_lshl_add_u32 v7, v45, 4, v44
    v_xor_b32 v8, 64, v7
    v_add_u32 v8, 0x4000, v8
    v_add_u32 v9, 30720, v7
    v_add_u32 v10, 29696, v8
    v_subrev_u32 v8, 1024, v8
    s_lshl_b32 s91, s78, 8
    v_lshl_add_u32 v11, v41, 3, s91
    s_mov_b32 s81, 0
    s_lshl_b32 s91, s77, 13
    s_lshl_b32 s92, s38, 11
    s_add_u32 s91, s91, s92
    v_lshl_add_u32 v2, v1, 4, s91
    v_lshrrev_b32 v27, 1, v42
    v_xor_b32 v28, v27, v41
    v_lshlrev_b32 v28, 4, v28
    v_lshl_add_u32 v28, v42, 7, v28
    v_add_u32 v12, 91136, v28
    v_xor_b32 v13, 64, v12
    v_lshrrev_b32 v27, 2, v42
    v_lshl_add_u32 v27, v41, 2, v27
    v_and_b32 v28, 3, v42
    v_lshlrev_b32 v28, 3, v28
    v_lshl_add_u32 v28, v27, 8, v28
    v_add_u32 v28, 91136, v28
    v_and_b32 v27, 7, v27
    v_xor_b32 v29, 0, v27
    v_lshl_add_u32 v16, v29, 5, v28
    v_xor_b32 v29, 1, v27
    v_lshl_add_u32 v17, v29, 5, v28
    v_xor_b32 v29, 2, v27
    v_lshl_add_u32 v18, v29, 5, v28
    v_xor_b32 v29, 3, v27
    v_lshl_add_u32 v19, v29, 5, v28
    v_xor_b32 v29, 4, v27
    v_lshl_add_u32 v20, v29, 5, v28
    v_xor_b32 v29, 5, v27
    v_lshl_add_u32 v21, v29, 5, v28
    v_xor_b32 v29, 6, v27
    v_lshl_add_u32 v22, v29, 5, v28
    v_xor_b32 v29, 7, v27
    v_lshl_add_u32 v23, v29, 5, v28
    s_lshl_b32 s91, s79, 13
    v_lshl_add_u32 v15, v1, 4, s91
    s_lshr_b32 s91, s77, 1
    s_xor_b32 s92, s72, 4
    v_cmp_eq_u32 vcc, 1, v1
    v_mov_b32 v24, s91
    v_mov_b32 v25, s92
    v_cndmask_b32 v24, v24, v25, vcc
    v_lshlrev_b32 v24, 7, v24
    v_mov_b32 v25, -2
    v_mov_b32 v29, 0
    s_movk_i32 s85, 0x1000
    s_lshr_b32 s91, s38, 1
    s_lshl_b32 s92, s77, 1
    s_add_u32 s91, s91, s92
    s_lshl_b32 s91, s91, 6
    s_and_b32 s92, s38, 1
    s_lshl_b32 s92, s92, 3
    s_add_u32 s89, s91, s92
    s_lshl_b32 s90, s38, 13
    s_add_u32 s90, s90, 37888
    s_mov_b32 s87, 0x200000
    s_lshr_b32 s86, s77, 1
    s_lshl_b32 s86, s86, 9
    s_add_u32 s86, s86, 40046592
    v_and_b32 v27, 3, v1
    v_lshlrev_b32 v27, 7, v27
    s_mov_b32 s95, 0xffff0000
    s_add_u32 s64, s36, 0x1a00000
    s_addc_u32 s65, s37, 0
    s_mov_b32 s66, 0x400000
    s_mov_b32 s67, 0x20000
    s_getpc_b64 s[8:9]
L_pc_3:
    s_sub_u32 s8, s8, L_pc_3-recurrent_scan__ssm_conv_s5__mixer_channel_mlp__prompt_kernel
    s_subb_u32 s9, s9, 0
    s_mov_b32 s10, L_code_end-recurrent_scan__ssm_conv_s5__mixer_channel_mlp__prompt_kernel
    s_mov_b32 s11, 0x20000
    s_lshr_b32 s93, s2, 3
    s_mul_i32 s93, s93, ((L_code_end-L_slast+4095)/4096)
    v_add_u32 v14, s93, v1
    v_lshlrev_b32 v14, 7, v14
    v_add_u32 v14, L_slast-recurrent_scan__ssm_conv_s5__mixer_channel_mlp__prompt_kernel, v14
    s_cmp_eq_u32 s38, 2
    s_cselect_b32 s93, ((L_code_end-L_slast+4095)/4096), 0
    v_cmp_gt_u32 vcc, s93, v1
    v_mov_b32 v43, 1073741824
    s_nop 0
    v_cndmask_b32 v14, v43, v14, vcc
    s_cmp_lg_u32 s76, 0
    s_cbranch_scc1 L_init1
    v_accvgpr_read_b32 v45, a184
    v_accvgpr_read_b32 v47, a185
    v_accvgpr_read_b32 v81, a152
    v_accvgpr_read_b32 v83, a153
    v_accvgpr_read_b32 v85, a154
    v_accvgpr_read_b32 v87, a155
    v_lshlrev_b32 v44, 16, v45
    v_and_b32 v45, s95, v45
    v_lshlrev_b32 v46, 16, v47
    v_and_b32 v47, s95, v47
    v_lshlrev_b32 v80, 16, v81
    v_and_b32 v81, s95, v81
    v_lshlrev_b32 v82, 16, v83
    v_and_b32 v83, s95, v83
    v_pk_mul_f32 v[80:81], v[80:81], v[44:45]
    v_pk_mul_f32 v[82:83], v[82:83], v[46:47]
    v_lshlrev_b32 v84, 16, v85
    v_and_b32 v85, s95, v85
    v_lshlrev_b32 v86, 16, v87
    v_and_b32 v87, s95, v87
    v_pk_mul_f32 v[84:85], v[84:85], v[44:45]
    v_pk_mul_f32 v[86:87], v[86:87], v[46:47]
    v_accvgpr_read_b32 v45, a186
    v_accvgpr_read_b32 v47, a187
    v_accvgpr_read_b32 v89, a156
    v_accvgpr_read_b32 v91, a157
    v_accvgpr_read_b32 v93, a158
    v_accvgpr_read_b32 v95, a159
    v_lshlrev_b32 v44, 16, v45
    v_and_b32 v45, s95, v45
    v_lshlrev_b32 v46, 16, v47
    v_and_b32 v47, s95, v47
    v_lshlrev_b32 v88, 16, v89
    v_and_b32 v89, s95, v89
    v_lshlrev_b32 v90, 16, v91
    v_and_b32 v91, s95, v91
    v_pk_mul_f32 v[88:89], v[88:89], v[44:45]
    v_pk_mul_f32 v[90:91], v[90:91], v[46:47]
    v_lshlrev_b32 v92, 16, v93
    v_and_b32 v93, s95, v93
    v_lshlrev_b32 v94, 16, v95
    v_and_b32 v95, s95, v95
    v_pk_mul_f32 v[92:93], v[92:93], v[44:45]
    v_pk_mul_f32 v[94:95], v[94:95], v[46:47]
    v_accvgpr_read_b32 v45, a188
    v_accvgpr_read_b32 v47, a189
    v_accvgpr_read_b32 v97, a160
    v_accvgpr_read_b32 v99, a161
    v_accvgpr_read_b32 v101, a162
    v_accvgpr_read_b32 v103, a163
    v_lshlrev_b32 v44, 16, v45
    v_and_b32 v45, s95, v45
    v_lshlrev_b32 v46, 16, v47
    v_and_b32 v47, s95, v47
    v_lshlrev_b32 v96, 16, v97
    v_and_b32 v97, s95, v97
    v_lshlrev_b32 v98, 16, v99
    v_and_b32 v99, s95, v99
    v_pk_mul_f32 v[96:97], v[96:97], v[44:45]
    v_pk_mul_f32 v[98:99], v[98:99], v[46:47]
    v_lshlrev_b32 v100, 16, v101
    v_and_b32 v101, s95, v101
    v_lshlrev_b32 v102, 16, v103
    v_and_b32 v103, s95, v103
    v_pk_mul_f32 v[100:101], v[100:101], v[44:45]
    v_pk_mul_f32 v[102:103], v[102:103], v[46:47]
    v_accvgpr_read_b32 v45, a190
    v_accvgpr_read_b32 v47, a191
    v_accvgpr_read_b32 v105, a164
    v_accvgpr_read_b32 v107, a165
    v_accvgpr_read_b32 v109, a166
    v_accvgpr_read_b32 v111, a167
    v_lshlrev_b32 v44, 16, v45
    v_and_b32 v45, s95, v45
    v_lshlrev_b32 v46, 16, v47
    v_and_b32 v47, s95, v47
    v_lshlrev_b32 v104, 16, v105
    v_and_b32 v105, s95, v105
    v_lshlrev_b32 v106, 16, v107
    v_and_b32 v107, s95, v107
    v_pk_mul_f32 v[104:105], v[104:105], v[44:45]
    v_pk_mul_f32 v[106:107], v[106:107], v[46:47]
    v_lshlrev_b32 v108, 16, v109
    v_and_b32 v109, s95, v109
    v_lshlrev_b32 v110, 16, v111
    v_and_b32 v111, s95, v111
    v_pk_mul_f32 v[108:109], v[108:109], v[44:45]
    v_pk_mul_f32 v[110:111], v[110:111], v[46:47]
    v_accvgpr_read_b32 v45, a192
    v_accvgpr_read_b32 v47, a193
    v_accvgpr_read_b32 v113, a168
    v_accvgpr_read_b32 v115, a169
    v_accvgpr_read_b32 v117, a170
    v_accvgpr_read_b32 v119, a171
    v_lshlrev_b32 v44, 16, v45
    v_and_b32 v45, s95, v45
    v_lshlrev_b32 v46, 16, v47
    v_and_b32 v47, s95, v47
    v_lshlrev_b32 v112, 16, v113
    v_and_b32 v113, s95, v113
    v_lshlrev_b32 v114, 16, v115
    v_and_b32 v115, s95, v115
    v_pk_mul_f32 v[112:113], v[112:113], v[44:45]
    v_pk_mul_f32 v[114:115], v[114:115], v[46:47]
    v_lshlrev_b32 v116, 16, v117
    v_and_b32 v117, s95, v117
    v_lshlrev_b32 v118, 16, v119
    v_and_b32 v119, s95, v119
    v_pk_mul_f32 v[116:117], v[116:117], v[44:45]
    v_pk_mul_f32 v[118:119], v[118:119], v[46:47]
    v_accvgpr_read_b32 v45, a194
    v_accvgpr_read_b32 v47, a195
    v_accvgpr_read_b32 v121, a172
    v_accvgpr_read_b32 v123, a173
    v_accvgpr_read_b32 v125, a174
    v_accvgpr_read_b32 v127, a175
    v_lshlrev_b32 v44, 16, v45
    v_and_b32 v45, s95, v45
    v_lshlrev_b32 v46, 16, v47
    v_and_b32 v47, s95, v47
    v_lshlrev_b32 v120, 16, v121
    v_and_b32 v121, s95, v121
    v_lshlrev_b32 v122, 16, v123
    v_and_b32 v123, s95, v123
    v_pk_mul_f32 v[120:121], v[120:121], v[44:45]
    v_pk_mul_f32 v[122:123], v[122:123], v[46:47]
    v_lshlrev_b32 v124, 16, v125
    v_and_b32 v125, s95, v125
    v_lshlrev_b32 v126, 16, v127
    v_and_b32 v127, s95, v127
    v_pk_mul_f32 v[124:125], v[124:125], v[44:45]
    v_pk_mul_f32 v[126:127], v[126:127], v[46:47]
    v_accvgpr_read_b32 v45, a196
    v_accvgpr_read_b32 v47, a197
    v_accvgpr_read_b32 v129, a176
    v_accvgpr_read_b32 v131, a177
    v_accvgpr_read_b32 v133, a178
    v_accvgpr_read_b32 v135, a179
    v_lshlrev_b32 v44, 16, v45
    v_and_b32 v45, s95, v45
    v_lshlrev_b32 v46, 16, v47
    v_and_b32 v47, s95, v47
    v_lshlrev_b32 v128, 16, v129
    v_and_b32 v129, s95, v129
    v_lshlrev_b32 v130, 16, v131
    v_and_b32 v131, s95, v131
    v_pk_mul_f32 v[128:129], v[128:129], v[44:45]
    v_pk_mul_f32 v[130:131], v[130:131], v[46:47]
    v_lshlrev_b32 v132, 16, v133
    v_and_b32 v133, s95, v133
    v_lshlrev_b32 v134, 16, v135
    v_and_b32 v135, s95, v135
    v_pk_mul_f32 v[132:133], v[132:133], v[44:45]
    v_pk_mul_f32 v[134:135], v[134:135], v[46:47]
    v_accvgpr_read_b32 v45, a198
    v_accvgpr_read_b32 v47, a199
    v_accvgpr_read_b32 v137, a180
    v_accvgpr_read_b32 v139, a181
    v_accvgpr_read_b32 v141, a182
    v_accvgpr_read_b32 v143, a183
    v_lshlrev_b32 v44, 16, v45
    v_and_b32 v45, s95, v45
    v_lshlrev_b32 v46, 16, v47
    v_and_b32 v47, s95, v47
    v_lshlrev_b32 v136, 16, v137
    v_and_b32 v137, s95, v137
    v_lshlrev_b32 v138, 16, v139
    v_and_b32 v139, s95, v139
    v_pk_mul_f32 v[136:137], v[136:137], v[44:45]
    v_pk_mul_f32 v[138:139], v[138:139], v[46:47]
    v_lshlrev_b32 v140, 16, v141
    v_and_b32 v141, s95, v141
    v_lshlrev_b32 v142, 16, v143
    v_and_b32 v143, s95, v143
    v_pk_mul_f32 v[140:141], v[140:141], v[44:45]
    v_pk_mul_f32 v[142:143], v[142:143], v[46:47]
    s_mov_b32 s80, 8388608
    s_mov_b32 s54, 1835008
    s_mov_b32 s88, 10
    s_branch L_init2
L_init1:
    s_mov_b32 s80, 12058624
    s_mov_b32 s88, 41
L_init2:
    s_mov_b32 s92, 1048576
L_pollB:
    buffer_load_dword v45, v27, s[40:43], s86 offen sc1
    s_waitcnt vmcnt(0)
    v_cmp_gt_u32 vcc, 8, v45
    s_sub_u32 s92, s92, 1
    s_cselect_b64 vcc, 0, vcc
    s_cbranch_vccnz L_pollB
    buffer_load_dwordx4 a[0:3], v2, s[60:63], s80 offen offset:0 sc1
    buffer_load_dwordx4 a[4:7], v2, s[60:63], s80 offen offset:1024 sc1
    s_add_u32 s80, s80, 131072
    buffer_load_dwordx4 a[8:11], v2, s[60:63], s80 offen offset:0 sc1
    buffer_load_dwordx4 a[12:15], v2, s[60:63], s80 offen offset:1024 sc1
    s_add_u32 s80, s80, 131072
    buffer_load_dwordx4 a[16:19], v2, s[60:63], s80 offen offset:0 sc1
    buffer_load_dwordx4 a[20:23], v2, s[60:63], s80 offen offset:1024 sc1
    s_add_u32 s80, s80, 131072
    buffer_load_dwordx4 a[24:27], v2, s[60:63], s80 offen offset:0 sc1
    buffer_load_dwordx4 a[28:31], v2, s[60:63], s80 offen offset:1024 sc1
    s_add_u32 s80, s80, 131072
    buffer_load_dwordx4 a[32:35], v2, s[60:63], s80 offen offset:0 sc1
    buffer_load_dwordx4 a[36:39], v2, s[60:63], s80 offen offset:1024 sc1
    s_add_u32 s80, s80, 131072
    buffer_load_dwordx4 a[40:43], v2, s[60:63], s80 offen offset:0 sc1
    buffer_load_dwordx4 a[44:47], v2, s[60:63], s80 offen offset:1024 sc1
    s_add_u32 s80, s80, 131072
    buffer_load_dwordx4 a[48:51], v2, s[60:63], s80 offen offset:0 sc1
    buffer_load_dwordx4 a[52:55], v2, s[60:63], s80 offen offset:1024 sc1
    s_add_u32 s80, s80, 131072
    s_add_u32 m0, s83, 32768
    s_barrier
    s_cmp_lg_u32 s38, 0
    s_cbranch_scc1 L_noarrh
    s_lshl_b32 s91, s72, 7
    s_add_u32 s91, s91, 40050688
    v_mov_b32 v44, 0
    v_mov_b32 v45, 1
    s_mov_b64 exec, 1
    buffer_atomic_add v45, v44, s[40:43], s91 offen sc1
    s_mov_b64 exec, -1
L_noarrh:
    ds_read_b64_tr_b16 a[64:65], v16 offset:0
    ds_read_b64_tr_b16 a[66:67], v16 offset:4096
    ds_read_b64_tr_b16 a[68:69], v17 offset:0
    ds_read_b64_tr_b16 a[70:71], v17 offset:4096
    ds_read_b64_tr_b16 a[72:73], v18 offset:0
    ds_read_b64_tr_b16 a[74:75], v18 offset:4096
    ds_read_b64_tr_b16 a[76:77], v19 offset:0
    ds_read_b64_tr_b16 a[78:79], v19 offset:4096
    ds_read_b64_tr_b16 a[80:81], v20 offset:0
    ds_read_b64_tr_b16 a[82:83], v20 offset:4096
    ds_read_b64_tr_b16 a[84:85], v21 offset:0
    ds_read_b64_tr_b16 a[86:87], v21 offset:4096
    ds_read_b64_tr_b16 a[88:89], v22 offset:0
    ds_read_b64_tr_b16 a[90:91], v22 offset:4096
    ds_read_b64_tr_b16 a[92:93], v23 offset:0
    ds_read_b64_tr_b16 a[94:95], v23 offset:4096
L_gloop:
    s_waitcnt vmcnt(12) lgkmcnt(12)
    v_mfma_f32_16x16x32_bf16 v[176:179], a[64:67], a[0:3], v[176:179]
    ds_read_b64_tr_b16 a[96:97], v16 offset:8192
    ds_read_b64_tr_b16 a[98:99], v16 offset:12288
    v_mfma_f32_16x16x32_bf16 v[180:183], a[64:67], a[4:7], v[180:183]
    buffer_load_dwordx4 a[56:59], v2, s[60:63], s80 offen offset:0 sc1
    v_mfma_f32_16x16x32_bf16 v[188:191], a[68:71], a[4:7], v[188:191]
    ds_read_b64_tr_b16 a[100:101], v17 offset:8192
    ds_read_b64_tr_b16 a[102:103], v17 offset:12288
    v_mfma_f32_16x16x32_bf16 v[184:187], a[68:71], a[0:3], v[184:187]
    s_waitcnt lgkmcnt(12)
    v_mfma_f32_16x16x32_bf16 v[192:195], a[72:75], a[0:3], v[192:195]
    ds_read_b64_tr_b16 a[104:105], v18 offset:8192
    ds_read_b64_tr_b16 a[106:107], v18 offset:12288
    v_mfma_f32_16x16x32_bf16 v[196:199], a[72:75], a[4:7], v[196:199]
    buffer_load_dwordx4 v5, s[52:55], s82 offen offset:2048 lds
    v_mfma_f32_16x16x32_bf16 v[204:207], a[76:79], a[4:7], v[204:207]
    ds_read_b64_tr_b16 a[108:109], v19 offset:8192
    ds_read_b64_tr_b16 a[110:111], v19 offset:12288
    v_mfma_f32_16x16x32_bf16 v[200:203], a[76:79], a[0:3], v[200:203]
    s_waitcnt lgkmcnt(12)
    v_mfma_f32_16x16x32_bf16 v[208:211], a[80:83], a[0:3], v[208:211]
    ds_read_b64_tr_b16 a[112:113], v20 offset:8192
    ds_read_b64_tr_b16 a[114:115], v20 offset:12288
    v_mfma_f32_16x16x32_bf16 v[212:215], a[80:83], a[4:7], v[212:215]
    buffer_load_dwordx4 a[60:63], v2, s[60:63], s80 offen offset:1024 sc1
    s_add_u32 s80, s80, 131072
    v_mfma_f32_16x16x32_bf16 v[220:223], a[84:87], a[4:7], v[220:223]
    ds_read_b64_tr_b16 a[116:117], v21 offset:8192
    ds_read_b64_tr_b16 a[118:119], v21 offset:12288
    v_mfma_f32_16x16x32_bf16 v[216:219], a[84:87], a[0:3], v[216:219]
    s_waitcnt lgkmcnt(12)
    v_mfma_f32_16x16x32_bf16 v[224:227], a[88:91], a[0:3], v[224:227]
    ds_read_b64_tr_b16 a[120:121], v22 offset:8192
    ds_read_b64_tr_b16 a[122:123], v22 offset:12288
    v_mfma_f32_16x16x32_bf16 v[228:231], a[88:91], a[4:7], v[228:231]
    buffer_load_dwordx4 v6, s[52:55], s82 offen offset:3072 lds
    s_add_u32 s82, s82, 131072
    v_mfma_f32_16x16x32_bf16 v[236:239], a[92:95], a[4:7], v[236:239]
    ds_read_b64_tr_b16 a[124:125], v23 offset:8192
    ds_read_b64_tr_b16 a[126:127], v23 offset:12288
    v_mfma_f32_16x16x32_bf16 v[232:235], a[92:95], a[0:3], v[232:235]
    s_waitcnt vmcnt(8)
    s_barrier
    s_waitcnt vmcnt(14) lgkmcnt(12)
    v_mfma_f32_16x16x32_bf16 v[176:179], a[96:99], a[8:11], v[176:179]
    ds_read_b64_tr_b16 a[64:65], v16 offset:16384
    ds_read_b64_tr_b16 a[66:67], v16 offset:20480
    v_mfma_f32_16x16x32_bf16 v[180:183], a[96:99], a[12:15], v[180:183]
    buffer_load_dwordx4 a[0:3], v2, s[60:63], s80 offen offset:0 sc1
    v_mfma_f32_16x16x32_bf16 v[188:191], a[100:103], a[12:15], v[188:191]
    ds_read_b64_tr_b16 a[68:69], v17 offset:16384
    ds_read_b64_tr_b16 a[70:71], v17 offset:20480
    v_mfma_f32_16x16x32_bf16 v[184:187], a[100:103], a[8:11], v[184:187]
    s_waitcnt lgkmcnt(12)
    s_add_u32 m0, s83, 49152
    v_mfma_f32_16x16x32_bf16 v[192:195], a[104:107], a[8:11], v[192:195]
    ds_read_b64_tr_b16 a[72:73], v18 offset:16384
    ds_read_b64_tr_b16 a[74:75], v18 offset:20480
    v_mfma_f32_16x16x32_bf16 v[196:199], a[104:107], a[12:15], v[196:199]
    buffer_load_dwordx4 v3, s[52:55], s82 offen offset:0 lds
    v_mfma_f32_16x16x32_bf16 v[204:207], a[108:111], a[12:15], v[204:207]
    ds_read_b64_tr_b16 a[76:77], v19 offset:16384
    ds_read_b64_tr_b16 a[78:79], v19 offset:20480
    v_mfma_f32_16x16x32_bf16 v[200:203], a[108:111], a[8:11], v[200:203]
    s_waitcnt lgkmcnt(12)
    v_mfma_f32_16x16x32_bf16 v[208:211], a[112:115], a[8:11], v[208:211]
    ds_read_b64_tr_b16 a[80:81], v20 offset:16384
    ds_read_b64_tr_b16 a[82:83], v20 offset:20480
    v_mfma_f32_16x16x32_bf16 v[212:215], a[112:115], a[12:15], v[212:215]
    buffer_load_dwordx4 a[4:7], v2, s[60:63], s80 offen offset:1024 sc1
    s_add_u32 s80, s80, 131072
    v_mfma_f32_16x16x32_bf16 v[220:223], a[116:119], a[12:15], v[220:223]
    ds_read_b64_tr_b16 a[84:85], v21 offset:16384
    ds_read_b64_tr_b16 a[86:87], v21 offset:20480
    v_mfma_f32_16x16x32_bf16 v[216:219], a[116:119], a[8:11], v[216:219]
    s_waitcnt lgkmcnt(12)
    v_mfma_f32_16x16x32_bf16 v[224:227], a[120:123], a[8:11], v[224:227]
    ds_read_b64_tr_b16 a[88:89], v22 offset:16384
    ds_read_b64_tr_b16 a[90:91], v22 offset:20480
    v_mfma_f32_16x16x32_bf16 v[228:231], a[120:123], a[12:15], v[228:231]
    buffer_load_dwordx4 v4, s[52:55], s82 offen offset:1024 lds
    v_mfma_f32_16x16x32_bf16 v[236:239], a[124:127], a[12:15], v[236:239]
    ds_read_b64_tr_b16 a[92:93], v23 offset:16384
    ds_read_b64_tr_b16 a[94:95], v23 offset:20480
    v_mfma_f32_16x16x32_bf16 v[232:235], a[124:127], a[8:11], v[232:235]
    s_cmp_eq_u32 s88, 1
    s_cbranch_scc1 L_gdone
    s_waitcnt vmcnt(16) lgkmcnt(12)
    v_mfma_f32_16x16x32_bf16 v[176:179], a[64:67], a[16:19], v[176:179]
    ds_read_b64_tr_b16 a[96:97], v16 offset:24576
    ds_read_b64_tr_b16 a[98:99], v16 offset:28672
    v_mfma_f32_16x16x32_bf16 v[180:183], a[64:67], a[20:23], v[180:183]
    buffer_load_dwordx4 a[8:11], v2, s[60:63], s80 offen offset:0 sc1
    v_mfma_f32_16x16x32_bf16 v[188:191], a[68:71], a[20:23], v[188:191]
    ds_read_b64_tr_b16 a[100:101], v17 offset:24576
    ds_read_b64_tr_b16 a[102:103], v17 offset:28672
    v_mfma_f32_16x16x32_bf16 v[184:187], a[68:71], a[16:19], v[184:187]
    s_waitcnt lgkmcnt(12)
    v_mfma_f32_16x16x32_bf16 v[192:195], a[72:75], a[16:19], v[192:195]
    ds_read_b64_tr_b16 a[104:105], v18 offset:24576
    ds_read_b64_tr_b16 a[106:107], v18 offset:28672
    v_mfma_f32_16x16x32_bf16 v[196:199], a[72:75], a[20:23], v[196:199]
    buffer_load_dwordx4 v5, s[52:55], s82 offen offset:2048 lds
    v_mfma_f32_16x16x32_bf16 v[204:207], a[76:79], a[20:23], v[204:207]
    ds_read_b64_tr_b16 a[108:109], v19 offset:24576
    ds_read_b64_tr_b16 a[110:111], v19 offset:28672
    v_mfma_f32_16x16x32_bf16 v[200:203], a[76:79], a[16:19], v[200:203]
    s_waitcnt lgkmcnt(12)
    v_mfma_f32_16x16x32_bf16 v[208:211], a[80:83], a[16:19], v[208:211]
    ds_read_b64_tr_b16 a[112:113], v20 offset:24576
    ds_read_b64_tr_b16 a[114:115], v20 offset:28672
    v_mfma_f32_16x16x32_bf16 v[212:215], a[80:83], a[20:23], v[212:215]
    buffer_load_dwordx4 a[12:15], v2, s[60:63], s80 offen offset:1024 sc1
    s_add_u32 s80, s80, 131072
    v_mfma_f32_16x16x32_bf16 v[220:223], a[84:87], a[20:23], v[220:223]
    ds_read_b64_tr_b16 a[116:117], v21 offset:24576
    ds_read_b64_tr_b16 a[118:119], v21 offset:28672
    v_mfma_f32_16x16x32_bf16 v[216:219], a[84:87], a[16:19], v[216:219]
    s_waitcnt lgkmcnt(12)
    v_mfma_f32_16x16x32_bf16 v[224:227], a[88:91], a[16:19], v[224:227]
    ds_read_b64_tr_b16 a[120:121], v22 offset:24576
    ds_read_b64_tr_b16 a[122:123], v22 offset:28672
    v_mfma_f32_16x16x32_bf16 v[228:231], a[88:91], a[20:23], v[228:231]
    buffer_load_dwordx4 v6, s[52:55], s82 offen offset:3072 lds
    s_add_u32 s82, s82, 131072
    v_mfma_f32_16x16x32_bf16 v[236:239], a[92:95], a[20:23], v[236:239]
    ds_read_b64_tr_b16 a[124:125], v23 offset:24576
    ds_read_b64_tr_b16 a[126:127], v23 offset:28672
    v_mfma_f32_16x16x32_bf16 v[232:235], a[92:95], a[16:19], v[232:235]
    s_waitcnt vmcnt(8)
    s_barrier
    s_waitcnt lgkmcnt(12)
    v_mfma_f32_16x16x32_bf16 v[176:179], a[96:99], a[24:27], v[176:179]
    ds_read_b64_tr_b16 a[64:65], v16 offset:32768
    ds_read_b64_tr_b16 a[66:67], v16 offset:36864
    v_mfma_f32_16x16x32_bf16 v[180:183], a[96:99], a[28:31], v[180:183]
    buffer_load_dwordx4 a[16:19], v2, s[60:63], s80 offen offset:0 sc1
    v_mfma_f32_16x16x32_bf16 v[188:191], a[100:103], a[28:31], v[188:191]
    ds_read_b64_tr_b16 a[68:69], v17 offset:32768
    ds_read_b64_tr_b16 a[70:71], v17 offset:36864
    v_mfma_f32_16x16x32_bf16 v[184:187], a[100:103], a[24:27], v[184:187]
    s_waitcnt lgkmcnt(12)
    s_add_u32 m0, s83, 0
    v_mfma_f32_16x16x32_bf16 v[192:195], a[104:107], a[24:27], v[192:195]
    ds_read_b64_tr_b16 a[72:73], v18 offset:32768
    ds_read_b64_tr_b16 a[74:75], v18 offset:36864
    v_mfma_f32_16x16x32_bf16 v[196:199], a[104:107], a[28:31], v[196:199]
    buffer_load_dwordx4 v3, s[52:55], s82 offen offset:0 lds
    v_mfma_f32_16x16x32_bf16 v[204:207], a[108:111], a[28:31], v[204:207]
    ds_read_b64_tr_b16 a[76:77], v19 offset:32768
    ds_read_b64_tr_b16 a[78:79], v19 offset:36864
    v_mfma_f32_16x16x32_bf16 v[200:203], a[108:111], a[24:27], v[200:203]
    s_waitcnt lgkmcnt(12)
    v_mfma_f32_16x16x32_bf16 v[208:211], a[112:115], a[24:27], v[208:211]
    ds_read_b64_tr_b16 a[80:81], v20 offset:32768
    ds_read_b64_tr_b16 a[82:83], v20 offset:36864
    v_mfma_f32_16x16x32_bf16 v[212:215], a[112:115], a[28:31], v[212:215]
    buffer_load_dwordx4 a[20:23], v2, s[60:63], s80 offen offset:1024 sc1
    s_add_u32 s80, s80, 131072
    v_mfma_f32_16x16x32_bf16 v[220:223], a[116:119], a[28:31], v[220:223]
    ds_read_b64_tr_b16 a[84:85], v21 offset:32768
    ds_read_b64_tr_b16 a[86:87], v21 offset:36864
    v_mfma_f32_16x16x32_bf16 v[216:219], a[116:119], a[24:27], v[216:219]
    s_waitcnt lgkmcnt(12)
    v_mfma_f32_16x16x32_bf16 v[224:227], a[120:123], a[24:27], v[224:227]
    ds_read_b64_tr_b16 a[88:89], v22 offset:32768
    ds_read_b64_tr_b16 a[90:91], v22 offset:36864
    v_mfma_f32_16x16x32_bf16 v[228:231], a[120:123], a[28:31], v[228:231]
    buffer_load_dwordx4 v4, s[52:55], s82 offen offset:1024 lds
    v_mfma_f32_16x16x32_bf16 v[236:239], a[124:127], a[28:31], v[236:239]
    ds_read_b64_tr_b16 a[92:93], v23 offset:32768
    ds_read_b64_tr_b16 a[94:95], v23 offset:36864
    v_mfma_f32_16x16x32_bf16 v[232:235], a[124:127], a[24:27], v[232:235]
    s_cmp_eq_u32 s88, 2
    s_cbranch_scc1 L_gdone
    s_waitcnt lgkmcnt(12)
    v_mfma_f32_16x16x32_bf16 v[176:179], a[64:67], a[32:35], v[176:179]
    ds_read_b64_tr_b16 a[96:97], v16 offset:40960
    ds_read_b64_tr_b16 a[98:99], v16 offset:45056
    v_mfma_f32_16x16x32_bf16 v[180:183], a[64:67], a[36:39], v[180:183]
    buffer_load_dwordx4 a[24:27], v2, s[60:63], s80 offen offset:0 sc1
    v_mfma_f32_16x16x32_bf16 v[188:191], a[68:71], a[36:39], v[188:191]
    ds_read_b64_tr_b16 a[100:101], v17 offset:40960
    ds_read_b64_tr_b16 a[102:103], v17 offset:45056
    v_mfma_f32_16x16x32_bf16 v[184:187], a[68:71], a[32:35], v[184:187]
    s_waitcnt lgkmcnt(12)
    v_mfma_f32_16x16x32_bf16 v[192:195], a[72:75], a[32:35], v[192:195]
    ds_read_b64_tr_b16 a[104:105], v18 offset:40960
    ds_read_b64_tr_b16 a[106:107], v18 offset:45056
    v_mfma_f32_16x16x32_bf16 v[196:199], a[72:75], a[36:39], v[196:199]
    buffer_load_dwordx4 v5, s[52:55], s82 offen offset:2048 lds
    v_mfma_f32_16x16x32_bf16 v[204:207], a[76:79], a[36:39], v[204:207]
    ds_read_b64_tr_b16 a[108:109], v19 offset:40960
    ds_read_b64_tr_b16 a[110:111], v19 offset:45056
    v_mfma_f32_16x16x32_bf16 v[200:203], a[76:79], a[32:35], v[200:203]
    s_waitcnt lgkmcnt(12)
    v_mfma_f32_16x16x32_bf16 v[208:211], a[80:83], a[32:35], v[208:211]
    ds_read_b64_tr_b16 a[112:113], v20 offset:40960
    ds_read_b64_tr_b16 a[114:115], v20 offset:45056
    v_mfma_f32_16x16x32_bf16 v[212:215], a[80:83], a[36:39], v[212:215]
    buffer_load_dwordx4 a[28:31], v2, s[60:63], s80 offen offset:1024 sc1
    s_add_u32 s80, s80, 131072
    v_mfma_f32_16x16x32_bf16 v[220:223], a[84:87], a[36:39], v[220:223]
    ds_read_b64_tr_b16 a[116:117], v21 offset:40960
    ds_read_b64_tr_b16 a[118:119], v21 offset:45056
    v_mfma_f32_16x16x32_bf16 v[216:219], a[84:87], a[32:35], v[216:219]
    s_waitcnt lgkmcnt(12)
    v_mfma_f32_16x16x32_bf16 v[224:227], a[88:91], a[32:35], v[224:227]
    ds_read_b64_tr_b16 a[120:121], v22 offset:40960
    ds_read_b64_tr_b16 a[122:123], v22 offset:45056
    v_mfma_f32_16x16x32_bf16 v[228:231], a[88:91], a[36:39], v[228:231]
    buffer_load_dwordx4 v6, s[52:55], s82 offen offset:3072 lds
    s_add_u32 s82, s82, 131072
    v_mfma_f32_16x16x32_bf16 v[236:239], a[92:95], a[36:39], v[236:239]
    ds_read_b64_tr_b16 a[124:125], v23 offset:40960
    ds_read_b64_tr_b16 a[126:127], v23 offset:45056
    v_mfma_f32_16x16x32_bf16 v[232:235], a[92:95], a[32:35], v[232:235]
    s_waitcnt vmcnt(8)
    s_barrier
    s_waitcnt lgkmcnt(12)
    v_mfma_f32_16x16x32_bf16 v[176:179], a[96:99], a[40:43], v[176:179]
    ds_read_b64_tr_b16 a[64:65], v16 offset:49152
    ds_read_b64_tr_b16 a[66:67], v16 offset:53248
    v_mfma_f32_16x16x32_bf16 v[180:183], a[96:99], a[44:47], v[180:183]
    buffer_load_dwordx4 a[32:35], v2, s[60:63], s80 offen offset:0 sc1
    v_mfma_f32_16x16x32_bf16 v[188:191], a[100:103], a[44:47], v[188:191]
    ds_read_b64_tr_b16 a[68:69], v17 offset:49152
    ds_read_b64_tr_b16 a[70:71], v17 offset:53248
    v_mfma_f32_16x16x32_bf16 v[184:187], a[100:103], a[40:43], v[184:187]
    s_waitcnt lgkmcnt(12)
    s_add_u32 m0, s83, 16384
    v_mfma_f32_16x16x32_bf16 v[192:195], a[104:107], a[40:43], v[192:195]
    ds_read_b64_tr_b16 a[72:73], v18 offset:49152
    ds_read_b64_tr_b16 a[74:75], v18 offset:53248
    v_mfma_f32_16x16x32_bf16 v[196:199], a[104:107], a[44:47], v[196:199]
    buffer_load_dwordx4 v3, s[52:55], s82 offen offset:0 lds
    v_mfma_f32_16x16x32_bf16 v[204:207], a[108:111], a[44:47], v[204:207]
    ds_read_b64_tr_b16 a[76:77], v19 offset:49152
    ds_read_b64_tr_b16 a[78:79], v19 offset:53248
    v_mfma_f32_16x16x32_bf16 v[200:203], a[108:111], a[40:43], v[200:203]
    s_waitcnt lgkmcnt(12)
    v_mfma_f32_16x16x32_bf16 v[208:211], a[112:115], a[40:43], v[208:211]
    ds_read_b64_tr_b16 a[80:81], v20 offset:49152
    ds_read_b64_tr_b16 a[82:83], v20 offset:53248
    v_mfma_f32_16x16x32_bf16 v[212:215], a[112:115], a[44:47], v[212:215]
    buffer_load_dwordx4 a[36:39], v2, s[60:63], s80 offen offset:1024 sc1
    s_add_u32 s80, s80, 131072
    v_mfma_f32_16x16x32_bf16 v[220:223], a[116:119], a[44:47], v[220:223]
    ds_read_b64_tr_b16 a[84:85], v21 offset:49152
    ds_read_b64_tr_b16 a[86:87], v21 offset:53248
    v_mfma_f32_16x16x32_bf16 v[216:219], a[116:119], a[40:43], v[216:219]
    s_waitcnt lgkmcnt(12)
    v_mfma_f32_16x16x32_bf16 v[224:227], a[120:123], a[40:43], v[224:227]
    ds_read_b64_tr_b16 a[88:89], v22 offset:49152
    ds_read_b64_tr_b16 a[90:91], v22 offset:53248
    v_mfma_f32_16x16x32_bf16 v[228:231], a[120:123], a[44:47], v[228:231]
    buffer_load_dwordx4 v4, s[52:55], s82 offen offset:1024 lds
    v_mfma_f32_16x16x32_bf16 v[236:239], a[124:127], a[44:47], v[236:239]
    ds_read_b64_tr_b16 a[92:93], v23 offset:49152
    ds_read_b64_tr_b16 a[94:95], v23 offset:53248
    v_mfma_f32_16x16x32_bf16 v[232:235], a[124:127], a[40:43], v[232:235]
    s_waitcnt lgkmcnt(12)
    v_mfma_f32_16x16x32_bf16 v[176:179], a[64:67], a[48:51], v[176:179]
    ds_read_b64_tr_b16 a[96:97], v16 offset:57344
    ds_read_b64_tr_b16 a[98:99], v16 offset:61440
    v_mfma_f32_16x16x32_bf16 v[180:183], a[64:67], a[52:55], v[180:183]
    buffer_load_dwordx4 a[40:43], v2, s[60:63], s80 offen offset:0 sc1
    v_mfma_f32_16x16x32_bf16 v[188:191], a[68:71], a[52:55], v[188:191]
    ds_read_b64_tr_b16 a[100:101], v17 offset:57344
    ds_read_b64_tr_b16 a[102:103], v17 offset:61440
    v_mfma_f32_16x16x32_bf16 v[184:187], a[68:71], a[48:51], v[184:187]
    s_waitcnt lgkmcnt(12)
    v_mfma_f32_16x16x32_bf16 v[192:195], a[72:75], a[48:51], v[192:195]
    ds_read_b64_tr_b16 a[104:105], v18 offset:57344
    ds_read_b64_tr_b16 a[106:107], v18 offset:61440
    v_mfma_f32_16x16x32_bf16 v[196:199], a[72:75], a[52:55], v[196:199]
    buffer_load_dwordx4 v5, s[52:55], s82 offen offset:2048 lds
    v_mfma_f32_16x16x32_bf16 v[204:207], a[76:79], a[52:55], v[204:207]
    ds_read_b64_tr_b16 a[108:109], v19 offset:57344
    ds_read_b64_tr_b16 a[110:111], v19 offset:61440
    v_mfma_f32_16x16x32_bf16 v[200:203], a[76:79], a[48:51], v[200:203]
    s_waitcnt lgkmcnt(12)
    v_mfma_f32_16x16x32_bf16 v[208:211], a[80:83], a[48:51], v[208:211]
    ds_read_b64_tr_b16 a[112:113], v20 offset:57344
    ds_read_b64_tr_b16 a[114:115], v20 offset:61440
    v_mfma_f32_16x16x32_bf16 v[212:215], a[80:83], a[52:55], v[212:215]
    buffer_load_dwordx4 a[44:47], v2, s[60:63], s80 offen offset:1024 sc1
    s_add_u32 s80, s80, 131072
    v_mfma_f32_16x16x32_bf16 v[220:223], a[84:87], a[52:55], v[220:223]
    ds_read_b64_tr_b16 a[116:117], v21 offset:57344
    ds_read_b64_tr_b16 a[118:119], v21 offset:61440
    v_mfma_f32_16x16x32_bf16 v[216:219], a[84:87], a[48:51], v[216:219]
    s_waitcnt lgkmcnt(12)
    v_mfma_f32_16x16x32_bf16 v[224:227], a[88:91], a[48:51], v[224:227]
    ds_read_b64_tr_b16 a[120:121], v22 offset:57344
    ds_read_b64_tr_b16 a[122:123], v22 offset:61440
    v_mfma_f32_16x16x32_bf16 v[228:231], a[88:91], a[52:55], v[228:231]
    buffer_load_dwordx4 v6, s[52:55], s82 offen offset:3072 lds
    s_add_u32 s82, s82, 131072
    v_mfma_f32_16x16x32_bf16 v[236:239], a[92:95], a[52:55], v[236:239]
    ds_read_b64_tr_b16 a[124:125], v23 offset:57344
    ds_read_b64_tr_b16 a[126:127], v23 offset:61440
    v_mfma_f32_16x16x32_bf16 v[232:235], a[92:95], a[48:51], v[232:235]
    s_waitcnt vmcnt(8)
    s_barrier
    s_waitcnt lgkmcnt(12)
    v_mfma_f32_16x16x32_bf16 v[176:179], a[96:99], a[56:59], v[176:179]
    ds_read_b64_tr_b16 a[64:65], v16 offset:0
    ds_read_b64_tr_b16 a[66:67], v16 offset:4096
    v_mfma_f32_16x16x32_bf16 v[180:183], a[96:99], a[60:63], v[180:183]
    buffer_load_dwordx4 a[48:51], v2, s[60:63], s80 offen offset:0 sc1
    v_mfma_f32_16x16x32_bf16 v[188:191], a[100:103], a[60:63], v[188:191]
    ds_read_b64_tr_b16 a[68:69], v17 offset:0
    ds_read_b64_tr_b16 a[70:71], v17 offset:4096
    v_mfma_f32_16x16x32_bf16 v[184:187], a[100:103], a[56:59], v[184:187]
    s_waitcnt lgkmcnt(12)
    s_add_u32 m0, s83, 32768
    v_mfma_f32_16x16x32_bf16 v[192:195], a[104:107], a[56:59], v[192:195]
    ds_read_b64_tr_b16 a[72:73], v18 offset:0
    ds_read_b64_tr_b16 a[74:75], v18 offset:4096
    v_mfma_f32_16x16x32_bf16 v[196:199], a[104:107], a[60:63], v[196:199]
    buffer_load_dwordx4 v3, s[52:55], s82 offen offset:0 lds
    v_mfma_f32_16x16x32_bf16 v[204:207], a[108:111], a[60:63], v[204:207]
    ds_read_b64_tr_b16 a[76:77], v19 offset:0
    ds_read_b64_tr_b16 a[78:79], v19 offset:4096
    v_mfma_f32_16x16x32_bf16 v[200:203], a[108:111], a[56:59], v[200:203]
    s_waitcnt lgkmcnt(12)
    v_mfma_f32_16x16x32_bf16 v[208:211], a[112:115], a[56:59], v[208:211]
    ds_read_b64_tr_b16 a[80:81], v20 offset:0
    ds_read_b64_tr_b16 a[82:83], v20 offset:4096
    v_mfma_f32_16x16x32_bf16 v[212:215], a[112:115], a[60:63], v[212:215]
    buffer_load_dwordx4 a[52:55], v2, s[60:63], s80 offen offset:1024 sc1
    s_add_u32 s80, s80, 131072
    v_mfma_f32_16x16x32_bf16 v[220:223], a[116:119], a[60:63], v[220:223]
    ds_read_b64_tr_b16 a[84:85], v21 offset:0
    ds_read_b64_tr_b16 a[86:87], v21 offset:4096
    v_mfma_f32_16x16x32_bf16 v[216:219], a[116:119], a[56:59], v[216:219]
    s_waitcnt lgkmcnt(12)
    v_mfma_f32_16x16x32_bf16 v[224:227], a[120:123], a[56:59], v[224:227]
    ds_read_b64_tr_b16 a[88:89], v22 offset:0
    ds_read_b64_tr_b16 a[90:91], v22 offset:4096
    v_mfma_f32_16x16x32_bf16 v[228:231], a[120:123], a[60:63], v[228:231]
    buffer_load_dwordx4 v4, s[52:55], s82 offen offset:1024 lds
    v_mfma_f32_16x16x32_bf16 v[236:239], a[124:127], a[60:63], v[236:239]
    ds_read_b64_tr_b16 a[92:93], v23 offset:0
    ds_read_b64_tr_b16 a[94:95], v23 offset:4096
    v_mfma_f32_16x16x32_bf16 v[232:235], a[124:127], a[56:59], v[232:235]
    s_sub_u32 s88, s88, 4
    s_branch L_gloop
L_gdone:
    s_cmp_lg_u32 s76, 0
    s_cbranch_scc1 L_send
    s_waitcnt lgkmcnt(12)
    v_mfma_f32_16x16x32_bf16 v[176:179], a[64:67], a[32:35], v[176:179]
    ds_read_b64_tr_b16 a[96:97], v16 offset:40960
    ds_read_b64_tr_b16 a[98:99], v16 offset:45056
    v_mfma_f32_16x16x32_bf16 v[180:183], a[64:67], a[36:39], v[180:183]
    buffer_load_dwordx4 a[24:27], v2, s[60:63], s80 offen offset:0 sc1
    v_mfma_f32_16x16x32_bf16 v[188:191], a[68:71], a[36:39], v[188:191]
    ds_read_b64_tr_b16 a[100:101], v17 offset:40960
    ds_read_b64_tr_b16 a[102:103], v17 offset:45056
    v_mfma_f32_16x16x32_bf16 v[184:187], a[68:71], a[32:35], v[184:187]
    s_waitcnt lgkmcnt(12)
    v_mfma_f32_16x16x32_bf16 v[192:195], a[72:75], a[32:35], v[192:195]
    ds_read_b64_tr_b16 a[104:105], v18 offset:40960
    ds_read_b64_tr_b16 a[106:107], v18 offset:45056
    v_mfma_f32_16x16x32_bf16 v[196:199], a[72:75], a[36:39], v[196:199]
    buffer_load_dwordx4 v5, s[52:55], s82 offen offset:2048 lds
    v_mfma_f32_16x16x32_bf16 v[204:207], a[76:79], a[36:39], v[204:207]
    ds_read_b64_tr_b16 a[108:109], v19 offset:40960
    ds_read_b64_tr_b16 a[110:111], v19 offset:45056
    v_mfma_f32_16x16x32_bf16 v[200:203], a[76:79], a[32:35], v[200:203]
    s_waitcnt lgkmcnt(12)
    v_mfma_f32_16x16x32_bf16 v[208:211], a[80:83], a[32:35], v[208:211]
    ds_read_b64_tr_b16 a[112:113], v20 offset:40960
    ds_read_b64_tr_b16 a[114:115], v20 offset:45056
    v_mfma_f32_16x16x32_bf16 v[212:215], a[80:83], a[36:39], v[212:215]
    buffer_load_dwordx4 a[28:31], v2, s[60:63], s80 offen offset:1024 sc1
    s_add_u32 s80, s80, 131072
    v_mfma_f32_16x16x32_bf16 v[220:223], a[84:87], a[36:39], v[220:223]
    ds_read_b64_tr_b16 a[116:117], v21 offset:40960
    ds_read_b64_tr_b16 a[118:119], v21 offset:45056
    v_mfma_f32_16x16x32_bf16 v[216:219], a[84:87], a[32:35], v[216:219]
    s_waitcnt lgkmcnt(12)
    v_mfma_f32_16x16x32_bf16 v[224:227], a[88:91], a[32:35], v[224:227]
    ds_read_b64_tr_b16 a[120:121], v22 offset:40960
    ds_read_b64_tr_b16 a[122:123], v22 offset:45056
    v_mfma_f32_16x16x32_bf16 v[228:231], a[88:91], a[36:39], v[228:231]
    buffer_load_dwordx4 v6, s[52:55], s82 offen offset:3072 lds
    s_add_u32 s82, s82, 131072
    v_mfma_f32_16x16x32_bf16 v[236:239], a[92:95], a[36:39], v[236:239]
    ds_read_b64_tr_b16 a[124:125], v23 offset:40960
    ds_read_b64_tr_b16 a[126:127], v23 offset:45056
    s_mov_b32 s94, 40050688
    buffer_load_dword v26, v24, s[40:43], s94 offen sc1
    v_mfma_f32_16x16x32_bf16 v[232:235], a[92:95], a[32:35], v[232:235]
    s_waitcnt vmcnt(9)
    s_barrier
    s_waitcnt lgkmcnt(12)
    s_waitcnt vmcnt(0)
    s_mov_b32 s92, 1048576
L_pollh:
    v_cmp_gt_u32 vcc, 32, v26
    s_sub_u32 s92, s92, 1
    s_cselect_b64 vcc, 0, vcc
    s_cbranch_vccz L_goth
    buffer_load_dword v26, v24, s[40:43], s94 offen sc1
    s_waitcnt vmcnt(0)
    s_branch L_pollh
L_goth:
    s_mov_b32 s80, 0
    s_mov_b32 s62, 8388608
    v_mfma_f32_16x16x32_bf16 v[176:179], a[96:99], a[40:43], v[176:179]
    ds_read_b64_tr_b16 a[64:65], v16 offset:49152
    ds_read_b64_tr_b16 a[66:67], v16 offset:53248
    v_mfma_f32_16x16x32_bf16 v[180:183], a[96:99], a[44:47], v[180:183]
    buffer_load_dwordx4 a[32:35], v2, s[60:63], s80 offen offset:0 sc1
    v_mfma_f32_16x16x32_bf16 v[188:191], a[100:103], a[44:47], v[188:191]
    ds_read_b64_tr_b16 a[68:69], v17 offset:49152
    ds_read_b64_tr_b16 a[70:71], v17 offset:53248
    v_mfma_f32_16x16x32_bf16 v[184:187], a[100:103], a[40:43], v[184:187]
    s_waitcnt lgkmcnt(12)
    s_add_u32 m0, s83, 16384
    v_mfma_f32_16x16x32_bf16 v[192:195], a[104:107], a[40:43], v[192:195]
    ds_read_b64_tr_b16 a[72:73], v18 offset:49152
    ds_read_b64_tr_b16 a[74:75], v18 offset:53248
    v_mfma_f32_16x16x32_bf16 v[196:199], a[104:107], a[44:47], v[196:199]
    buffer_load_dwordx4 v3, s[52:55], s82 offen offset:0 lds
    v_mfma_f32_16x16x32_bf16 v[204:207], a[108:111], a[44:47], v[204:207]
    ds_read_b64_tr_b16 a[76:77], v19 offset:49152
    ds_read_b64_tr_b16 a[78:79], v19 offset:53248
    v_mfma_f32_16x16x32_bf16 v[200:203], a[108:111], a[40:43], v[200:203]
    s_waitcnt lgkmcnt(12)
    v_mfma_f32_16x16x32_bf16 v[208:211], a[112:115], a[40:43], v[208:211]
    ds_read_b64_tr_b16 a[80:81], v20 offset:49152
    ds_read_b64_tr_b16 a[82:83], v20 offset:53248
    v_mfma_f32_16x16x32_bf16 v[212:215], a[112:115], a[44:47], v[212:215]
    buffer_load_dwordx4 a[36:39], v2, s[60:63], s80 offen offset:1024 sc1
    s_add_u32 s80, s80, 131072
    v_mfma_f32_16x16x32_bf16 v[220:223], a[116:119], a[44:47], v[220:223]
    ds_read_b64_tr_b16 a[84:85], v21 offset:49152
    ds_read_b64_tr_b16 a[86:87], v21 offset:53248
    v_mfma_f32_16x16x32_bf16 v[216:219], a[116:119], a[40:43], v[216:219]
    s_waitcnt lgkmcnt(12)
    v_mfma_f32_16x16x32_bf16 v[224:227], a[120:123], a[40:43], v[224:227]
    ds_read_b64_tr_b16 a[88:89], v22 offset:49152
    ds_read_b64_tr_b16 a[90:91], v22 offset:53248
    v_mfma_f32_16x16x32_bf16 v[228:231], a[120:123], a[44:47], v[228:231]
    buffer_load_dwordx4 v4, s[52:55], s82 offen offset:1024 lds
    v_mfma_f32_16x16x32_bf16 v[236:239], a[124:127], a[44:47], v[236:239]
    ds_read_b64_tr_b16 a[92:93], v23 offset:49152
    ds_read_b64_tr_b16 a[94:95], v23 offset:53248
    v_mfma_f32_16x16x32_bf16 v[232:235], a[124:127], a[40:43], v[232:235]
    s_waitcnt lgkmcnt(12)
    v_mfma_f32_16x16x32_bf16 v[176:179], a[64:67], a[48:51], v[176:179]
    ds_read_b64_tr_b16 a[96:97], v16 offset:57344
    ds_read_b64_tr_b16 a[98:99], v16 offset:61440
    v_mfma_f32_16x16x32_bf16 v[180:183], a[64:67], a[52:55], v[180:183]
    buffer_load_dwordx4 a[40:43], v2, s[60:63], s80 offen offset:0 sc1
    v_mfma_f32_16x16x32_bf16 v[188:191], a[68:71], a[52:55], v[188:191]
    ds_read_b64_tr_b16 a[100:101], v17 offset:57344
    ds_read_b64_tr_b16 a[102:103], v17 offset:61440
    v_mfma_f32_16x16x32_bf16 v[184:187], a[68:71], a[48:51], v[184:187]
    s_waitcnt lgkmcnt(12)
    v_mfma_f32_16x16x32_bf16 v[192:195], a[72:75], a[48:51], v[192:195]
    ds_read_b64_tr_b16 a[104:105], v18 offset:57344
    ds_read_b64_tr_b16 a[106:107], v18 offset:61440
    v_mfma_f32_16x16x32_bf16 v[196:199], a[72:75], a[52:55], v[196:199]
    buffer_load_dwordx4 v5, s[52:55], s82 offen offset:2048 lds
    v_mfma_f32_16x16x32_bf16 v[204:207], a[76:79], a[52:55], v[204:207]
    ds_read_b64_tr_b16 a[108:109], v19 offset:57344
    ds_read_b64_tr_b16 a[110:111], v19 offset:61440
    v_mfma_f32_16x16x32_bf16 v[200:203], a[76:79], a[48:51], v[200:203]
    s_waitcnt lgkmcnt(12)
    v_mfma_f32_16x16x32_bf16 v[208:211], a[80:83], a[48:51], v[208:211]
    ds_read_b64_tr_b16 a[112:113], v20 offset:57344
    ds_read_b64_tr_b16 a[114:115], v20 offset:61440
    v_mfma_f32_16x16x32_bf16 v[212:215], a[80:83], a[52:55], v[212:215]
    buffer_load_dwordx4 a[44:47], v2, s[60:63], s80 offen offset:1024 sc1
    s_add_u32 s80, s80, 131072
    v_mfma_f32_16x16x32_bf16 v[220:223], a[84:87], a[52:55], v[220:223]
    ds_read_b64_tr_b16 a[116:117], v21 offset:57344
    ds_read_b64_tr_b16 a[118:119], v21 offset:61440
    v_mfma_f32_16x16x32_bf16 v[216:219], a[84:87], a[48:51], v[216:219]
    s_waitcnt lgkmcnt(12)
    v_mfma_f32_16x16x32_bf16 v[224:227], a[88:91], a[48:51], v[224:227]
    ds_read_b64_tr_b16 a[120:121], v22 offset:57344
    ds_read_b64_tr_b16 a[122:123], v22 offset:61440
    v_mfma_f32_16x16x32_bf16 v[228:231], a[88:91], a[52:55], v[228:231]
    buffer_load_dwordx4 v6, s[52:55], s82 offen offset:3072 lds
    s_add_u32 s82, s82, 131072
    v_mfma_f32_16x16x32_bf16 v[236:239], a[92:95], a[52:55], v[236:239]
    ds_read_b64_tr_b16 a[124:125], v23 offset:57344
    ds_read_b64_tr_b16 a[126:127], v23 offset:61440
    v_mfma_f32_16x16x32_bf16 v[232:235], a[92:95], a[48:51], v[232:235]
    s_barrier
    s_waitcnt lgkmcnt(12)
    v_mfma_f32_16x16x32_bf16 v[176:179], a[96:99], a[56:59], v[176:179]
    ds_read_b64_tr_b16 a[64:65], v16 offset:0
    ds_read_b64_tr_b16 a[66:67], v16 offset:4096
    v_mfma_f32_16x16x32_bf16 v[180:183], a[96:99], a[60:63], v[180:183]
    buffer_load_dwordx4 a[48:51], v2, s[60:63], s80 offen offset:0 sc1
    v_mfma_f32_16x16x32_bf16 v[188:191], a[100:103], a[60:63], v[188:191]
    ds_read_b64_tr_b16 a[68:69], v17 offset:0
    ds_read_b64_tr_b16 a[70:71], v17 offset:4096
    v_mfma_f32_16x16x32_bf16 v[184:187], a[100:103], a[56:59], v[184:187]
    s_waitcnt lgkmcnt(12)
    s_add_u32 m0, s83, 32768
    v_mfma_f32_16x16x32_bf16 v[192:195], a[104:107], a[56:59], v[192:195]
    ds_read_b64_tr_b16 a[72:73], v18 offset:0
    ds_read_b64_tr_b16 a[74:75], v18 offset:4096
    v_mfma_f32_16x16x32_bf16 v[196:199], a[104:107], a[60:63], v[196:199]
    buffer_load_dwordx4 v7, s[48:51], s81 offen offset:0 lds
    v_mfma_f32_16x16x32_bf16 v[204:207], a[108:111], a[60:63], v[204:207]
    ds_read_b64_tr_b16 a[76:77], v19 offset:0
    ds_read_b64_tr_b16 a[78:79], v19 offset:4096
    v_mfma_f32_16x16x32_bf16 v[200:203], a[108:111], a[56:59], v[200:203]
    s_waitcnt lgkmcnt(12)
    v_mfma_f32_16x16x32_bf16 v[208:211], a[112:115], a[56:59], v[208:211]
    ds_read_b64_tr_b16 a[80:81], v20 offset:0
    ds_read_b64_tr_b16 a[82:83], v20 offset:4096
    v_mfma_f32_16x16x32_bf16 v[212:215], a[112:115], a[60:63], v[212:215]
    buffer_load_dwordx4 a[52:55], v2, s[60:63], s80 offen offset:1024 sc1
    s_add_u32 s80, s80, 131072
    v_mfma_f32_16x16x32_bf16 v[220:223], a[116:119], a[60:63], v[220:223]
    ds_read_b64_tr_b16 a[84:85], v21 offset:0
    ds_read_b64_tr_b16 a[86:87], v21 offset:4096
    v_mfma_f32_16x16x32_bf16 v[216:219], a[116:119], a[56:59], v[216:219]
    s_waitcnt lgkmcnt(12)
    v_mfma_f32_16x16x32_bf16 v[224:227], a[120:123], a[56:59], v[224:227]
    ds_read_b64_tr_b16 a[88:89], v22 offset:0
    ds_read_b64_tr_b16 a[90:91], v22 offset:4096
    v_mfma_f32_16x16x32_bf16 v[228:231], a[120:123], a[60:63], v[228:231]
    buffer_load_dwordx4 v8, s[48:51], s81 offen offset:1024 lds
    v_mfma_f32_16x16x32_bf16 v[236:239], a[124:127], a[60:63], v[236:239]
    ds_read_b64_tr_b16 a[92:93], v23 offset:0
    ds_read_b64_tr_b16 a[94:95], v23 offset:4096
    v_mfma_f32_16x16x32_bf16 v[232:235], a[124:127], a[56:59], v[232:235]
    s_waitcnt lgkmcnt(12)
    v_mfma_f32_16x16x32_bf16 v[176:179], a[64:67], a[0:3], v[176:179]
    ds_read_b64_tr_b16 a[96:97], v16 offset:8192
    ds_read_b64_tr_b16 a[98:99], v16 offset:12288
    v_mfma_f32_16x16x32_bf16 v[180:183], a[64:67], a[4:7], v[180:183]
    buffer_load_dwordx4 a[56:59], v2, s[60:63], s80 offen offset:0 sc1
    v_mfma_f32_16x16x32_bf16 v[188:191], a[68:71], a[4:7], v[188:191]
    ds_read_b64_tr_b16 a[100:101], v17 offset:8192
    ds_read_b64_tr_b16 a[102:103], v17 offset:12288
    v_mfma_f32_16x16x32_bf16 v[184:187], a[68:71], a[0:3], v[184:187]
    s_waitcnt lgkmcnt(12)
    v_mfma_f32_16x16x32_bf16 v[192:195], a[72:75], a[0:3], v[192:195]
    ds_read_b64_tr_b16 a[104:105], v18 offset:8192
    ds_read_b64_tr_b16 a[106:107], v18 offset:12288
    v_mfma_f32_16x16x32_bf16 v[196:199], a[72:75], a[4:7], v[196:199]
    buffer_load_dwordx4 v9, s[48:51], s81 offen offset:2048 lds
    v_mfma_f32_16x16x32_bf16 v[204:207], a[76:79], a[4:7], v[204:207]
    ds_read_b64_tr_b16 a[108:109], v19 offset:8192
    ds_read_b64_tr_b16 a[110:111], v19 offset:12288
    v_mfma_f32_16x16x32_bf16 v[200:203], a[76:79], a[0:3], v[200:203]
    s_waitcnt lgkmcnt(12)
    v_mfma_f32_16x16x32_bf16 v[208:211], a[80:83], a[0:3], v[208:211]
    ds_read_b64_tr_b16 a[112:113], v20 offset:8192
    ds_read_b64_tr_b16 a[114:115], v20 offset:12288
    v_mfma_f32_16x16x32_bf16 v[212:215], a[80:83], a[4:7], v[212:215]
    buffer_load_dwordx4 a[60:63], v2, s[60:63], s80 offen offset:1024 sc1
    s_add_u32 s80, s80, 131072
    v_mfma_f32_16x16x32_bf16 v[220:223], a[84:87], a[4:7], v[220:223]
    ds_read_b64_tr_b16 a[116:117], v21 offset:8192
    ds_read_b64_tr_b16 a[118:119], v21 offset:12288
    v_mfma_f32_16x16x32_bf16 v[216:219], a[84:87], a[0:3], v[216:219]
    s_waitcnt lgkmcnt(12)
    v_mfma_f32_16x16x32_bf16 v[224:227], a[88:91], a[0:3], v[224:227]
    ds_read_b64_tr_b16 a[120:121], v22 offset:8192
    ds_read_b64_tr_b16 a[122:123], v22 offset:12288
    v_mfma_f32_16x16x32_bf16 v[228:231], a[88:91], a[4:7], v[228:231]
    buffer_load_dwordx4 v10, s[48:51], s81 offen offset:3072 lds
    s_add_u32 s81, s81, 128
    v_mfma_f32_16x16x32_bf16 v[236:239], a[92:95], a[4:7], v[236:239]
    ds_read_b64_tr_b16 a[124:125], v23 offset:8192
    ds_read_b64_tr_b16 a[126:127], v23 offset:12288
    v_mfma_f32_16x16x32_bf16 v[232:235], a[92:95], a[0:3], v[232:235]
    s_waitcnt vmcnt(8)
    s_barrier
    s_waitcnt lgkmcnt(12)
    v_mfma_f32_16x16x32_bf16 v[176:179], a[96:99], a[8:11], v[176:179]
    ds_read_b64_tr_b16 a[64:65], v16 offset:16384
    ds_read_b64_tr_b16 a[66:67], v16 offset:20480
    v_mfma_f32_16x16x32_bf16 v[180:183], a[96:99], a[12:15], v[180:183]
    buffer_load_dwordx4 a[0:3], v2, s[60:63], s80 offen offset:0 sc1
    v_mfma_f32_16x16x32_bf16 v[188:191], a[100:103], a[12:15], v[188:191]
    ds_read_b64_tr_b16 a[68:69], v17 offset:16384
    ds_read_b64_tr_b16 a[70:71], v17 offset:20480
    v_mfma_f32_16x16x32_bf16 v[184:187], a[100:103], a[8:11], v[184:187]
    s_waitcnt lgkmcnt(12)
    s_add_u32 m0, s83, 49152
    v_mfma_f32_16x16x32_bf16 v[192:195], a[104:107], a[8:11], v[192:195]
    ds_read_b64_tr_b16 a[72:73], v18 offset:16384
    ds_read_b64_tr_b16 a[74:75], v18 offset:20480
    v_mfma_f32_16x16x32_bf16 v[196:199], a[104:107], a[12:15], v[196:199]
    buffer_load_dwordx4 v7, s[48:51], s81 offen offset:0 lds
    v_mfma_f32_16x16x32_bf16 v[204:207], a[108:111], a[12:15], v[204:207]
    ds_read_b64_tr_b16 a[76:77], v19 offset:16384
    ds_read_b64_tr_b16 a[78:79], v19 offset:20480
    v_mfma_f32_16x16x32_bf16 v[200:203], a[108:111], a[8:11], v[200:203]
    s_waitcnt lgkmcnt(12)
    v_mfma_f32_16x16x32_bf16 v[208:211], a[112:115], a[8:11], v[208:211]
    ds_read_b64_tr_b16 a[80:81], v20 offset:16384
    ds_read_b64_tr_b16 a[82:83], v20 offset:20480
    v_mfma_f32_16x16x32_bf16 v[212:215], a[112:115], a[12:15], v[212:215]
    buffer_load_dwordx4 a[4:7], v2, s[60:63], s80 offen offset:1024 sc1
    s_add_u32 s80, s80, 131072
    v_mfma_f32_16x16x32_bf16 v[220:223], a[116:119], a[12:15], v[220:223]
    ds_read_b64_tr_b16 a[84:85], v21 offset:16384
    ds_read_b64_tr_b16 a[86:87], v21 offset:20480
    v_mfma_f32_16x16x32_bf16 v[216:219], a[116:119], a[8:11], v[216:219]
    s_waitcnt lgkmcnt(12)
    v_mfma_f32_16x16x32_bf16 v[224:227], a[120:123], a[8:11], v[224:227]
    ds_read_b64_tr_b16 a[88:89], v22 offset:16384
    ds_read_b64_tr_b16 a[90:91], v22 offset:20480
    v_mfma_f32_16x16x32_bf16 v[228:231], a[120:123], a[12:15], v[228:231]
    buffer_load_dwordx4 v8, s[48:51], s81 offen offset:1024 lds
    v_mfma_f32_16x16x32_bf16 v[236:239], a[124:127], a[12:15], v[236:239]
    ds_read_b64_tr_b16 a[92:93], v23 offset:16384
    ds_read_b64_tr_b16 a[94:95], v23 offset:20480
    v_mfma_f32_16x16x32_bf16 v[232:235], a[124:127], a[8:11], v[232:235]
    s_waitcnt lgkmcnt(12)
    v_mfma_f32_16x16x32_bf16 v[176:179], a[64:67], a[16:19], v[176:179]
    ds_read_b64_tr_b16 a[96:97], v16 offset:24576
    ds_read_b64_tr_b16 a[98:99], v16 offset:28672
    v_mfma_f32_16x16x32_bf16 v[180:183], a[64:67], a[20:23], v[180:183]
    buffer_load_dwordx4 a[8:11], v2, s[60:63], s80 offen offset:0 sc1
    v_mfma_f32_16x16x32_bf16 v[188:191], a[68:71], a[20:23], v[188:191]
    ds_read_b64_tr_b16 a[100:101], v17 offset:24576
    ds_read_b64_tr_b16 a[102:103], v17 offset:28672
    v_mfma_f32_16x16x32_bf16 v[184:187], a[68:71], a[16:19], v[184:187]
    s_waitcnt lgkmcnt(12)
    v_mfma_f32_16x16x32_bf16 v[192:195], a[72:75], a[16:19], v[192:195]
    ds_read_b64_tr_b16 a[104:105], v18 offset:24576
    ds_read_b64_tr_b16 a[106:107], v18 offset:28672
    v_mfma_f32_16x16x32_bf16 v[196:199], a[72:75], a[20:23], v[196:199]
    buffer_load_dwordx4 v9, s[48:51], s81 offen offset:2048 lds
    v_mfma_f32_16x16x32_bf16 v[204:207], a[76:79], a[20:23], v[204:207]
    ds_read_b64_tr_b16 a[108:109], v19 offset:24576
    ds_read_b64_tr_b16 a[110:111], v19 offset:28672
    v_mfma_f32_16x16x32_bf16 v[200:203], a[76:79], a[16:19], v[200:203]
    s_waitcnt lgkmcnt(12)
    v_mfma_f32_16x16x32_bf16 v[208:211], a[80:83], a[16:19], v[208:211]
    ds_read_b64_tr_b16 a[112:113], v20 offset:24576
    ds_read_b64_tr_b16 a[114:115], v20 offset:28672
    v_mfma_f32_16x16x32_bf16 v[212:215], a[80:83], a[20:23], v[212:215]
    buffer_load_dwordx4 a[12:15], v2, s[60:63], s80 offen offset:1024 sc1
    s_add_u32 s80, s80, 131072
    v_mfma_f32_16x16x32_bf16 v[220:223], a[84:87], a[20:23], v[220:223]
    ds_read_b64_tr_b16 a[116:117], v21 offset:24576
    ds_read_b64_tr_b16 a[118:119], v21 offset:28672
    v_mfma_f32_16x16x32_bf16 v[216:219], a[84:87], a[16:19], v[216:219]
    s_waitcnt lgkmcnt(12)
    v_mfma_f32_16x16x32_bf16 v[224:227], a[88:91], a[16:19], v[224:227]
    ds_read_b64_tr_b16 a[120:121], v22 offset:24576
    ds_read_b64_tr_b16 a[122:123], v22 offset:28672
    v_mfma_f32_16x16x32_bf16 v[228:231], a[88:91], a[20:23], v[228:231]
    buffer_load_dwordx4 v10, s[48:51], s81 offen offset:3072 lds
    s_add_u32 s81, s81, 128
    v_mfma_f32_16x16x32_bf16 v[236:239], a[92:95], a[20:23], v[236:239]
    ds_read_b64_tr_b16 a[124:125], v23 offset:24576
    ds_read_b64_tr_b16 a[126:127], v23 offset:28672
    v_mfma_f32_16x16x32_bf16 v[232:235], a[92:95], a[16:19], v[232:235]
    s_waitcnt vmcnt(8)
    s_barrier
    s_waitcnt lgkmcnt(12)
    v_mfma_f32_16x16x32_bf16 v[176:179], a[96:99], a[24:27], v[176:179]
    ds_read_b128 a[64:67], v12 offset:32768
    v_mfma_f32_16x16x32_bf16 v[180:183], a[96:99], a[28:31], v[180:183]
    buffer_load_dwordx4 a[16:19], v2, s[60:63], s80 offen offset:0 sc1
    v_mfma_f32_16x16x32_bf16 v[188:191], a[100:103], a[28:31], v[188:191]
    ds_read_b128 a[68:71], v12 offset:34816
    v_mfma_f32_16x16x32_bf16 v[184:187], a[100:103], a[24:27], v[184:187]
    s_waitcnt lgkmcnt(10)
    s_add_u32 m0, s83, 0
    v_mfma_f32_16x16x32_bf16 v[192:195], a[104:107], a[24:27], v[192:195]
    ds_read_b128 a[72:75], v12 offset:36864
    v_mfma_f32_16x16x32_bf16 v[196:199], a[104:107], a[28:31], v[196:199]
    buffer_load_dwordx4 v7, s[48:51], s81 offen offset:0 lds
    v_mfma_f32_16x16x32_bf16 v[204:207], a[108:111], a[28:31], v[204:207]
    ds_read_b128 a[76:79], v12 offset:38912
    v_mfma_f32_16x16x32_bf16 v[200:203], a[108:111], a[24:27], v[200:203]
    s_waitcnt lgkmcnt(8)
    v_mfma_f32_16x16x32_bf16 v[208:211], a[112:115], a[24:27], v[208:211]
    ds_read_b128 a[80:83], v12 offset:40960
    v_mfma_f32_16x16x32_bf16 v[212:215], a[112:115], a[28:31], v[212:215]
    buffer_load_dwordx4 a[20:23], v2, s[60:63], s80 offen offset:1024 sc1
    s_add_u32 s80, s80, 131072
    v_mfma_f32_16x16x32_bf16 v[220:223], a[116:119], a[28:31], v[220:223]
    ds_read_b128 a[84:87], v12 offset:43008
    v_mfma_f32_16x16x32_bf16 v[216:219], a[116:119], a[24:27], v[216:219]
    s_waitcnt lgkmcnt(6)
    v_mfma_f32_16x16x32_bf16 v[224:227], a[120:123], a[24:27], v[224:227]
    ds_read_b128 a[88:91], v12 offset:45056
    v_mfma_f32_16x16x32_bf16 v[228:231], a[120:123], a[28:31], v[228:231]
    buffer_load_dwordx4 v8, s[48:51], s81 offen offset:1024 lds
    v_mfma_f32_16x16x32_bf16 v[236:239], a[124:127], a[28:31], v[236:239]
    ds_read_b128 a[92:95], v12 offset:47104
    v_mfma_f32_16x16x32_bf16 v[232:235], a[124:127], a[24:27], v[232:235]
    s_mov_b32 s88, 7
L_sloop:
    s_waitcnt lgkmcnt(6)
    v_mfma_f32_16x16x32_bf16 v[80:83], a[64:67], a[32:35], v[80:83]
    ds_read_b128 a[96:99], v13 offset:32768
    v_mfma_f32_16x16x32_bf16 v[84:87], a[64:67], a[36:39], v[84:87]
    buffer_load_dwordx4 a[24:27], v2, s[60:63], s80 offen offset:0 sc1
    v_mfma_f32_16x16x32_bf16 v[92:95], a[68:71], a[36:39], v[92:95]
    ds_read_b128 a[100:103], v13 offset:34816
    v_mfma_f32_16x16x32_bf16 v[88:91], a[68:71], a[32:35], v[88:91]
    s_waitcnt lgkmcnt(6)
    v_mfma_f32_16x16x32_bf16 v[96:99], a[72:75], a[32:35], v[96:99]
    ds_read_b128 a[104:107], v13 offset:36864
    v_mfma_f32_16x16x32_bf16 v[100:103], a[72:75], a[36:39], v[100:103]
    buffer_load_dwordx4 v9, s[48:51], s81 offen offset:2048 lds
    v_mfma_f32_16x16x32_bf16 v[108:111], a[76:79], a[36:39], v[108:111]
    ds_read_b128 a[108:111], v13 offset:38912
    v_mfma_f32_16x16x32_bf16 v[104:107], a[76:79], a[32:35], v[104:107]
    s_waitcnt lgkmcnt(6)
    v_mfma_f32_16x16x32_bf16 v[112:115], a[80:83], a[32:35], v[112:115]
    ds_read_b128 a[112:115], v13 offset:40960
    v_mfma_f32_16x16x32_bf16 v[116:119], a[80:83], a[36:39], v[116:119]
    buffer_load_dwordx4 a[28:31], v2, s[60:63], s80 offen offset:1024 sc1
    s_add_u32 s80, s80, 131072
    v_mfma_f32_16x16x32_bf16 v[124:127], a[84:87], a[36:39], v[124:127]
    ds_read_b128 a[116:119], v13 offset:43008
    v_mfma_f32_16x16x32_bf16 v[120:123], a[84:87], a[32:35], v[120:123]
    s_waitcnt lgkmcnt(6)
    v_mfma_f32_16x16x32_bf16 v[128:131], a[88:91], a[32:35], v[128:131]
    ds_read_b128 a[120:123], v13 offset:45056
    v_mfma_f32_16x16x32_bf16 v[132:135], a[88:91], a[36:39], v[132:135]
    buffer_load_dwordx4 v10, s[48:51], s81 offen offset:3072 lds
    s_add_u32 s81, s81, 128
    v_mfma_f32_16x16x32_bf16 v[140:143], a[92:95], a[36:39], v[140:143]
    ds_read_b128 a[124:127], v13 offset:47104
    v_mfma_f32_16x16x32_bf16 v[136:139], a[92:95], a[32:35], v[136:139]
    s_waitcnt vmcnt(8)
    s_barrier
    s_waitcnt lgkmcnt(6)
    v_mfma_f32_16x16x32_bf16 v[80:83], a[96:99], a[40:43], v[80:83]
    ds_read_b128 a[64:67], v12 offset:49152
    v_mfma_f32_16x16x32_bf16 v[84:87], a[96:99], a[44:47], v[84:87]
    buffer_load_dwordx4 a[32:35], v2, s[60:63], s80 offen offset:0 sc1
    v_mfma_f32_16x16x32_bf16 v[92:95], a[100:103], a[44:47], v[92:95]
    ds_read_b128 a[68:71], v12 offset:51200
    v_mfma_f32_16x16x32_bf16 v[88:91], a[100:103], a[40:43], v[88:91]
    s_waitcnt lgkmcnt(6)
    s_add_u32 m0, s83, 16384
    v_mfma_f32_16x16x32_bf16 v[96:99], a[104:107], a[40:43], v[96:99]
    ds_read_b128 a[72:75], v12 offset:53248
    v_mfma_f32_16x16x32_bf16 v[100:103], a[104:107], a[44:47], v[100:103]
    buffer_load_dwordx4 v7, s[48:51], s81 offen offset:0 lds
    v_mfma_f32_16x16x32_bf16 v[108:111], a[108:111], a[44:47], v[108:111]
    ds_read_b128 a[76:79], v12 offset:55296
    v_mfma_f32_16x16x32_bf16 v[104:107], a[108:111], a[40:43], v[104:107]
    s_waitcnt lgkmcnt(6)
    v_mfma_f32_16x16x32_bf16 v[112:115], a[112:115], a[40:43], v[112:115]
    ds_read_b128 a[80:83], v12 offset:57344
    v_mfma_f32_16x16x32_bf16 v[116:119], a[112:115], a[44:47], v[116:119]
    buffer_load_dwordx4 a[36:39], v2, s[60:63], s80 offen offset:1024 sc1
    s_add_u32 s80, s80, 131072
    v_mfma_f32_16x16x32_bf16 v[124:127], a[116:119], a[44:47], v[124:127]
    ds_read_b128 a[84:87], v12 offset:59392
    v_mfma_f32_16x16x32_bf16 v[120:123], a[116:119], a[40:43], v[120:123]
    s_waitcnt lgkmcnt(6)
    v_mfma_f32_16x16x32_bf16 v[128:131], a[120:123], a[40:43], v[128:131]
    ds_read_b128 a[88:91], v12 offset:61440
    v_mfma_f32_16x16x32_bf16 v[132:135], a[120:123], a[44:47], v[132:135]
    buffer_load_dwordx4 v8, s[48:51], s81 offen offset:1024 lds
    v_mfma_f32_16x16x32_bf16 v[140:143], a[124:127], a[44:47], v[140:143]
    ds_read_b128 a[92:95], v12 offset:63488
    v_mfma_f32_16x16x32_bf16 v[136:139], a[124:127], a[40:43], v[136:139]
    s_waitcnt lgkmcnt(6)
    v_mfma_f32_16x16x32_bf16 v[80:83], a[64:67], a[48:51], v[80:83]
    ds_read_b128 a[96:99], v13 offset:49152
    v_mfma_f32_16x16x32_bf16 v[84:87], a[64:67], a[52:55], v[84:87]
    buffer_load_dwordx4 a[40:43], v2, s[60:63], s80 offen offset:0 sc1
    v_mfma_f32_16x16x32_bf16 v[92:95], a[68:71], a[52:55], v[92:95]
    ds_read_b128 a[100:103], v13 offset:51200
    v_mfma_f32_16x16x32_bf16 v[88:91], a[68:71], a[48:51], v[88:91]
    s_waitcnt lgkmcnt(6)
    v_mfma_f32_16x16x32_bf16 v[96:99], a[72:75], a[48:51], v[96:99]
    ds_read_b128 a[104:107], v13 offset:53248
    v_mfma_f32_16x16x32_bf16 v[100:103], a[72:75], a[52:55], v[100:103]
    buffer_load_dwordx4 v9, s[48:51], s81 offen offset:2048 lds
    v_mfma_f32_16x16x32_bf16 v[108:111], a[76:79], a[52:55], v[108:111]
    ds_read_b128 a[108:111], v13 offset:55296
    v_mfma_f32_16x16x32_bf16 v[104:107], a[76:79], a[48:51], v[104:107]
    s_waitcnt lgkmcnt(6)
    v_mfma_f32_16x16x32_bf16 v[112:115], a[80:83], a[48:51], v[112:115]
    ds_read_b128 a[112:115], v13 offset:57344
    v_mfma_f32_16x16x32_bf16 v[116:119], a[80:83], a[52:55], v[116:119]
    buffer_load_dwordx4 a[44:47], v2, s[60:63], s80 offen offset:1024 sc1
    s_add_u32 s80, s80, 131072
    v_mfma_f32_16x16x32_bf16 v[124:127], a[84:87], a[52:55], v[124:127]
    ds_read_b128 a[116:119], v13 offset:59392
    v_mfma_f32_16x16x32_bf16 v[120:123], a[84:87], a[48:51], v[120:123]
    s_waitcnt lgkmcnt(6)
    v_mfma_f32_16x16x32_bf16 v[128:131], a[88:91], a[48:51], v[128:131]
    ds_read_b128 a[120:123], v13 offset:61440
    v_mfma_f32_16x16x32_bf16 v[132:135], a[88:91], a[52:55], v[132:135]
    s_cmp_eq_u32 s88, 2
    s_cselect_b32 s94, 0, 1073741824
    buffer_load_dwordx4 v10, s[48:51], s81 offen offset:3072 lds
    s_add_u32 s81, s81, 128
    v_mfma_f32_16x16x32_bf16 v[140:143], a[92:95], a[52:55], v[140:143]
    ds_read_b128 a[124:127], v13 offset:63488
    buffer_load_dword v43, v14, s[8:11], s94 offen
    v_mfma_f32_16x16x32_bf16 v[136:139], a[92:95], a[48:51], v[136:139]
    s_cmp_eq_u32 s81, 2048
    s_cselect_b32 s48, s16, s48
    s_cselect_b32 s49, s17, s49
    s_cselect_b32 s81, 0, s81
    s_cselect_b32 s50, s87, s50
    s_cselect_b32 s87, 0, s87
    s_waitcnt vmcnt(9)
    s_barrier
    s_waitcnt lgkmcnt(6)
    v_mfma_f32_16x16x32_bf16 v[80:83], a[96:99], a[56:59], v[80:83]
    ds_read_b128 a[64:67], v12 offset:0
    v_mfma_f32_16x16x32_bf16 v[84:87], a[96:99], a[60:63], v[84:87]
    buffer_load_dwordx4 a[48:51], v2, s[60:63], s80 offen offset:0 sc1
    v_mfma_f32_16x16x32_bf16 v[92:95], a[100:103], a[60:63], v[92:95]
    ds_read_b128 a[68:71], v12 offset:2048
    v_mfma_f32_16x16x32_bf16 v[88:91], a[100:103], a[56:59], v[88:91]
    s_waitcnt lgkmcnt(6)
    s_add_u32 m0, s83, 32768
    v_mfma_f32_16x16x32_bf16 v[96:99], a[104:107], a[56:59], v[96:99]
    ds_read_b128 a[72:75], v12 offset:4096
    v_mfma_f32_16x16x32_bf16 v[100:103], a[104:107], a[60:63], v[100:103]
    buffer_load_dwordx4 v7, s[48:51], s81 offen offset:0 lds
    v_mfma_f32_16x16x32_bf16 v[108:111], a[108:111], a[60:63], v[108:111]
    ds_read_b128 a[76:79], v12 offset:6144
    v_mfma_f32_16x16x32_bf16 v[104:107], a[108:111], a[56:59], v[104:107]
    s_waitcnt lgkmcnt(6)
    v_mfma_f32_16x16x32_bf16 v[112:115], a[112:115], a[56:59], v[112:115]
    ds_read_b128 a[80:83], v12 offset:8192
    v_mfma_f32_16x16x32_bf16 v[116:119], a[112:115], a[60:63], v[116:119]
    buffer_load_dwordx4 a[52:55], v2, s[60:63], s80 offen offset:1024 sc1
    s_add_u32 s80, s80, 131072
    v_mfma_f32_16x16x32_bf16 v[124:127], a[116:119], a[60:63], v[124:127]
    ds_read_b128 a[84:87], v12 offset:10240
    v_mfma_f32_16x16x32_bf16 v[120:123], a[116:119], a[56:59], v[120:123]
    s_waitcnt lgkmcnt(6)
    v_mfma_f32_16x16x32_bf16 v[128:131], a[120:123], a[56:59], v[128:131]
    ds_read_b128 a[88:91], v12 offset:12288
    v_mfma_f32_16x16x32_bf16 v[132:135], a[120:123], a[60:63], v[132:135]
    buffer_load_dwordx4 v8, s[48:51], s81 offen offset:1024 lds
    v_mfma_f32_16x16x32_bf16 v[140:143], a[124:127], a[60:63], v[140:143]
    ds_read_b128 a[92:95], v12 offset:14336
    v_mfma_f32_16x16x32_bf16 v[136:139], a[124:127], a[56:59], v[136:139]
    s_waitcnt lgkmcnt(6)
    v_mfma_f32_16x16x32_bf16 v[80:83], a[64:67], a[0:3], v[80:83]
    ds_read_b128 a[96:99], v13 offset:0
    v_mfma_f32_16x16x32_bf16 v[84:87], a[64:67], a[4:7], v[84:87]
    buffer_load_dwordx4 a[56:59], v2, s[60:63], s80 offen offset:0 sc1
    v_mfma_f32_16x16x32_bf16 v[92:95], a[68:71], a[4:7], v[92:95]
    ds_read_b128 a[100:103], v13 offset:2048
    v_mfma_f32_16x16x32_bf16 v[88:91], a[68:71], a[0:3], v[88:91]
    s_waitcnt lgkmcnt(6)
    v_mfma_f32_16x16x32_bf16 v[96:99], a[72:75], a[0:3], v[96:99]
    ds_read_b128 a[104:107], v13 offset:4096
    v_mfma_f32_16x16x32_bf16 v[100:103], a[72:75], a[4:7], v[100:103]
    buffer_load_dwordx4 v9, s[48:51], s81 offen offset:2048 lds
    v_mfma_f32_16x16x32_bf16 v[108:111], a[76:79], a[4:7], v[108:111]
    ds_read_b128 a[108:111], v13 offset:6144
    v_mfma_f32_16x16x32_bf16 v[104:107], a[76:79], a[0:3], v[104:107]
    s_waitcnt lgkmcnt(6)
    v_mfma_f32_16x16x32_bf16 v[112:115], a[80:83], a[0:3], v[112:115]
    ds_read_b128 a[112:115], v13 offset:8192
    v_mfma_f32_16x16x32_bf16 v[116:119], a[80:83], a[4:7], v[116:119]
    buffer_load_dwordx4 a[60:63], v2, s[60:63], s80 offen offset:1024 sc1
    s_add_u32 s80, s80, 131072
    v_mfma_f32_16x16x32_bf16 v[124:127], a[84:87], a[4:7], v[124:127]
    ds_read_b128 a[116:119], v13 offset:10240
    v_mfma_f32_16x16x32_bf16 v[120:123], a[84:87], a[0:3], v[120:123]
    s_waitcnt lgkmcnt(6)
    v_mfma_f32_16x16x32_bf16 v[128:131], a[88:91], a[0:3], v[128:131]
    ds_read_b128 a[120:123], v13 offset:12288
    v_mfma_f32_16x16x32_bf16 v[132:135], a[88:91], a[4:7], v[132:135]
    buffer_load_dwordx4 v10, s[48:51], s81 offen offset:3072 lds
    s_add_u32 s81, s81, 128
    v_mfma_f32_16x16x32_bf16 v[140:143], a[92:95], a[4:7], v[140:143]
    ds_read_b128 a[124:127], v13 offset:14336
    v_mfma_f32_16x16x32_bf16 v[136:139], a[92:95], a[0:3], v[136:139]
    s_waitcnt vmcnt(9)
    s_barrier
    s_waitcnt lgkmcnt(6)
    v_mfma_f32_16x16x32_bf16 v[80:83], a[96:99], a[8:11], v[80:83]
    ds_read_b128 a[64:67], v12 offset:16384
    v_mfma_f32_16x16x32_bf16 v[84:87], a[96:99], a[12:15], v[84:87]
    buffer_load_dwordx4 a[0:3], v2, s[60:63], s80 offen offset:0 sc1
    v_mfma_f32_16x16x32_bf16 v[92:95], a[100:103], a[12:15], v[92:95]
    ds_read_b128 a[68:71], v12 offset:18432
    v_mfma_f32_16x16x32_bf16 v[88:91], a[100:103], a[8:11], v[88:91]
    s_waitcnt lgkmcnt(6)
    s_add_u32 m0, s83, 49152
    v_mfma_f32_16x16x32_bf16 v[96:99], a[104:107], a[8:11], v[96:99]
    ds_read_b128 a[72:75], v12 offset:20480
    v_mfma_f32_16x16x32_bf16 v[100:103], a[104:107], a[12:15], v[100:103]
    buffer_load_dwordx4 v7, s[48:51], s81 offen offset:0 lds
    v_mfma_f32_16x16x32_bf16 v[108:111], a[108:111], a[12:15], v[108:111]
    ds_read_b128 a[76:79], v12 offset:22528
    v_mfma_f32_16x16x32_bf16 v[104:107], a[108:111], a[8:11], v[104:107]
    s_waitcnt lgkmcnt(6)
    v_mfma_f32_16x16x32_bf16 v[112:115], a[112:115], a[8:11], v[112:115]
    ds_read_b128 a[80:83], v12 offset:24576
    v_mfma_f32_16x16x32_bf16 v[116:119], a[112:115], a[12:15], v[116:119]
    buffer_load_dwordx4 a[4:7], v2, s[60:63], s80 offen offset:1024 sc1
    s_add_u32 s80, s80, 131072
    v_mfma_f32_16x16x32_bf16 v[124:127], a[116:119], a[12:15], v[124:127]
    ds_read_b128 a[84:87], v12 offset:26624
    v_mfma_f32_16x16x32_bf16 v[120:123], a[116:119], a[8:11], v[120:123]
    s_waitcnt lgkmcnt(6)
    v_mfma_f32_16x16x32_bf16 v[128:131], a[120:123], a[8:11], v[128:131]
    ds_read_b128 a[88:91], v12 offset:28672
    v_mfma_f32_16x16x32_bf16 v[132:135], a[120:123], a[12:15], v[132:135]
    buffer_load_dwordx4 v8, s[48:51], s81 offen offset:1024 lds
    v_mfma_f32_16x16x32_bf16 v[140:143], a[124:127], a[12:15], v[140:143]
    ds_read_b128 a[92:95], v12 offset:30720
    v_mfma_f32_16x16x32_bf16 v[136:139], a[124:127], a[8:11], v[136:139]
    s_waitcnt lgkmcnt(6)
    v_mfma_f32_16x16x32_bf16 v[80:83], a[64:67], a[16:19], v[80:83]
    ds_read_b128 a[96:99], v13 offset:16384
    v_mfma_f32_16x16x32_bf16 v[84:87], a[64:67], a[20:23], v[84:87]
    buffer_load_dwordx4 a[8:11], v2, s[60:63], s80 offen offset:0 sc1
    v_mfma_f32_16x16x32_bf16 v[92:95], a[68:71], a[20:23], v[92:95]
    ds_read_b128 a[100:103], v13 offset:18432
    v_mfma_f32_16x16x32_bf16 v[88:91], a[68:71], a[16:19], v[88:91]
    s_waitcnt lgkmcnt(6)
    v_mfma_f32_16x16x32_bf16 v[96:99], a[72:75], a[16:19], v[96:99]
    ds_read_b128 a[104:107], v13 offset:20480
    v_mfma_f32_16x16x32_bf16 v[100:103], a[72:75], a[20:23], v[100:103]
    buffer_load_dwordx4 v9, s[48:51], s81 offen offset:2048 lds
    v_mfma_f32_16x16x32_bf16 v[108:111], a[76:79], a[20:23], v[108:111]
    ds_read_b128 a[108:111], v13 offset:22528
    v_mfma_f32_16x16x32_bf16 v[104:107], a[76:79], a[16:19], v[104:107]
    s_waitcnt lgkmcnt(6)
    v_mfma_f32_16x16x32_bf16 v[112:115], a[80:83], a[16:19], v[112:115]
    ds_read_b128 a[112:115], v13 offset:24576
    v_mfma_f32_16x16x32_bf16 v[116:119], a[80:83], a[20:23], v[116:119]
    buffer_load_dwordx4 a[12:15], v2, s[60:63], s80 offen offset:1024 sc1
    s_add_u32 s80, s80, 131072
    v_mfma_f32_16x16x32_bf16 v[124:127], a[84:87], a[20:23], v[124:127]
    ds_read_b128 a[116:119], v13 offset:26624
    v_mfma_f32_16x16x32_bf16 v[120:123], a[84:87], a[16:19], v[120:123]
    s_waitcnt lgkmcnt(6)
    v_mfma_f32_16x16x32_bf16 v[128:131], a[88:91], a[16:19], v[128:131]
    ds_read_b128 a[120:123], v13 offset:28672
    v_mfma_f32_16x16x32_bf16 v[132:135], a[88:91], a[20:23], v[132:135]
    buffer_load_dwordx4 v10, s[48:51], s81 offen offset:3072 lds
    s_add_u32 s81, s81, 128
    v_mfma_f32_16x16x32_bf16 v[140:143], a[92:95], a[20:23], v[140:143]
    ds_read_b128 a[124:127], v13 offset:30720
    v_mfma_f32_16x16x32_bf16 v[136:139], a[92:95], a[16:19], v[136:139]
    s_waitcnt vmcnt(8)
    s_barrier
    s_waitcnt lgkmcnt(6)
    v_mfma_f32_16x16x32_bf16 v[80:83], a[96:99], a[24:27], v[80:83]
    ds_read_b128 a[64:67], v12 offset:32768
    v_mfma_f32_16x16x32_bf16 v[84:87], a[96:99], a[28:31], v[84:87]
    buffer_load_dwordx4 a[16:19], v2, s[60:63], s80 offen offset:0 sc1
    v_mfma_f32_16x16x32_bf16 v[92:95], a[100:103], a[28:31], v[92:95]
    ds_read_b128 a[68:71], v12 offset:34816
    v_mfma_f32_16x16x32_bf16 v[88:91], a[100:103], a[24:27], v[88:91]
    s_waitcnt lgkmcnt(6)
    s_add_u32 m0, s83, 0
    v_mfma_f32_16x16x32_bf16 v[96:99], a[104:107], a[24:27], v[96:99]
    ds_read_b128 a[72:75], v12 offset:36864
    v_mfma_f32_16x16x32_bf16 v[100:103], a[104:107], a[28:31], v[100:103]
    buffer_load_dwordx4 v7, s[48:51], s81 offen offset:0 lds
    v_mfma_f32_16x16x32_bf16 v[108:111], a[108:111], a[28:31], v[108:111]
    ds_read_b128 a[76:79], v12 offset:38912
    v_mfma_f32_16x16x32_bf16 v[104:107], a[108:111], a[24:27], v[104:107]
    s_waitcnt lgkmcnt(6)
    v_mfma_f32_16x16x32_bf16 v[112:115], a[112:115], a[24:27], v[112:115]
    ds_read_b128 a[80:83], v12 offset:40960
    v_mfma_f32_16x16x32_bf16 v[116:119], a[112:115], a[28:31], v[116:119]
    buffer_load_dwordx4 a[20:23], v2, s[60:63], s80 offen offset:1024 sc1
    s_add_u32 s80, s80, 131072
    v_mfma_f32_16x16x32_bf16 v[124:127], a[116:119], a[28:31], v[124:127]
    ds_read_b128 a[84:87], v12 offset:43008
    v_mfma_f32_16x16x32_bf16 v[120:123], a[116:119], a[24:27], v[120:123]
    s_waitcnt lgkmcnt(6)
    v_mfma_f32_16x16x32_bf16 v[128:131], a[120:123], a[24:27], v[128:131]
    ds_read_b128 a[88:91], v12 offset:45056
    v_mfma_f32_16x16x32_bf16 v[132:135], a[120:123], a[28:31], v[132:135]
    buffer_load_dwordx4 v8, s[48:51], s81 offen offset:1024 lds
    v_mfma_f32_16x16x32_bf16 v[140:143], a[124:127], a[28:31], v[140:143]
    ds_read_b128 a[92:95], v12 offset:47104
    v_mfma_f32_16x16x32_bf16 v[136:139], a[124:127], a[24:27], v[136:139]
    s_sub_u32 s88, s88, 1
    s_cmp_lg_u32 s88, 0
    s_cbranch_scc1 L_sloop
L_slast:
    s_waitcnt lgkmcnt(6)
    v_mfma_f32_16x16x32_bf16 v[80:83], a[64:67], a[32:35], v[80:83]
    ds_read_b128 a[96:99], v13 offset:32768
    v_mfma_f32_16x16x32_bf16 v[84:87], a[64:67], a[36:39], v[84:87]
    buffer_load_dwordx4 a[24:27], v2, s[60:63], s80 offen offset:0 sc1
    v_mfma_f32_16x16x32_bf16 v[92:95], a[68:71], a[36:39], v[92:95]
    ds_read_b128 a[100:103], v13 offset:34816
    v_mfma_f32_16x16x32_bf16 v[88:91], a[68:71], a[32:35], v[88:91]
    s_waitcnt lgkmcnt(6)
    v_mfma_f32_16x16x32_bf16 v[96:99], a[72:75], a[32:35], v[96:99]
    ds_read_b128 a[104:107], v13 offset:36864
    v_mfma_f32_16x16x32_bf16 v[100:103], a[72:75], a[36:39], v[100:103]
    buffer_load_dwordx4 v9, s[48:51], s81 offen offset:2048 lds
    v_mfma_f32_16x16x32_bf16 v[108:111], a[76:79], a[36:39], v[108:111]
    ds_read_b128 a[108:111], v13 offset:38912
    v_mfma_f32_16x16x32_bf16 v[104:107], a[76:79], a[32:35], v[104:107]
    s_waitcnt lgkmcnt(6)
    v_mfma_f32_16x16x32_bf16 v[112:115], a[80:83], a[32:35], v[112:115]
    ds_read_b128 a[112:115], v13 offset:40960
    v_mfma_f32_16x16x32_bf16 v[116:119], a[80:83], a[36:39], v[116:119]
    buffer_load_dwordx4 a[28:31], v2, s[60:63], s80 offen offset:1024 sc1
    s_add_u32 s80, s80, 131072
    v_mfma_f32_16x16x32_bf16 v[124:127], a[84:87], a[36:39], v[124:127]
    ds_read_b128 a[116:119], v13 offset:43008
    v_mfma_f32_16x16x32_bf16 v[120:123], a[84:87], a[32:35], v[120:123]
    s_waitcnt lgkmcnt(6)
    v_mfma_f32_16x16x32_bf16 v[128:131], a[88:91], a[32:35], v[128:131]
    ds_read_b128 a[120:123], v13 offset:45056
    v_mfma_f32_16x16x32_bf16 v[132:135], a[88:91], a[36:39], v[132:135]
    buffer_load_dwordx4 v10, s[48:51], s81 offen offset:3072 lds
    s_add_u32 s81, s81, 128
    v_mfma_f32_16x16x32_bf16 v[140:143], a[92:95], a[36:39], v[140:143]
    ds_read_b128 a[124:127], v13 offset:47104
    v_mfma_f32_16x16x32_bf16 v[136:139], a[92:95], a[32:35], v[136:139]
    s_waitcnt vmcnt(8)
    s_barrier
    s_waitcnt lgkmcnt(6)
    v_mfma_f32_16x16x32_bf16 v[80:83], a[96:99], a[40:43], v[80:83]
    ds_read_b128 a[64:67], v12 offset:49152
    v_mfma_f32_16x16x32_bf16 v[84:87], a[96:99], a[44:47], v[84:87]
    v_mfma_f32_16x16x32_bf16 v[92:95], a[100:103], a[44:47], v[92:95]
    ds_read_b128 a[68:71], v12 offset:51200
    v_mfma_f32_16x16x32_bf16 v[88:91], a[100:103], a[40:43], v[88:91]
    s_waitcnt lgkmcnt(6)
    s_add_u32 m0, s83, 16384
    v_mfma_f32_16x16x32_bf16 v[96:99], a[104:107], a[40:43], v[96:99]
    ds_read_b128 a[72:75], v12 offset:53248
    v_mfma_f32_16x16x32_bf16 v[100:103], a[104:107], a[44:47], v[100:103]
    buffer_load_dwordx4 v7, s[48:51], s81 offen offset:0 lds
    v_mfma_f32_16x16x32_bf16 v[108:111], a[108:111], a[44:47], v[108:111]
    ds_read_b128 a[76:79], v12 offset:55296
    v_mfma_f32_16x16x32_bf16 v[104:107], a[108:111], a[40:43], v[104:107]
    s_waitcnt lgkmcnt(6)
    v_lshrrev_b32 v27, 1, v41
    v_xor_b32 v27, v27, v42
    v_lshlrev_b32 v27, 4, v27
    v_lshl_add_u32 v27, v42, 8, v27
    v_and_b32 v28, 1, v41
    v_lshl_add_u32 v27, v28, 3, v27
    v_mfma_f32_16x16x32_bf16 v[112:115], a[112:115], a[40:43], v[112:115]
    ds_read_b128 a[80:83], v12 offset:57344
    v_mfma_f32_16x16x32_bf16 v[116:119], a[112:115], a[44:47], v[116:119]
    v_add_u32 v30, s90, v27
    s_lshl_b32 s93, s38, 13
    s_add_u32 s93, s93, 1024
    v_and_b32 v27, 7, v42
    v_xor_b32 v27, v27, v41
    v_lshlrev_b32 v27, 4, v27
    v_mfma_f32_16x16x32_bf16 v[124:127], a[116:119], a[44:47], v[124:127]
    ds_read_b128 a[84:87], v12 offset:59392
    v_mfma_f32_16x16x32_bf16 v[120:123], a[116:119], a[40:43], v[120:123]
    s_waitcnt lgkmcnt(6)
    v_lshl_add_u32 v28, v42, 7, v27
    v_lshrrev_b32 v27, 3, v1
    v_and_b32 v26, 7, v1
    v_xor_b32 v29, v26, v27
    v_lshlrev_b32 v29, 4, v29
    v_lshl_add_u32 v29, v27, 7, v29
    v_mfma_f32_16x16x32_bf16 v[128:131], a[120:123], a[40:43], v[128:131]
    ds_read_b128 a[88:91], v12 offset:61440
    v_mfma_f32_16x16x32_bf16 v[132:135], a[120:123], a[44:47], v[132:135]
    v_lshrrev_b32 v31, 2, v27
    v_and_b32 v27, 3, v27
    v_lshl_add_u32 v31, v31, 4, v27
    v_add_u32 v31, s89, v31
    v_lshlrev_b32 v31, 12, v31
    v_lshl_add_u32 v31, v26, 4, v31
    buffer_load_dwordx4 v8, s[48:51], s81 offen offset:1024 lds
    v_mfma_f32_16x16x32_bf16 v[140:143], a[124:127], a[44:47], v[140:143]
    ds_read_b128 a[92:95], v12 offset:63488
    v_mfma_f32_16x16x32_bf16 v[136:139], a[124:127], a[40:43], v[136:139]
    s_waitcnt lgkmcnt(6)
    v_mfma_f32_16x16x32_bf16 v[80:83], a[64:67], a[48:51], v[80:83]
    ds_read_b128 a[96:99], v13 offset:49152
    v_mfma_f32_16x16x32_bf16 v[84:87], a[64:67], a[52:55], v[84:87]
    v_mfma_f32_16x16x32_bf16 v[92:95], a[68:71], a[52:55], v[92:95]
    ds_read_b128 a[100:103], v13 offset:51200
    v_mfma_f32_16x16x32_bf16 v[88:91], a[68:71], a[48:51], v[88:91]
    s_waitcnt lgkmcnt(6)
    v_mfma_f32_16x16x32_bf16 v[96:99], a[72:75], a[48:51], v[96:99]
    ds_read_b128 a[104:107], v13 offset:53248
    v_mfma_f32_16x16x32_bf16 v[100:103], a[72:75], a[52:55], v[100:103]
    buffer_load_dwordx4 v9, s[48:51], s81 offen offset:2048 lds
    v_mfma_f32_16x16x32_bf16 v[108:111], a[76:79], a[52:55], v[108:111]
    ds_read_b128 a[108:111], v13 offset:55296
    v_mfma_f32_16x16x32_bf16 v[104:107], a[76:79], a[48:51], v[104:107]
    s_waitcnt lgkmcnt(6)
    s_lshl_b32 s94, s78, 9
    v_add_u32 v31, s94, v31
    v_add_u32 v28, s93, v28
    v_add_u32 v29, s93, v29
    v_mov_b32 v25, 0xffff0000
    v_mfma_f32_16x16x32_bf16 v[112:115], a[80:83], a[48:51], v[112:115]
    ds_read_b128 a[112:115], v13 offset:57344
    v_mfma_f32_16x16x32_bf16 v[116:119], a[80:83], a[52:55], v[116:119]
    s_mov_b32 s56, s32
    s_mov_b32 s57, s33
    s_mov_b32 s58, 0x800000
    s_mov_b32 s80, 0xbfb8aa3b
    v_mfma_f32_16x16x32_bf16 v[124:127], a[84:87], a[52:55], v[124:127]
    ds_read_b128 a[116:119], v13 offset:59392
    v_mfma_f32_16x16x32_bf16 v[120:123], a[84:87], a[48:51], v[120:123]
    s_waitcnt lgkmcnt(6)
    v_xor_b32 v4, 0, v30
    v_xor_b32 v5, 32, v30
    v_xor_b32 v6, 64, v30
    v_xor_b32 v7, 96, v30
    v_mfma_f32_16x16x32_bf16 v[128:131], a[88:91], a[48:51], v[128:131]
    ds_read_b128 a[120:123], v13 offset:61440
    v_mfma_f32_16x16x32_bf16 v[132:135], a[88:91], a[52:55], v[132:135]
    v_xor_b32 v16, 128, v30
    v_xor_b32 v17, 160, v30
    v_xor_b32 v18, 192, v30
    v_xor_b32 v19, 224, v30
    buffer_load_dwordx4 v10, s[48:51], s81 offen offset:3072 lds
    s_add_u32 s81, s81, 128
    v_mfma_f32_16x16x32_bf16 v[140:143], a[92:95], a[52:55], v[140:143]
    ds_read_b128 a[124:127], v13 offset:63488
    v_mfma_f32_16x16x32_bf16 v[136:139], a[92:95], a[48:51], v[136:139]
    s_waitcnt vmcnt(4)
    s_barrier
    s_waitcnt lgkmcnt(6)
    v_mfma_f32_16x16x32_bf16 v[80:83], a[96:99], a[56:59], v[80:83]
    ds_read_b128 a[64:67], v12 offset:0
    v_mfma_f32_16x16x32_bf16 v[84:87], a[96:99], a[60:63], v[84:87]
    v_mfma_f32_16x16x32_bf16 v[92:95], a[100:103], a[60:63], v[92:95]
    ds_read_b128 a[68:71], v12 offset:2048
    v_mfma_f32_16x16x32_bf16 v[88:91], a[100:103], a[56:59], v[88:91]
    s_waitcnt lgkmcnt(6)
    v_mfma_f32_16x16x32_bf16 v[96:99], a[104:107], a[56:59], v[96:99]
    ds_read_b128 a[72:75], v12 offset:4096
    v_mfma_f32_16x16x32_bf16 v[100:103], a[104:107], a[60:63], v[100:103]
    v_mfma_f32_16x16x32_bf16 v[108:111], a[108:111], a[60:63], v[108:111]
    ds_read_b128 a[76:79], v12 offset:6144
    v_mfma_f32_16x16x32_bf16 v[104:107], a[108:111], a[56:59], v[104:107]
    s_waitcnt lgkmcnt(6)
    v_mfma_f32_16x16x32_bf16 v[112:115], a[112:115], a[56:59], v[112:115]
    ds_read_b128 a[80:83], v12 offset:8192
    v_mfma_f32_16x16x32_bf16 v[116:119], a[112:115], a[60:63], v[116:119]
    v_mfma_f32_16x16x32_bf16 v[124:127], a[116:119], a[60:63], v[124:127]
    ds_read_b128 a[84:87], v12 offset:10240
    v_mfma_f32_16x16x32_bf16 v[120:123], a[116:119], a[56:59], v[120:123]
    s_waitcnt lgkmcnt(6)
    v_mfma_f32_16x16x32_bf16 v[128:131], a[120:123], a[56:59], v[128:131]
    ds_read_b128 a[88:91], v12 offset:12288
    v_mfma_f32_16x16x32_bf16 v[132:135], a[120:123], a[60:63], v[132:135]
    v_mfma_f32_16x16x32_bf16 v[140:143], a[124:127], a[60:63], v[140:143]
    ds_read_b128 a[92:95], v12 offset:14336
    v_mfma_f32_16x16x32_bf16 v[136:139], a[124:127], a[56:59], v[136:139]
    s_waitcnt lgkmcnt(6)
    v_mfma_f32_16x16x32_bf16 v[80:83], a[64:67], a[0:3], v[80:83]
    ds_read_b128 a[96:99], v13 offset:0
    v_mfma_f32_16x16x32_bf16 v[84:87], a[64:67], a[4:7], v[84:87]
    ds_read_b64 v[44:45], v4 offset:0
    v_mfma_f32_16x16x32_bf16 v[92:95], a[68:71], a[4:7], v[92:95]
    ds_read_b128 a[100:103], v13 offset:2048
    v_mfma_f32_16x16x32_bf16 v[88:91], a[68:71], a[0:3], v[88:91]
    s_waitcnt lgkmcnt(7)
    ds_read_b64 v[48:49], v5 offset:0
    v_mfma_f32_16x16x32_bf16 v[96:99], a[72:75], a[0:3], v[96:99]
    ds_read_b128 a[104:107], v13 offset:4096
    v_mfma_f32_16x16x32_bf16 v[100:103], a[72:75], a[4:7], v[100:103]
    ds_read_b64 v[52:53], v6 offset:0
    v_mfma_f32_16x16x32_bf16 v[108:111], a[76:79], a[4:7], v[108:111]
    ds_read_b128 a[108:111], v13 offset:6144
    v_mfma_f32_16x16x32_bf16 v[104:107], a[76:79], a[0:3], v[104:107]
    s_waitcnt lgkmcnt(9)
    ds_read_b64 v[56:57], v7 offset:0
    v_mfma_f32_16x16x32_bf16 v[112:115], a[80:83], a[0:3], v[112:115]
    ds_read_b128 a[112:115], v13 offset:8192
    v_mfma_f32_16x16x32_bf16 v[116:119], a[80:83], a[4:7], v[116:119]
    ds_read_b64 v[60:61], v16 offset:0
    v_mfma_f32_16x16x32_bf16 v[124:127], a[84:87], a[4:7], v[124:127]
    ds_read_b128 a[116:119], v13 offset:10240
    v_mfma_f32_16x16x32_bf16 v[120:123], a[84:87], a[0:3], v[120:123]
    s_waitcnt lgkmcnt(11)
    ds_read_b64 v[64:65], v17 offset:0
    v_mfma_f32_16x16x32_bf16 v[128:131], a[88:91], a[0:3], v[128:131]
    ds_read_b128 a[120:123], v13 offset:12288
    v_mfma_f32_16x16x32_bf16 v[132:135], a[88:91], a[4:7], v[132:135]
    ds_read_b64 v[68:69], v18 offset:0
    v_mfma_f32_16x16x32_bf16 v[140:143], a[92:95], a[4:7], v[140:143]
    ds_read_b128 a[124:127], v13 offset:14336
    v_mfma_f32_16x16x32_bf16 v[136:139], a[92:95], a[0:3], v[136:139]
    ds_read_b64 v[72:73], v19 offset:0
    s_waitcnt vmcnt(0)
    s_barrier
    s_waitcnt lgkmcnt(13)
    v_mfma_f32_16x16x32_bf16 v[80:83], a[96:99], a[8:11], v[80:83]
    ds_read_b128 a[64:67], v12 offset:16384
    v_mfma_f32_16x16x32_bf16 v[84:87], a[96:99], a[12:15], v[84:87]
    ds_read_b64 v[46:47], v4 offset:4096
    v_mfma_f32_16x16x32_bf16 v[92:95], a[100:103], a[12:15], v[92:95]
    ds_read_b128 a[68:71], v12 offset:18432
    v_mfma_f32_16x16x32_bf16 v[88:91], a[100:103], a[8:11], v[88:91]
    s_waitcnt lgkmcnt(12)
    ds_read_b64 v[50:51], v5 offset:4096
    v_mfma_f32_16x16x32_bf16 v[96:99], a[104:107], a[8:11], v[96:99]
    ds_read_b128 a[72:75], v12 offset:20480
    v_mfma_f32_16x16x32_bf16 v[100:103], a[104:107], a[12:15], v[100:103]
    ds_read_b64 v[54:55], v6 offset:4096
    v_mfma_f32_16x16x32_bf16 v[108:111], a[108:111], a[12:15], v[108:111]
    ds_read_b128 a[76:79], v12 offset:22528
    v_mfma_f32_16x16x32_bf16 v[104:107], a[108:111], a[8:11], v[104:107]
    s_waitcnt lgkmcnt(12)
    ds_read_b64 v[58:59], v7 offset:4096
    v_mfma_f32_16x16x32_bf16 v[112:115], a[112:115], a[8:11], v[112:115]
    ds_read_b128 a[80:83], v12 offset:24576
    v_mfma_f32_16x16x32_bf16 v[116:119], a[112:115], a[12:15], v[116:119]
    ds_read_b64 v[62:63], v16 offset:4096
    v_mfma_f32_16x16x32_bf16 v[124:127], a[116:119], a[12:15], v[124:127]
    ds_read_b128 a[84:87], v12 offset:26624
    v_mfma_f32_16x16x32_bf16 v[120:123], a[116:119], a[8:11], v[120:123]
    s_waitcnt lgkmcnt(12)
    ds_read_b64 v[66:67], v17 offset:4096
    v_mfma_f32_16x16x32_bf16 v[128:131], a[120:123], a[8:11], v[128:131]
    ds_read_b128 a[88:91], v12 offset:28672
    v_mfma_f32_16x16x32_bf16 v[132:135], a[120:123], a[12:15], v[132:135]
    ds_read_b64 v[70:71], v18 offset:4096
    v_mfma_f32_16x16x32_bf16 v[140:143], a[124:127], a[12:15], v[140:143]
    ds_read_b128 a[92:95], v12 offset:30720
    v_mfma_f32_16x16x32_bf16 v[136:139], a[124:127], a[8:11], v[136:139]
    ds_read_b64 v[74:75], v19 offset:4096
    s_waitcnt lgkmcnt(13)
    v_mfma_f32_16x16x32_bf16 v[80:83], a[64:67], a[16:19], v[80:83]
    ds_read_b128 a[96:99], v13 offset:16384
    v_mfma_f32_16x16x32_bf16 v[84:87], a[64:67], a[20:23], v[84:87]
    buffer_load_dwordx4 v[144:147], v15, s[64:67], 0 offen offset:0 sc1
    v_mfma_f32_16x16x32_bf16 v[92:95], a[68:71], a[20:23], v[92:95]
    ds_read_b128 a[100:103], v13 offset:18432
    v_mfma_f32_16x16x32_bf16 v[88:91], a[68:71], a[16:19], v[88:91]
    s_waitcnt lgkmcnt(11)
    buffer_load_dwordx4 v[148:151], v15, s[64:67], 0 offen offset:1024 sc1
    v_mfma_f32_16x16x32_bf16 v[96:99], a[72:75], a[16:19], v[96:99]
    ds_read_b128 a[104:107], v13 offset:20480
    v_mfma_f32_16x16x32_bf16 v[100:103], a[72:75], a[20:23], v[100:103]
    buffer_load_dwordx4 v[152:155], v15, s[64:67], 0 offen offset:2048 sc1
    v_mfma_f32_16x16x32_bf16 v[108:111], a[76:79], a[20:23], v[108:111]
    ds_read_b128 a[108:111], v13 offset:22528
    v_mfma_f32_16x16x32_bf16 v[104:107], a[76:79], a[16:19], v[104:107]
    s_waitcnt lgkmcnt(9)
    buffer_load_dwordx4 v[156:159], v15, s[64:67], 0 offen offset:3072 sc1
    v_mfma_f32_16x16x32_bf16 v[112:115], a[80:83], a[16:19], v[112:115]
    ds_read_b128 a[112:115], v13 offset:24576
    v_mfma_f32_16x16x32_bf16 v[116:119], a[80:83], a[20:23], v[116:119]
    buffer_load_dwordx4 v[160:163], v15, s[64:67], s85 offen offset:0 sc1
    v_mfma_f32_16x16x32_bf16 v[124:127], a[84:87], a[20:23], v[124:127]
    ds_read_b128 a[116:119], v13 offset:26624
    v_mfma_f32_16x16x32_bf16 v[120:123], a[84:87], a[16:19], v[120:123]
    s_waitcnt lgkmcnt(7)
    buffer_load_dwordx4 v[164:167], v15, s[64:67], s85 offen offset:1024 sc1
    v_mfma_f32_16x16x32_bf16 v[128:131], a[88:91], a[16:19], v[128:131]
    ds_read_b128 a[120:123], v13 offset:28672
    v_mfma_f32_16x16x32_bf16 v[132:135], a[88:91], a[20:23], v[132:135]
    buffer_load_dwordx4 v[168:171], v15, s[64:67], s85 offen offset:2048 sc1
    v_mfma_f32_16x16x32_bf16 v[140:143], a[92:95], a[20:23], v[140:143]
    ds_read_b128 a[124:127], v13 offset:30720
    v_mfma_f32_16x16x32_bf16 v[136:139], a[92:95], a[16:19], v[136:139]
    buffer_load_dwordx4 v[172:175], v15, s[64:67], s85 offen offset:3072 sc1
    s_waitcnt lgkmcnt(6)
    v_mfma_f32_16x16x32_bf16 v[80:83], a[96:99], a[24:27], v[80:83]
    v_xor_b32 v4, 64, v28
    v_mfma_f32_16x16x32_bf16 v[84:87], a[96:99], a[28:31], v[84:87]
    v_mfma_f32_16x16x32_bf16 v[92:95], a[100:103], a[28:31], v[92:95]
    v_mfma_f32_16x16x32_bf16 v[88:91], a[100:103], a[24:27], v[88:91]
    s_waitcnt lgkmcnt(4)
    v_mfma_f32_16x16x32_bf16 v[96:99], a[104:107], a[24:27], v[96:99]
    v_mfma_f32_16x16x32_bf16 v[100:103], a[104:107], a[28:31], v[100:103]
    v_mfma_f32_16x16x32_bf16 v[108:111], a[108:111], a[28:31], v[108:111]
    v_mfma_f32_16x16x32_bf16 v[104:107], a[108:111], a[24:27], v[104:107]
    s_waitcnt lgkmcnt(2)
    v_mfma_f32_16x16x32_bf16 v[112:115], a[112:115], a[24:27], v[112:115]
    v_mfma_f32_16x16x32_bf16 v[116:119], a[112:115], a[28:31], v[116:119]
    v_mfma_f32_16x16x32_bf16 v[124:127], a[116:119], a[28:31], v[124:127]
    v_mfma_f32_16x16x32_bf16 v[120:123], a[116:119], a[24:27], v[120:123]
    s_waitcnt lgkmcnt(0)
    v_mfma_f32_16x16x32_bf16 v[128:131], a[120:123], a[24:27], v[128:131]
    v_mfma_f32_16x16x32_bf16 v[132:135], a[120:123], a[28:31], v[132:135]
    v_mfma_f32_16x16x32_bf16 v[140:143], a[124:127], a[28:31], v[140:143]
    v_mfma_f32_16x16x32_bf16 v[136:139], a[124:127], a[24:27], v[136:139]
    s_branch L_fin
L_send:
    s_waitcnt lgkmcnt(0)
    v_mfma_f32_16x16x32_bf16 v[176:179], a[64:67], a[16:19], v[176:179]
    ds_read_b64_tr_b16 a[96:97], v16 offset:24576
    ds_read_b64_tr_b16 a[98:99], v16 offset:28672
    v_mfma_f32_16x16x32_bf16 v[180:183], a[64:67], a[20:23], v[180:183]
    ds_read_b64_tr_b16 a[100:101], v17 offset:24576
    ds_read_b64_tr_b16 a[102:103], v17 offset:28672
    v_mfma_f32_16x16x32_bf16 v[188:191], a[68:71], a[20:23], v[188:191]
    ds_read_b64_tr_b16 a[104:105], v18 offset:24576
    ds_read_b64_tr_b16 a[106:107], v18 offset:28672
    v_mfma_f32_16x16x32_bf16 v[184:187], a[68:71], a[16:19], v[184:187]
    ds_read_b64_tr_b16 a[108:109], v19 offset:24576
    ds_read_b64_tr_b16 a[110:111], v19 offset:28672
    v_mfma_f32_16x16x32_bf16 v[192:195], a[72:75], a[16:19], v[192:195]
    ds_read_b64_tr_b16 a[112:113], v20 offset:24576
    ds_read_b64_tr_b16 a[114:115], v20 offset:28672
    v_mfma_f32_16x16x32_bf16 v[196:199], a[72:75], a[20:23], v[196:199]
    ds_read_b64_tr_b16 a[116:117], v21 offset:24576
    ds_read_b64_tr_b16 a[118:119], v21 offset:28672
    v_mfma_f32_16x16x32_bf16 v[204:207], a[76:79], a[20:23], v[204:207]
    ds_read_b64_tr_b16 a[120:121], v22 offset:24576
    ds_read_b64_tr_b16 a[122:123], v22 offset:28672
    v_mfma_f32_16x16x32_bf16 v[200:203], a[76:79], a[16:19], v[200:203]
    ds_read_b64_tr_b16 a[124:125], v23 offset:24576
    ds_read_b64_tr_b16 a[126:127], v23 offset:28672
    s_waitcnt lgkmcnt(12)
    v_mfma_f32_16x16x32_bf16 v[176:179], a[96:99], a[24:27], v[176:179]
    v_mfma_f32_16x16x32_bf16 v[180:183], a[96:99], a[28:31], v[180:183]
    v_mfma_f32_16x16x32_bf16 v[188:191], a[100:103], a[28:31], v[188:191]
    v_mfma_f32_16x16x32_bf16 v[184:187], a[100:103], a[24:27], v[184:187]
    v_mfma_f32_16x16x32_bf16 v[208:211], a[80:83], a[16:19], v[208:211]
    v_mfma_f32_16x16x32_bf16 v[212:215], a[80:83], a[20:23], v[212:215]
    s_nop 5
    v_cvt_pk_bf16_f32 v176, v176, v177
    v_cvt_pk_bf16_f32 v177, v178, v179
    v_cvt_pk_bf16_f32 v178, v184, v185
    v_mfma_f32_16x16x32_bf16 v[220:223], a[84:87], a[20:23], v[220:223]
    v_cvt_pk_bf16_f32 v179, v186, v187
    v_min_u32 v176, v176, v25
    v_min_u32 v177, v177, v25
    v_mfma_f32_16x16x32_bf16 v[216:219], a[84:87], a[16:19], v[216:219]
    s_waitcnt lgkmcnt(8)
    v_min_u32 v178, v178, v25
    v_min_u32 v179, v179, v25
    buffer_store_dwordx4 v[176:179], v15, s[64:67], 0 offen offset:0 sc1
    v_mfma_f32_16x16x32_bf16 v[192:195], a[104:107], a[24:27], v[192:195]
    v_cvt_pk_bf16_f32 v180, v180, v181
    v_cvt_pk_bf16_f32 v181, v182, v183
    v_cvt_pk_bf16_f32 v182, v188, v189
    v_mfma_f32_16x16x32_bf16 v[196:199], a[104:107], a[28:31], v[196:199]
    v_cvt_pk_bf16_f32 v183, v190, v191
    v_min_u32 v180, v180, v25
    v_min_u32 v181, v181, v25
    v_mfma_f32_16x16x32_bf16 v[204:207], a[108:111], a[28:31], v[204:207]
    v_min_u32 v182, v182, v25
    v_min_u32 v183, v183, v25
    buffer_store_dwordx4 v[180:183], v15, s[64:67], 0 offen offset:1024 sc1
    v_mfma_f32_16x16x32_bf16 v[200:203], a[108:111], a[24:27], v[200:203]
    v_mfma_f32_16x16x32_bf16 v[224:227], a[88:91], a[16:19], v[224:227]
    v_mfma_f32_16x16x32_bf16 v[228:231], a[88:91], a[20:23], v[228:231]
    s_nop 5
    v_cvt_pk_bf16_f32 v192, v192, v193
    v_cvt_pk_bf16_f32 v193, v194, v195
    v_cvt_pk_bf16_f32 v194, v200, v201
    v_mfma_f32_16x16x32_bf16 v[236:239], a[92:95], a[20:23], v[236:239]
    v_cvt_pk_bf16_f32 v195, v202, v203
    v_min_u32 v192, v192, v25
    v_min_u32 v193, v193, v25
    v_mfma_f32_16x16x32_bf16 v[232:235], a[92:95], a[16:19], v[232:235]
    s_waitcnt lgkmcnt(4)
    v_min_u32 v194, v194, v25
    v_min_u32 v195, v195, v25
    buffer_store_dwordx4 v[192:195], v15, s[64:67], 0 offen offset:2048 sc1
    v_mfma_f32_16x16x32_bf16 v[208:211], a[112:115], a[24:27], v[208:211]
    v_cvt_pk_bf16_f32 v196, v196, v197
    v_cvt_pk_bf16_f32 v197, v198, v199
    v_cvt_pk_bf16_f32 v198, v204, v205
    v_mfma_f32_16x16x32_bf16 v[212:215], a[112:115], a[28:31], v[212:215]
    v_cvt_pk_bf16_f32 v199, v206, v207
    v_min_u32 v196, v196, v25
    v_min_u32 v197, v197, v25
    v_mfma_f32_16x16x32_bf16 v[220:223], a[116:119], a[28:31], v[220:223]
    v_min_u32 v198, v198, v25
    v_min_u32 v199, v199, v25
    buffer_store_dwordx4 v[196:199], v15, s[64:67], 0 offen offset:3072 sc1
    v_mfma_f32_16x16x32_bf16 v[216:219], a[116:119], a[24:27], v[216:219]
    s_waitcnt lgkmcnt(0)
    v_mfma_f32_16x16x32_bf16 v[224:227], a[120:123], a[24:27], v[224:227]
    v_mfma_f32_16x16x32_bf16 v[228:231], a[120:123], a[28:31], v[228:231]
    s_nop 5
    v_cvt_pk_bf16_f32 v208, v208, v209
    v_cvt_pk_bf16_f32 v209, v210, v211
    v_cvt_pk_bf16_f32 v210, v216, v217
    v_cvt_pk_bf16_f32 v211, v218, v219
    v_min_u32 v208, v208, v25
    v_min_u32 v209, v209, v25
    v_mfma_f32_16x16x32_bf16 v[236:239], a[124:127], a[28:31], v[236:239]
    v_min_u32 v210, v210, v25
    v_min_u32 v211, v211, v25
    buffer_store_dwordx4 v[208:211], v15, s[64:67], s85 offen offset:0 sc1
    v_cvt_pk_bf16_f32 v212, v212, v213
    v_cvt_pk_bf16_f32 v213, v214, v215
    v_cvt_pk_bf16_f32 v214, v220, v221
    v_mfma_f32_16x16x32_bf16 v[232:235], a[124:127], a[24:27], v[232:235]
    v_cvt_pk_bf16_f32 v215, v222, v223
    v_min_u32 v212, v212, v25
    v_min_u32 v213, v213, v25
    v_min_u32 v214, v214, v25
    v_min_u32 v215, v215, v25
    buffer_store_dwordx4 v[212:215], v15, s[64:67], s85 offen offset:1024 sc1
    s_nop 1
    v_cvt_pk_bf16_f32 v224, v224, v225
    v_cvt_pk_bf16_f32 v225, v226, v227
    v_cvt_pk_bf16_f32 v226, v232, v233
    v_cvt_pk_bf16_f32 v227, v234, v235
    v_min_u32 v224, v224, v25
    v_min_u32 v225, v225, v25
    v_min_u32 v226, v226, v25
    v_min_u32 v227, v227, v25
    buffer_store_dwordx4 v[224:227], v15, s[64:67], s85 offen offset:2048 sc1
    v_cvt_pk_bf16_f32 v228, v228, v229
    v_cvt_pk_bf16_f32 v229, v230, v231
    v_cvt_pk_bf16_f32 v230, v236, v237
    v_cvt_pk_bf16_f32 v231, v238, v239
    v_min_u32 v228, v228, v25
    v_min_u32 v229, v229, v25
    v_min_u32 v230, v230, v25
    v_min_u32 v231, v231, v25
    buffer_store_dwordx4 v[228:231], v15, s[64:67], s85 offen offset:3072 sc1
    s_branch L_done
L_fin:
    s_mov_b32 s91, 1048576
    s_waitcnt vmcnt(0)
L_need0:
    v_max3_u32 v26, v144, v145, v146
    v_max3_u32 v27, v147, v148, v149
    v_max3_u32 v26, v150, v151, v26
    v_max_u32 v26, v26, v27
    v_cmp_eq_u32 vcc, -1, v26
    s_cbranch_vccz L_have0
    s_waitcnt vmcnt(0)
    v_max3_u32 v26, v144, v145, v146
    v_max3_u32 v27, v147, v148, v149
    v_max3_u32 v26, v150, v151, v26
    v_max_u32 v26, v26, v27
    v_cmp_eq_u32 vcc, -1, v26
    s_sub_u32 s91, s91, 1
    s_cselect_b64 vcc, 0, vcc
    s_cbranch_vccz L_have0
    buffer_load_dwordx4 v[144:147], v15, s[64:67], 0 offen offset:0 sc1
    buffer_load_dwordx4 v[148:151], v15, s[64:67], 0 offen offset:1024 sc1
    s_waitcnt vmcnt(0)
    s_branch L_need0
L_have0:
    s_waitcnt lgkmcnt(0)
    v_max3_u32 v26, v152, v153, v154
    v_max3_u32 v27, v155, v156, v157
    v_max3_u32 v26, v158, v159, v26
    v_max_u32 v26, v26, v27
    v_cmp_eq_u32 vcc, -1, v26
    s_cbranch_vccz L_asked1
    buffer_load_dwordx4 v[152:155], v15, s[64:67], 0 offen offset:2048 sc1
    buffer_load_dwordx4 v[156:159], v15, s[64:67], 0 offen offset:3072 sc1
L_asked1:
    v_lshlrev_b32 v240, 16, v144
    v_and_b32 v241, v25, v144
    v_lshlrev_b32 v242, 16, v145
    v_and_b32 v243, v25, v145
    v_pk_add_f32 v[176:177], v[176:177], v[240:241]
    v_pk_add_f32 v[178:179], v[178:179], v[242:243]
    v_lshlrev_b32 v8, 16, v44
    v_pk_mul_f32 v[240:241], v[176:177], s[80:81] op_sel_hi:[1,0]
    v_pk_mul_f32 v[242:243], v[178:179], s[80:81] op_sel_hi:[1,0]
    v_and_b32 v9, v25, v44
    v_lshlrev_b32 v10, 16, v45
    v_exp_f32 v240, v240
    v_exp_f32 v241, v241
    v_exp_f32 v242, v242
    v_exp_f32 v243, v243
    v_pk_mul_f32 v[80:81], v[80:81], v[176:177]
    v_pk_add_f32 v[240:241], v[240:241], 1.0 op_sel_hi:[1,0]
    v_pk_add_f32 v[242:243], v[242:243], 1.0 op_sel_hi:[1,0]
    v_rcp_f32 v240, v240
    v_rcp_f32 v241, v241
    v_rcp_f32 v242, v242
    v_rcp_f32 v243, v243
    v_pk_mul_f32 v[82:83], v[82:83], v[178:179]
    v_and_b32 v11, v25, v45
    v_pk_fma_f32 v[176:177], v[80:81], v[240:241], v[8:9]
    v_pk_fma_f32 v[178:179], v[82:83], v[242:243], v[10:11]
    ds_write_b128 v28, v[176:179] offset:0
    v_lshlrev_b32 v244, 16, v146
    v_and_b32 v245, v25, v146
    v_lshlrev_b32 v246, 16, v147
    v_and_b32 v247, v25, v147
    v_pk_add_f32 v[184:185], v[184:185], v[244:245]
    v_pk_add_f32 v[186:187], v[186:187], v[246:247]
    v_lshlrev_b32 v20, 16, v48
    v_pk_mul_f32 v[244:245], v[184:185], s[80:81] op_sel_hi:[1,0]
    v_pk_mul_f32 v[246:247], v[186:187], s[80:81] op_sel_hi:[1,0]
    v_and_b32 v21, v25, v48
    v_lshlrev_b32 v22, 16, v49
    v_exp_f32 v244, v244
    v_exp_f32 v245, v245
    v_exp_f32 v246, v246
    v_exp_f32 v247, v247
    v_pk_mul_f32 v[88:89], v[88:89], v[184:185]
    v_pk_add_f32 v[244:245], v[244:245], 1.0 op_sel_hi:[1,0]
    v_pk_add_f32 v[246:247], v[246:247], 1.0 op_sel_hi:[1,0]
    v_rcp_f32 v244, v244
    v_rcp_f32 v245, v245
    v_rcp_f32 v246, v246
    v_rcp_f32 v247, v247
    v_pk_mul_f32 v[90:91], v[90:91], v[186:187]
    v_and_b32 v23, v25, v49
    v_pk_fma_f32 v[184:185], v[88:89], v[244:245], v[20:21]
    v_pk_fma_f32 v[186:187], v[90:91], v[246:247], v[22:23]
    ds_write_b128 v4, v[184:187] offset:0
    v_lshlrev_b32 v240, 16, v148
    v_and_b32 v241, v25, v148
    v_lshlrev_b32 v242, 16, v149
    v_and_b32 v243, v25, v149
    v_pk_add_f32 v[180:181], v[180:181], v[240:241]
    v_pk_add_f32 v[182:183], v[182:183], v[242:243]
    v_lshlrev_b32 v8, 16, v46
    v_pk_mul_f32 v[240:241], v[180:181], s[80:81] op_sel_hi:[1,0]
    v_pk_mul_f32 v[242:243], v[182:183], s[80:81] op_sel_hi:[1,0]
    v_and_b32 v9, v25, v46
    v_lshlrev_b32 v10, 16, v47
    v_exp_f32 v240, v240
    v_exp_f32 v241, v241
    v_exp_f32 v242, v242
    v_exp_f32 v243, v243
    v_pk_mul_f32 v[84:85], v[84:85], v[180:181]
    v_pk_add_f32 v[240:241], v[240:241], 1.0 op_sel_hi:[1,0]
    v_pk_add_f32 v[242:243], v[242:243], 1.0 op_sel_hi:[1,0]
    v_rcp_f32 v240, v240
    v_rcp_f32 v241, v241
    v_rcp_f32 v242, v242
    v_rcp_f32 v243, v243
    v_pk_mul_f32 v[86:87], v[86:87], v[182:183]
    v_and_b32 v11, v25, v47
    v_pk_fma_f32 v[180:181], v[84:85], v[240:241], v[8:9]
    v_pk_fma_f32 v[182:183], v[86:87], v[242:243], v[10:11]
    ds_write_b128 v28, v[180:183] offset:2048
    v_lshlrev_b32 v244, 16, v150
    v_and_b32 v245, v25, v150
    v_lshlrev_b32 v246, 16, v151
    v_and_b32 v247, v25, v151
    v_pk_add_f32 v[188:189], v[188:189], v[244:245]
    v_pk_add_f32 v[190:191], v[190:191], v[246:247]
    v_lshlrev_b32 v20, 16, v50
    v_pk_mul_f32 v[244:245], v[188:189], s[80:81] op_sel_hi:[1,0]
    v_pk_mul_f32 v[246:247], v[190:191], s[80:81] op_sel_hi:[1,0]
    v_and_b32 v21, v25, v50
    v_lshlrev_b32 v22, 16, v51
    v_exp_f32 v244, v244
    v_exp_f32 v245, v245
    v_exp_f32 v246, v246
    v_exp_f32 v247, v247
    v_pk_mul_f32 v[92:93], v[92:93], v[188:189]
    v_pk_add_f32 v[244:245], v[244:245], 1.0 op_sel_hi:[1,0]
    v_pk_add_f32 v[246:247], v[246:247], 1.0 op_sel_hi:[1,0]
    v_rcp_f32 v244, v244
    v_rcp_f32 v245, v245
    v_rcp_f32 v246, v246
    v_rcp_f32 v247, v247
    v_pk_mul_f32 v[94:95], v[94:95], v[190:191]
    v_and_b32 v23, v25, v51
    v_pk_fma_f32 v[188:189], v[92:93], v[244:245], v[20:21]
    v_pk_fma_f32 v[190:191], v[94:95], v[246:247], v[22:23]
    ds_write_b128 v4, v[188:191] offset:2048
L_need1:
    v_max3_u32 v26, v152, v153, v154
    v_max3_u32 v27, v155, v156, v157
    v_max3_u32 v26, v158, v159, v26
    v_max_u32 v26, v26, v27
    v_cmp_eq_u32 vcc, -1, v26
    s_cbranch_vccz L_have1
    s_waitcnt vmcnt(0)
    v_max3_u32 v26, v152, v153, v154
    v_max3_u32 v27, v155, v156, v157
    v_max3_u32 v26, v158, v159, v26
    v_max_u32 v26, v26, v27
    v_cmp_eq_u32 vcc, -1, v26
    s_sub_u32 s91, s91, 1
    s_cselect_b64 vcc, 0, vcc
    s_cbranch_vccz L_have1
    buffer_load_dwordx4 v[152:155], v15, s[64:67], 0 offen offset:2048 sc1
    buffer_load_dwordx4 v[156:159], v15, s[64:67], 0 offen offset:3072 sc1
    s_waitcnt vmcnt(0)
    s_branch L_need1
L_have1:
    v_max3_u32 v26, v160, v161, v162
    v_max3_u32 v27, v163, v164, v165
    v_max3_u32 v26, v166, v167, v26
    v_max_u32 v26, v26, v27
    v_cmp_eq_u32 vcc, -1, v26
    s_cbranch_vccz L_asked2
    buffer_load_dwordx4 v[160:163], v15, s[64:67], s85 offen offset:0 sc1
    buffer_load_dwordx4 v[164:167], v15, s[64:67], s85 offen offset:1024 sc1
L_asked2:
    s_waitcnt lgkmcnt(0)
    ds_read_b128 v[176:179], v29 offset:0
    v_lshlrev_b32 v240, 16, v152
    v_and_b32 v241, v25, v152
    v_lshlrev_b32 v242, 16, v153
    v_and_b32 v243, v25, v153
    v_pk_add_f32 v[192:193], v[192:193], v[240:241]
    v_pk_add_f32 v[194:195], v[194:195], v[242:243]
    v_lshlrev_b32 v8, 16, v52
    v_pk_mul_f32 v[240:241], v[192:193], s[80:81] op_sel_hi:[1,0]
    v_pk_mul_f32 v[242:243], v[194:195], s[80:81] op_sel_hi:[1,0]
    v_and_b32 v9, v25, v52
    v_lshlrev_b32 v10, 16, v53
    v_exp_f32 v240, v240
    v_exp_f32 v241, v241
    v_exp_f32 v242, v242
    v_exp_f32 v243, v243
    v_pk_mul_f32 v[96:97], v[96:97], v[192:193]
    v_pk_add_f32 v[240:241], v[240:241], 1.0 op_sel_hi:[1,0]
    v_pk_add_f32 v[242:243], v[242:243], 1.0 op_sel_hi:[1,0]
    v_rcp_f32 v240, v240
    v_rcp_f32 v241, v241
    v_rcp_f32 v242, v242
    v_rcp_f32 v243, v243
    v_pk_mul_f32 v[98:99], v[98:99], v[194:195]
    v_and_b32 v11, v25, v53
    v_pk_fma_f32 v[192:193], v[96:97], v[240:241], v[8:9]
    v_pk_fma_f32 v[194:195], v[98:99], v[242:243], v[10:11]
    s_waitcnt lgkmcnt(0)
    s_mov_b32 s94, 0
    buffer_store_dwordx4 v[176:179], v31, s[56:59], s94 offen nt
    ds_write_b128 v28, v[192:195] offset:4096
    ds_read_b128 v[180:183], v29 offset:1024
    v_lshlrev_b32 v244, 16, v154
    v_and_b32 v245, v25, v154
    v_lshlrev_b32 v246, 16, v155
    v_and_b32 v247, v25, v155
    v_pk_add_f32 v[200:201], v[200:201], v[244:245]
    v_pk_add_f32 v[202:203], v[202:203], v[246:247]
    v_lshlrev_b32 v20, 16, v56
    v_pk_mul_f32 v[244:245], v[200:201], s[80:81] op_sel_hi:[1,0]
    v_pk_mul_f32 v[246:247], v[202:203], s[80:81] op_sel_hi:[1,0]
    v_and_b32 v21, v25, v56
    v_lshlrev_b32 v22, 16, v57
    v_exp_f32 v244, v244
    v_exp_f32 v245, v245
    v_exp_f32 v246, v246
    v_exp_f32 v247, v247
    v_pk_mul_f32 v[104:105], v[104:105], v[200:201]
    v_pk_add_f32 v[244:245], v[244:245], 1.0 op_sel_hi:[1,0]
    v_pk_add_f32 v[246:247], v[246:247], 1.0 op_sel_hi:[1,0]
    v_rcp_f32 v244, v244
    v_rcp_f32 v245, v245
    v_rcp_f32 v246, v246
    v_rcp_f32 v247, v247
    v_pk_mul_f32 v[106:107], v[106:107], v[202:203]
    v_and_b32 v23, v25, v57
    v_pk_fma_f32 v[200:201], v[104:105], v[244:245], v[20:21]
    v_pk_fma_f32 v[202:203], v[106:107], v[246:247], v[22:23]
    s_waitcnt lgkmcnt(0)
    s_mov_b32 s94, 131072
    buffer_store_dwordx4 v[180:183], v31, s[56:59], s94 offen nt
    ds_write_b128 v4, v[200:203] offset:4096
    ds_read_b128 v[184:187], v29 offset:2048
    v_lshlrev_b32 v240, 16, v156
    v_and_b32 v241, v25, v156
    v_lshlrev_b32 v242, 16, v157
    v_and_b32 v243, v25, v157
    v_pk_add_f32 v[196:197], v[196:197], v[240:241]
    v_pk_add_f32 v[198:199], v[198:199], v[242:243]
    v_lshlrev_b32 v8, 16, v54
    v_pk_mul_f32 v[240:241], v[196:197], s[80:81] op_sel_hi:[1,0]
    v_pk_mul_f32 v[242:243], v[198:199], s[80:81] op_sel_hi:[1,0]
    v_and_b32 v9, v25, v54
    v_lshlrev_b32 v10, 16, v55
    v_exp_f32 v240, v240
    v_exp_f32 v241, v241
    v_exp_f32 v242, v242
    v_exp_f32 v243, v243
    v_pk_mul_f32 v[100:101], v[100:101], v[196:197]
    v_pk_add_f32 v[240:241], v[240:241], 1.0 op_sel_hi:[1,0]
    v_pk_add_f32 v[242:243], v[242:243], 1.0 op_sel_hi:[1,0]
    v_rcp_f32 v240, v240
    v_rcp_f32 v241, v241
    v_rcp_f32 v242, v242
    v_rcp_f32 v243, v243
    v_pk_mul_f32 v[102:103], v[102:103], v[198:199]
    v_and_b32 v11, v25, v55
    v_pk_fma_f32 v[196:197], v[100:101], v[240:241], v[8:9]
    v_pk_fma_f32 v[198:199], v[102:103], v[242:243], v[10:11]
    s_waitcnt lgkmcnt(0)
    s_mov_b32 s94, 16384
    buffer_store_dwordx4 v[184:187], v31, s[56:59], s94 offen nt
    ds_write_b128 v28, v[196:199] offset:6144
    ds_read_b128 v[188:191], v29 offset:3072
    v_lshlrev_b32 v244, 16, v158
    v_and_b32 v245, v25, v158
    v_lshlrev_b32 v246, 16, v159
    v_and_b32 v247, v25, v159
    v_pk_add_f32 v[204:205], v[204:205], v[244:245]
    v_pk_add_f32 v[206:207], v[206:207], v[246:247]
    v_lshlrev_b32 v20, 16, v58
    v_pk_mul_f32 v[244:245], v[204:205], s[80:81] op_sel_hi:[1,0]
    v_pk_mul_f32 v[246:247], v[206:207], s[80:81] op_sel_hi:[1,0]
    v_and_b32 v21, v25, v58
    v_lshlrev_b32 v22, 16, v59
    v_exp_f32 v244, v244
    v_exp_f32 v245, v245
    v_exp_f32 v246, v246
    v_exp_f32 v247, v247
    v_pk_mul_f32 v[108:109], v[108:109], v[204:205]
    v_pk_add_f32 v[244:245], v[244:245], 1.0 op_sel_hi:[1,0]
    v_pk_add_f32 v[246:247], v[246:247], 1.0 op_sel_hi:[1,0]
    v_rcp_f32 v244, v244
    v_rcp_f32 v245, v245
    v_rcp_f32 v246, v246
    v_rcp_f32 v247, v247
    v_pk_mul_f32 v[110:111], v[110:111], v[206:207]
    v_and_b32 v23, v25, v59
    v_pk_fma_f32 v[204:205], v[108:109], v[244:245], v[20:21]
    v_pk_fma_f32 v[206:207], v[110:111], v[246:247], v[22:23]
    s_waitcnt lgkmcnt(0)
    s_mov_b32 s94, 147456
    buffer_store_dwordx4 v[188:191], v31, s[56:59], s94 offen nt
    ds_write_b128 v4, v[204:207] offset:6144
L_need2:
    v_max3_u32 v26, v160, v161, v162
    v_max3_u32 v27, v163, v164, v165
    v_max3_u32 v26, v166, v167, v26
    v_max_u32 v26, v26, v27
    v_cmp_eq_u32 vcc, -1, v26
    s_cbranch_vccz L_have2
    s_waitcnt vmcnt(0)
    v_max3_u32 v26, v160, v161, v162
    v_max3_u32 v27, v163, v164, v165
    v_max3_u32 v26, v166, v167, v26
    v_max_u32 v26, v26, v27
    v_cmp_eq_u32 vcc, -1, v26
    s_sub_u32 s91, s91, 1
    s_cselect_b64 vcc, 0, vcc
    s_cbranch_vccz L_have2
    buffer_load_dwordx4 v[160:163], v15, s[64:67], s85 offen offset:0 sc1
    buffer_load_dwordx4 v[164:167], v15, s[64:67], s85 offen offset:1024 sc1
    s_waitcnt vmcnt(0)
    s_branch L_need2
L_have2:
    v_max3_u32 v26, v168, v169, v170
    v_max3_u32 v27, v171, v172, v173
    v_max3_u32 v26, v174, v175, v26
    v_max_u32 v26, v26, v27
    v_cmp_eq_u32 vcc, -1, v26
    s_cbranch_vccz L_asked3
    buffer_load_dwordx4 v[168:171], v15, s[64:67], s85 offen offset:2048 sc1
    buffer_load_dwordx4 v[172:175], v15, s[64:67], s85 offen offset:3072 sc1
L_asked3:
    s_waitcnt lgkmcnt(0)
    ds_read_b128 v[192:195], v29 offset:4096
    v_lshlrev_b32 v240, 16, v160
    v_and_b32 v241, v25, v160
    v_lshlrev_b32 v242, 16, v161
    v_and_b32 v243, v25, v161
    v_pk_add_f32 v[208:209], v[208:209], v[240:241]
    v_pk_add_f32 v[210:211], v[210:211], v[242:243]
    v_lshlrev_b32 v8, 16, v60
    v_pk_mul_f32 v[240:241], v[208:209], s[80:81] op_sel_hi:[1,0]
    v_pk_mul_f32 v[242:243], v[210:211], s[80:81] op_sel_hi:[1,0]
    v_and_b32 v9, v25, v60
    v_lshlrev_b32 v10, 16, v61
    v_exp_f32 v240, v240
    v_exp_f32 v241, v241
    v_exp_f32 v242, v242
    v_exp_f32 v243, v243
    v_pk_mul_f32 v[112:113], v[112:113], v[208:209]
    v_pk_add_f32 v[240:241], v[240:241], 1.0 op_sel_hi:[1,0]
    v_pk_add_f32 v[242:243], v[242:243], 1.0 op_sel_hi:[1,0]
    v_rcp_f32 v240, v240
    v_rcp_f32 v241, v241
    v_rcp_f32 v242, v242
    v_rcp_f32 v243, v243
    v_pk_mul_f32 v[114:115], v[114:115], v[210:211]
    v_and_b32 v11, v25, v61
    v_pk_fma_f32 v[208:209], v[112:113], v[240:241], v[8:9]
    v_pk_fma_f32 v[210:211], v[114:115], v[242:243], v[10:11]
    s_waitcnt lgkmcnt(0)
    s_mov_b32 s94, 128
    buffer_store_dwordx4 v[192:195], v31, s[56:59], s94 offen nt
    ds_write_b128 v28, v[208:211] offset:36864
    ds_read_b128 v[196:199], v29 offset:5120
    v_lshlrev_b32 v244, 16, v162
    v_and_b32 v245, v25, v162
    v_lshlrev_b32 v246, 16, v163
    v_and_b32 v247, v25, v163
    v_pk_add_f32 v[216:217], v[216:217], v[244:245]
    v_pk_add_f32 v[218:219], v[218:219], v[246:247]
    v_lshlrev_b32 v20, 16, v64
    v_pk_mul_f32 v[244:245], v[216:217], s[80:81] op_sel_hi:[1,0]
    v_pk_mul_f32 v[246:247], v[218:219], s[80:81] op_sel_hi:[1,0]
    v_and_b32 v21, v25, v64
    v_lshlrev_b32 v22, 16, v65
    v_exp_f32 v244, v244
    v_exp_f32 v245, v245
    v_exp_f32 v246, v246
    v_exp_f32 v247, v247
    v_pk_mul_f32 v[120:121], v[120:121], v[216:217]
    v_pk_add_f32 v[244:245], v[244:245], 1.0 op_sel_hi:[1,0]
    v_pk_add_f32 v[246:247], v[246:247], 1.0 op_sel_hi:[1,0]
    v_rcp_f32 v244, v244
    v_rcp_f32 v245, v245
    v_rcp_f32 v246, v246
    v_rcp_f32 v247, v247
    v_pk_mul_f32 v[122:123], v[122:123], v[218:219]
    v_and_b32 v23, v25, v65
    v_pk_fma_f32 v[216:217], v[120:121], v[244:245], v[20:21]
    v_pk_fma_f32 v[218:219], v[122:123], v[246:247], v[22:23]
    s_waitcnt lgkmcnt(0)
    s_mov_b32 s94, 131200
    buffer_store_dwordx4 v[196:199], v31, s[56:59], s94 offen nt
    ds_write_b128 v4, v[216:219] offset:36864
    ds_read_b128 v[200:203], v29 offset:6144
    v_lshlrev_b32 v240, 16, v164
    v_and_b32 v241, v25, v164
    v_lshlrev_b32 v242, 16, v165
    v_and_b32 v243, v25, v165
    v_pk_add_f32 v[212:213], v[212:213], v[240:241]
    v_pk_add_f32 v[214:215], v[214:215], v[242:243]
    v_lshlrev_b32 v8, 16, v62
    v_pk_mul_f32 v[240:241], v[212:213], s[80:81] op_sel_hi:[1,0]
    v_pk_mul_f32 v[242:243], v[214:215], s[80:81] op_sel_hi:[1,0]
    v_and_b32 v9, v25, v62
    v_lshlrev_b32 v10, 16, v63
    v_exp_f32 v240, v240
    v_exp_f32 v241, v241
    v_exp_f32 v242, v242
    v_exp_f32 v243, v243
    v_pk_mul_f32 v[116:117], v[116:117], v[212:213]
    v_pk_add_f32 v[240:241], v[240:241], 1.0 op_sel_hi:[1,0]
    v_pk_add_f32 v[242:243], v[242:243], 1.0 op_sel_hi:[1,0]
    v_rcp_f32 v240, v240
    v_rcp_f32 v241, v241
    v_rcp_f32 v242, v242
    v_rcp_f32 v243, v243
    v_pk_mul_f32 v[118:119], v[118:119], v[214:215]
    v_and_b32 v11, v25, v63
    v_pk_fma_f32 v[212:213], v[116:117], v[240:241], v[8:9]
    v_pk_fma_f32 v[214:215], v[118:119], v[242:243], v[10:11]
    s_waitcnt lgkmcnt(0)
    s_mov_b32 s94, 16512
    buffer_store_dwordx4 v[200:203], v31, s[56:59], s94 offen nt
    ds_write_b128 v28, v[212:215] offset:38912
    ds_read_b128 v[204:207], v29 offset:7168
    v_lshlrev_b32 v244, 16, v166
    v_and_b32 v245, v25, v166
    v_lshlrev_b32 v246, 16, v167
    v_and_b32 v247, v25, v167
    v_pk_add_f32 v[220:221], v[220:221], v[244:245]
    v_pk_add_f32 v[222:223], v[222:223], v[246:247]
    v_lshlrev_b32 v20, 16, v66
    v_pk_mul_f32 v[244:245], v[220:221], s[80:81] op_sel_hi:[1,0]
    v_pk_mul_f32 v[246:247], v[222:223], s[80:81] op_sel_hi:[1,0]
    v_and_b32 v21, v25, v66
    v_lshlrev_b32 v22, 16, v67
    v_exp_f32 v244, v244
    v_exp_f32 v245, v245
    v_exp_f32 v246, v246
    v_exp_f32 v247, v247
    v_pk_mul_f32 v[124:125], v[124:125], v[220:221]
    v_pk_add_f32 v[244:245], v[244:245], 1.0 op_sel_hi:[1,0]
    v_pk_add_f32 v[246:247], v[246:247], 1.0 op_sel_hi:[1,0]
    v_rcp_f32 v244, v244
    v_rcp_f32 v245, v245
    v_rcp_f32 v246, v246
    v_rcp_f32 v247, v247
    v_pk_mul_f32 v[126:127], v[126:127], v[222:223]
    v_and_b32 v23, v25, v67
    v_pk_fma_f32 v[220:221], v[124:125], v[244:245], v[20:21]
    v_pk_fma_f32 v[222:223], v[126:127], v[246:247], v[22:23]
    s_waitcnt lgkmcnt(0)
    s_mov_b32 s94, 147584
    buffer_store_dwordx4 v[204:207], v31, s[56:59], s94 offen nt
    ds_write_b128 v4, v[220:223] offset:38912
L_need3:
    v_max3_u32 v26, v168, v169, v170
    v_max3_u32 v27, v171, v172, v173
    v_max3_u32 v26, v174, v175, v26
    v_max_u32 v26, v26, v27
    v_cmp_eq_u32 vcc, -1, v26
    s_cbranch_vccz L_have3
    s_waitcnt vmcnt(0)
    v_max3_u32 v26, v168, v169, v170
    v_max3_u32 v27, v171, v172, v173
    v_max3_u32 v26, v174, v175, v26
    v_max_u32 v26, v26, v27
    v_cmp_eq_u32 vcc, -1, v26
    s_sub_u32 s91, s91, 1
    s_cselect_b64 vcc, 0, vcc
    s_cbranch_vccz L_have3
    buffer_load_dwordx4 v[168:171], v15, s[64:67], s85 offen offset:2048 sc1
    buffer_load_dwordx4 v[172:175], v15, s[64:67], s85 offen offset:3072 sc1
    s_waitcnt vmcnt(0)
    s_branch L_need3
L_have3:
    s_waitcnt lgkmcnt(0)
    ds_read_b128 v[208:211], v29 offset:36864
    v_lshlrev_b32 v240, 16, v168
    v_and_b32 v241, v25, v168
    v_lshlrev_b32 v242, 16, v169
    v_and_b32 v243, v25, v169
    v_pk_add_f32 v[224:225], v[224:225], v[240:241]
    v_pk_add_f32 v[226:227], v[226:227], v[242:243]
    v_lshlrev_b32 v8, 16, v68
    v_pk_mul_f32 v[240:241], v[224:225], s[80:81] op_sel_hi:[1,0]
    v_pk_mul_f32 v[242:243], v[226:227], s[80:81] op_sel_hi:[1,0]
    v_and_b32 v9, v25, v68
    v_lshlrev_b32 v10, 16, v69
    v_exp_f32 v240, v240
    v_exp_f32 v241, v241
    v_exp_f32 v242, v242
    v_exp_f32 v243, v243
    v_pk_mul_f32 v[128:129], v[128:129], v[224:225]
    v_pk_add_f32 v[240:241], v[240:241], 1.0 op_sel_hi:[1,0]
    v_pk_add_f32 v[242:243], v[242:243], 1.0 op_sel_hi:[1,0]
    v_rcp_f32 v240, v240
    v_rcp_f32 v241, v241
    v_rcp_f32 v242, v242
    v_rcp_f32 v243, v243
    v_pk_mul_f32 v[130:131], v[130:131], v[226:227]
    v_and_b32 v11, v25, v69
    v_pk_fma_f32 v[224:225], v[128:129], v[240:241], v[8:9]
    v_pk_fma_f32 v[226:227], v[130:131], v[242:243], v[10:11]
    s_waitcnt lgkmcnt(0)
    s_mov_b32 s94, 256
    buffer_store_dwordx4 v[208:211], v31, s[56:59], s94 offen nt
    ds_write_b128 v28, v[224:227] offset:40960
    ds_read_b128 v[212:215], v29 offset:37888
    v_lshlrev_b32 v244, 16, v170
    v_and_b32 v245, v25, v170
    v_lshlrev_b32 v246, 16, v171
    v_and_b32 v247, v25, v171
    v_pk_add_f32 v[232:233], v[232:233], v[244:245]
    v_pk_add_f32 v[234:235], v[234:235], v[246:247]
    v_lshlrev_b32 v20, 16, v72
    v_pk_mul_f32 v[244:245], v[232:233], s[80:81] op_sel_hi:[1,0]
    v_pk_mul_f32 v[246:247], v[234:235], s[80:81] op_sel_hi:[1,0]
    v_and_b32 v21, v25, v72
    v_lshlrev_b32 v22, 16, v73
    v_exp_f32 v244, v244
    v_exp_f32 v245, v245
    v_exp_f32 v246, v246
    v_exp_f32 v247, v247
    v_pk_mul_f32 v[136:137], v[136:137], v[232:233]
    v_pk_add_f32 v[244:245], v[244:245], 1.0 op_sel_hi:[1,0]
    v_pk_add_f32 v[246:247], v[246:247], 1.0 op_sel_hi:[1,0]
    v_rcp_f32 v244, v244
    v_rcp_f32 v245, v245
    v_rcp_f32 v246, v246
    v_rcp_f32 v247, v247
    v_pk_mul_f32 v[138:139], v[138:139], v[234:235]
    v_and_b32 v23, v25, v73
    v_pk_fma_f32 v[232:233], v[136:137], v[244:245], v[20:21]
    v_pk_fma_f32 v[234:235], v[138:139], v[246:247], v[22:23]
    s_waitcnt lgkmcnt(0)
    s_mov_b32 s94, 131328
    buffer_store_dwordx4 v[212:215], v31, s[56:59], s94 offen nt
    ds_write_b128 v4, v[232:235] offset:40960
    ds_read_b128 v[216:219], v29 offset:38912
    v_lshlrev_b32 v240, 16, v172
    v_and_b32 v241, v25, v172
    v_lshlrev_b32 v242, 16, v173
    v_and_b32 v243, v25, v173
    v_pk_add_f32 v[228:229], v[228:229], v[240:241]
    v_pk_add_f32 v[230:231], v[230:231], v[242:243]
    v_lshlrev_b32 v8, 16, v70
    v_pk_mul_f32 v[240:241], v[228:229], s[80:81] op_sel_hi:[1,0]
    v_pk_mul_f32 v[242:243], v[230:231], s[80:81] op_sel_hi:[1,0]
    v_and_b32 v9, v25, v70
    v_lshlrev_b32 v10, 16, v71
    v_exp_f32 v240, v240
    v_exp_f32 v241, v241
    v_exp_f32 v242, v242
    v_exp_f32 v243, v243
    v_pk_mul_f32 v[132:133], v[132:133], v[228:229]
    v_pk_add_f32 v[240:241], v[240:241], 1.0 op_sel_hi:[1,0]
    v_pk_add_f32 v[242:243], v[242:243], 1.0 op_sel_hi:[1,0]
    v_rcp_f32 v240, v240
    v_rcp_f32 v241, v241
    v_rcp_f32 v242, v242
    v_rcp_f32 v243, v243
    v_pk_mul_f32 v[134:135], v[134:135], v[230:231]
    v_and_b32 v11, v25, v71
    v_pk_fma_f32 v[228:229], v[132:133], v[240:241], v[8:9]
    v_pk_fma_f32 v[230:231], v[134:135], v[242:243], v[10:11]
    s_waitcnt lgkmcnt(0)
    s_mov_b32 s94, 16640
    buffer_store_dwordx4 v[216:219], v31, s[56:59], s94 offen nt
    ds_write_b128 v28, v[228:231] offset:43008
    ds_read_b128 v[220:223], v29 offset:39936
    v_lshlrev_b32 v244, 16, v174
    v_and_b32 v245, v25, v174
    v_lshlrev_b32 v246, 16, v175
    v_and_b32 v247, v25, v175
    v_pk_add_f32 v[236:237], v[236:237], v[244:245]
    v_pk_add_f32 v[238:239], v[238:239], v[246:247]
    v_lshlrev_b32 v20, 16, v74
    v_pk_mul_f32 v[244:245], v[236:237], s[80:81] op_sel_hi:[1,0]
    v_pk_mul_f32 v[246:247], v[238:239], s[80:81] op_sel_hi:[1,0]
    v_and_b32 v21, v25, v74
    v_lshlrev_b32 v22, 16, v75
    v_exp_f32 v244, v244
    v_exp_f32 v245, v245
    v_exp_f32 v246, v246
    v_exp_f32 v247, v247
    v_pk_mul_f32 v[140:141], v[140:141], v[236:237]
    v_pk_add_f32 v[244:245], v[244:245], 1.0 op_sel_hi:[1,0]
    v_pk_add_f32 v[246:247], v[246:247], 1.0 op_sel_hi:[1,0]
    v_rcp_f32 v244, v244
    v_rcp_f32 v245, v245
    v_rcp_f32 v246, v246
    v_rcp_f32 v247, v247
    v_pk_mul_f32 v[142:143], v[142:143], v[238:239]
    v_and_b32 v23, v25, v75
    v_pk_fma_f32 v[236:237], v[140:141], v[244:245], v[20:21]
    v_pk_fma_f32 v[238:239], v[142:143], v[246:247], v[22:23]
    s_waitcnt lgkmcnt(0)
    s_mov_b32 s94, 147712
    buffer_store_dwordx4 v[220:223], v31, s[56:59], s94 offen nt
    ds_write_b128 v4, v[236:239] offset:43008
    s_waitcnt lgkmcnt(0)
    ds_read_b128 v[224:227], v29 offset:40960
    ds_read_b128 v[228:231], v29 offset:41984
    ds_read_b128 v[232:235], v29 offset:43008
    ds_read_b128 v[236:239], v29 offset:44032
    s_waitcnt lgkmcnt(3)
    s_mov_b32 s94, 384
    buffer_store_dwordx4 v[224:227], v31, s[56:59], s94 offen nt
    s_waitcnt lgkmcnt(2)
    s_mov_b32 s94, 131456
    buffer_store_dwordx4 v[228:231], v31, s[56:59], s94 offen nt
    s_waitcnt lgkmcnt(1)
    s_mov_b32 s94, 16768
    buffer_store_dwordx4 v[232:235], v31, s[56:59], s94 offen nt
    s_waitcnt lgkmcnt(0)
    s_mov_b32 s94, 147840
    buffer_store_dwordx4 v[236:239], v31, s[56:59], s94 offen nt
L_done:
L_end:
    s_endpgm
L_code_end:
.section .rodata,"a"
.p2align 6
.amdhsa_kernel recurrent_scan__ssm_conv_s5__mixer_channel_mlp__prompt_kernel
  .amdhsa_next_free_vgpr 456
  .amdhsa_next_free_sgpr 102
  .amdhsa_accum_offset 256
  .amdhsa_group_segment_fixed_size 0
  .amdhsa_kernarg_size 136
  .amdhsa_user_sgpr_count 2
  .amdhsa_user_sgpr_kernarg_segment_ptr 1
  .amdhsa_system_sgpr_workgroup_id_x 1
  .amdhsa_float_denorm_mode_32 3
.end_amdhsa_kernel
```
